```python
import torch

def _softmax(x, axis=-1):
    return torch.softmax(x, dim=axis)
def _gelu(x):
    return torch.nn.functional.gelu(x, approximate="tanh")
def _silu(x):
    return torch.nn.functional.silu(x)
def _sigmoid(x):
    return torch.sigmoid(x)
def _layernorm(x, axis=-1, eps=1e-5):
    m = x.mean(dim=axis, keepdim=True)
    v = x.var(dim=axis, keepdim=True, unbiased=False)
    return (x - m) / torch.sqrt(v + eps)
def _scatter_add(tgt, idx, src, axis=0):
    return tgt.clone().index_add_(axis, idx, src)
def _segment_sum(src, seg, n):
    out = torch.zeros((n,) + src.shape[1:], dtype=src.dtype)
    return out.index_add_(0, seg, src)
def _pad(x, pw):
    flat = tuple(v for pair in reversed(pw) for v in pair)
    return torch.nn.functional.pad(x, flat)

kernel_name = 'standalone__seq2seq_rnn_t_joint__speech'

def setup_inputs():

    _w = (lambda a: (lambda t: t.to(torch.bfloat16) if t.is_floating_point() else t)(torch.as_tensor(a)))
    B, T, D, K = 2, 4000, 512, 5
    U = 8
    sc = (1.0 / (K * D)) ** 0.5
    sd = (1.0 / D) ** 0.5
    return {
        "x": _w((lambda *s: torch.randn(*s, dtype=torch.bfloat16) * 0.2)(B, T, D) * 0.5),
        "w1": _w((lambda *s: torch.randn(*s, dtype=torch.bfloat16) * 3.2)(K, D, D) * sc),
        "w2": _w((lambda *s: torch.randn(*s, dtype=torch.bfloat16) * 3.2)(K, D, D) * sc),
        "g": _w((lambda *s: torch.randn(*s, dtype=torch.bfloat16) * 3.2)(B, U, D) * 0.5),
        "w_f": _w((lambda *s: torch.randn(*s, dtype=torch.bfloat16) * 3.2)(D, D) * sd),
        "w_g": _w((lambda *s: torch.randn(*s, dtype=torch.bfloat16) * 3.2)(D, D) * sd),
        "w_o": _w((lambda *s: torch.randn(*s, dtype=torch.bfloat16) * 3.2)(D, D) * sd),
    }

def reference(x, w1, w2, g, w_f, w_g, w_o):
    B, T, D = x.shape
    K = w1.shape[0]
    pad = K // 2
    xp = _pad(x, ((0,0),(pad,pad),(0,0)))
    h = torch.zeros_like(x)
    for i in range(K):
        h = h + torch.einsum("btc,cd->btd", xp[:, i:i+T, :], w1[i])
    h = _gelu(h)[:, ::2, :]
    T1 = h.shape[1]
    hp = _pad(h, ((0,0),(pad,pad),(0,0)))
    f = torch.zeros_like(h)
    for i in range(K):
        f = f + torch.einsum("btc,cd->btd", hp[:, i:i+T1, :], w2[i])
    f = _gelu(f)[:, ::2, :]
    fe = torch.einsum("btd,de->bte", f, w_f)
    ge = torch.einsum("bud,de->bue", g, w_g)
    j = torch.tanh(fe[:, :, None, :] + ge[:, None, :, :])
    return torch.einsum("btud,dv->btuv", j, w_o)
```

```asm
; @launch grid=(256,1,1) block=(512,1,1) lds=163840
.amdgcn_target "amdgcn-amd-amdhsa--gfx950"
.text
.globl standalone__seq2seq_rnn_t_joint__speech_kernel
.p2align 8
.type standalone__seq2seq_rnn_t_joint__speech_kernel,@function
standalone__seq2seq_rnn_t_joint__speech_kernel:
  s_cmp_ge_u32 s2, 256
  s_cbranch_scc1 L_done
  s_load_dwordx16 s[32:47], s[0:1], 0
  s_load_dwordx4 s[48:51], s[0:1], 64
  s_getpc_b64 s[26:27]
L_pc_here:
  s_sub_u32 s26, s26, L_pc_here-standalone__seq2seq_rnn_t_joint__speech_kernel
  s_subb_u32 s27, s27, 0
  s_lshr_b32 s24, s2, 3
  s_lshl_b32 s24, s24, 4
  v_add_u32 v1, s24, v0
  v_lshlrev_b32 v1, 7, v1
  v_min_u32 v1, L_code_end-standalone__seq2seq_rnn_t_joint__speech_kernel-4, v1
  v_cmp_gt_u32 vcc, 16, v0
  s_and_saveexec_b64 s[82:83], vcc
  s_cbranch_execz L_cpf_1
  global_load_dword v71, v1, s[26:27]
L_cpf_1:
  s_mov_b64 exec, s[82:83]
  v_lshrrev_b32 v1, 6, v0
  s_and_b32 s4, s2, 7
  v_readfirstlane_b32 s3, v1
  s_lshr_b32 s5, s2, 3
  s_lshr_b32 s6, s4, 2
  s_and_b32 s7, s4, 3
  v_and_b32 v0, 63, v0
  s_lshr_b32 s61, s5, 3
  s_and_b32 s62, s5, 7
  s_lshl_b32 s60, s4, 1
  s_cmp_ge_u32 s3, 4
  s_cbranch_scc1 L_loader
  s_waitcnt lgkmcnt(0)
  s_lshr_b32 s26, s60, 1
  s_add_u32 s26, s26, s3
  s_add_u32 s26, s26, 0
  s_and_b32 s26, s26, 7
  s_lshl_b32 s26, s26, 7
  s_mul_i32 s27, s6, 4096000
  s_add_u32 s26, s26, s27
  s_lshl_b32 s24, s5, 5
  s_mul_i32 s27, s7, 1000
  s_add_u32 s24, s24, s27
  s_sub_u32 s24, s24, 6
  v_add_u32 v1, s24, v0
  v_max_i32 v1, 0, v1
  v_min_i32 v1, 3999, v1
  v_lshlrev_b32 v1, 10, v1
  v_add_u32 v1, s26, v1
  s_mov_b64 exec, 0xffffffff
  global_load_dword v67, v1, s[32:33]
  s_mov_b64 exec, -1
  s_lshr_b32 s24, s34, 7
  s_sub_u32 s24, 3, s24
  s_and_b32 s24, s24, 7
  s_lshl_b32 s24, s24, 7
  s_lshl_b32 s25, s5, 10
  s_add_u32 s24, s24, s25
  s_add_u32 s25, s60, s3
  s_add_u32 s25, s25, 0
  s_and_b32 s25, s25, 15
  s_lshl_b32 s25, s25, 15
  s_add_u32 s24, s24, s25
  v_lshlrev_b32 v1, 19, v0
  v_add_u32 v1, s24, v1
  s_mov_b64 exec, 0x1f
  global_load_dword v68, v1, s[34:35]
  s_mov_b64 exec, -1
  s_cmp_lg_u32 s3, 2
  s_cbranch_scc1 L_cen2_2
  s_getreg_b32 s24, hwreg(HW_REG_XCC_ID)
  s_memrealtime s[26:27]
  s_and_b32 s24, s24, 15
  s_mul_i32 s25, s24, s24
  s_lshl_b32 s25, s25, 20
  s_lshl_b32 s52, s24, 8
  s_add_u32 s25, s25, s52
  s_add_u32 s25, s25, 1
  s_waitcnt lgkmcnt(0)
  v_mov_b32 v2, s25
  v_mov_b32 v3, s26
  s_lshr_b32 s52, s4, 2
  s_lshl_b32 s52, s52, 7
  s_and_b32 s55, s4, 3
  s_lshl_b32 s55, s55, 3
  s_add_u32 s52, s52, s55
  v_mov_b32 v1, s52
  s_mov_b64 exec, 1
  global_atomic_add_x2 v1, v[2:3], s[48:49] sc1
  s_mov_b64 exec, -1
L_cen2_2:
  s_lshl_b32 s24, s4, 12
  s_add_u32 s84, s50, s24
  s_addc_u32 s85, s51, 0
  s_add_u32 s84, s84, 11534336
  s_addc_u32 s85, s85, 0
  s_mov_b32 s86, 4096
  s_mov_b32 s87, 0x00020000
  s_lshl_b32 s24, s4, 19
  s_add_u32 s16, s50, s24
  s_addc_u32 s17, s51, 0
  s_mov_b32 s18, 524288
  s_mov_b32 s19, 0x00020000
  s_lshr_b32 s24, s3, 1
  s_and_b32 s25, s3, 1
  v_and_b32 v1, 15, v0
  v_lshrrev_b32 v2, 4, v0
  s_lshl_b32 s26, s24, 4
  v_add_u32 v1, s26, v1
  v_add_u32 v5, 0, v1
  v_bfe_u32 v6, v5, 1, 3
  v_lshlrev_b32 v5, 7, v5
  v_xor_b32 v6, v6, v2
  v_lshlrev_b32 v6, 4, v6
  v_add_u32 v5, v5, v6
  v_mov_b32 v40, v5
  v_xor_b32 v41, 64, v40
  v_add_u32 v5, 1, v1
  v_bfe_u32 v6, v5, 1, 3
  v_lshlrev_b32 v5, 7, v5
  v_xor_b32 v6, v6, v2
  v_lshlrev_b32 v6, 4, v6
  v_add_u32 v5, v5, v6
  v_mov_b32 v42, v5
  v_xor_b32 v43, 64, v42
  v_lshrrev_b32 v5, 4, v0
  v_mul_u32_u24 v6, 5120, v5
  v_bfe_u32 v7, v0, 2, 2
  v_lshlrev_b32 v3, 7, v7
  v_add_u32 v6, v6, v3
  v_lshrrev_b32 v7, 1, v7
  v_and_b32 v5, 1, v5
  v_lshlrev_b32 v5, 1, v5
  v_add_u32 v7, v7, v5
  s_lshl_b32 s26, s25, 1
  v_xor_b32 v7, s26, v7
  v_lshlrev_b32 v7, 5, v7
  v_add_u32 v6, v6, v7
  v_and_b32 v7, 3, v0
  v_lshlrev_b32 v7, 3, v7
  v_add_u32 v6, v6, v7
  v_add_u32 v44, 69632, v6
  v_xor_b32 v45, 32, v44
  v_add_u32 v46, 40960, v44
  v_add_u32 v47, 40960, v45
  s_lshr_b32 s52, s4, 2
  s_lshl_b32 s52, s52, 7
  s_and_b32 s55, s4, 3
  s_lshl_b32 s55, s55, 3
  s_add_u32 s52, s52, s55
  v_mov_b32 v66, s52
  v_mov_b32 v8, 0
  v_mov_b32 v9, 0
  v_mov_b32 v10, 0
  v_mov_b32 v11, 0
  v_mov_b32 v12, 0
  v_mov_b32 v13, 0
  v_mov_b32 v14, 0
  v_mov_b32 v15, 0
  v_mov_b32 v16, 0
  v_mov_b32 v17, 0
  v_mov_b32 v18, 0
  v_mov_b32 v19, 0
  v_mov_b32 v20, 0
  v_mov_b32 v21, 0
  v_mov_b32 v22, 0
  v_mov_b32 v23, 0
  v_mov_b32 v24, 0
  v_mov_b32 v25, 0
  v_mov_b32 v26, 0
  v_mov_b32 v27, 0
  v_mov_b32 v28, 0
  v_mov_b32 v29, 0
  v_mov_b32 v30, 0
  v_mov_b32 v31, 0
  v_mov_b32 v32, 0
  v_mov_b32 v33, 0
  v_mov_b32 v34, 0
  v_mov_b32 v35, 0
  v_mov_b32 v36, 0
  v_mov_b32 v37, 0
  v_mov_b32 v38, 0
  v_mov_b32 v39, 0
  s_barrier
  ds_read_b64_tr_b16 a[44:45], v44 offset:0
  ds_read_b64_tr_b16 a[46:47], v44 offset:512
  ds_read_b64_tr_b16 a[48:49], v45 offset:0
  ds_read_b64_tr_b16 a[50:51], v45 offset:512
  ds_read_b128 a[0:3], v40 offset:0
  ds_read_b128 a[8:11], v40 offset:8704
  ds_read_b128 a[16:19], v40 offset:17408
  ds_read_b128 a[24:27], v40 offset:26112
  ds_read_b64_tr_b16 a[52:53], v44 offset:1024
  ds_read_b64_tr_b16 a[54:55], v44 offset:1536
  ds_read_b64_tr_b16 a[56:57], v45 offset:1024
  ds_read_b64_tr_b16 a[58:59], v45 offset:1536
  ds_read_b128 a[4:7], v40 offset:4352
  ds_read_b128 a[12:15], v40 offset:13056
  ds_read_b128 a[20:23], v40 offset:21760
  ds_read_b128 a[28:31], v40 offset:30464
  ds_read_b64_tr_b16 a[60:61], v44 offset:2048
  ds_read_b64_tr_b16 a[62:63], v44 offset:2560
  ds_read_b64_tr_b16 a[64:65], v45 offset:2048
  ds_read_b64_tr_b16 a[66:67], v45 offset:2560
  ds_read_b128 a[32:35], v42 offset:0
  ds_read_b64_tr_b16 a[68:69], v44 offset:3072
  ds_read_b64_tr_b16 a[70:71], v44 offset:3584
  ds_read_b64_tr_b16 a[72:73], v45 offset:3072
  ds_read_b64_tr_b16 a[74:75], v45 offset:3584
  ds_read_b128 a[36:39], v42 offset:4352
  ds_read_b64_tr_b16 a[76:77], v44 offset:4096
  ds_read_b64_tr_b16 a[78:79], v44 offset:4608
  ds_read_b64_tr_b16 a[80:81], v45 offset:4096
  ds_read_b64_tr_b16 a[82:83], v45 offset:4608
  ds_read_b128 a[40:43], v42 offset:8704
  s_waitcnt lgkmcnt(0)
  s_barrier
  v_mfma_f32_16x16x32_bf16 v[8:11], a[44:47], a[0:3], v[8:11]
  ds_read_b64_tr_b16 v[88:89], v44 offset:20480
  ds_read_b64_tr_b16 v[90:91], v44 offset:20992
  v_mfma_f32_16x16x32_bf16 v[12:15], a[48:51], a[0:3], v[12:15]
  ds_read_b64_tr_b16 v[92:93], v45 offset:20480
  v_mfma_f32_16x16x32_bf16 v[16:19], a[44:47], a[8:11], v[16:19]
  ds_read_b64_tr_b16 v[94:95], v45 offset:20992
  v_mfma_f32_16x16x32_bf16 v[20:23], a[48:51], a[8:11], v[20:23]
  ds_read_b128 a[84:87], v41 offset:0
  v_mfma_f32_16x16x32_bf16 v[24:27], a[44:47], a[16:19], v[24:27]
  ds_read_b128 a[92:95], v41 offset:8704
  v_mfma_f32_16x16x32_bf16 v[28:31], a[48:51], a[16:19], v[28:31]
  ds_read_b128 a[100:103], v41 offset:17408
  v_mfma_f32_16x16x32_bf16 v[32:35], a[44:47], a[24:27], v[32:35]
  ds_read_b128 a[108:111], v41 offset:26112
  v_mfma_f32_16x16x32_bf16 v[36:39], a[48:51], a[24:27], v[36:39]
  ds_read_b64_tr_b16 v[96:97], v44 offset:21504
  v_mfma_f32_16x16x32_bf16 v[8:11], a[52:55], a[4:7], v[8:11]
  ds_read_b64_tr_b16 v[98:99], v44 offset:22016
  v_mfma_f32_16x16x32_bf16 v[12:15], a[56:59], a[4:7], v[12:15]
  ds_read_b64_tr_b16 v[100:101], v45 offset:21504
  v_mfma_f32_16x16x32_bf16 v[16:19], a[52:55], a[12:15], v[16:19]
  ds_read_b64_tr_b16 v[102:103], v45 offset:22016
  v_mfma_f32_16x16x32_bf16 v[20:23], a[56:59], a[12:15], v[20:23]
  ds_read_b128 a[88:91], v41 offset:4352
  v_mfma_f32_16x16x32_bf16 v[24:27], a[52:55], a[20:23], v[24:27]
  ds_read_b128 a[96:99], v41 offset:13056
  v_mfma_f32_16x16x32_bf16 v[28:31], a[56:59], a[20:23], v[28:31]
  ds_read_b128 a[104:107], v41 offset:21760
  v_mfma_f32_16x16x32_bf16 v[32:35], a[52:55], a[28:31], v[32:35]
  ds_read_b128 a[112:115], v41 offset:30464
  v_mfma_f32_16x16x32_bf16 v[36:39], a[56:59], a[28:31], v[36:39]
  ds_read_b64_tr_b16 v[104:105], v44 offset:22528
  v_mfma_f32_16x16x32_bf16 v[8:11], a[60:63], a[8:11], v[8:11]
  ds_read_b64_tr_b16 v[106:107], v44 offset:23040
  v_mfma_f32_16x16x32_bf16 v[12:15], a[64:67], a[8:11], v[12:15]
  ds_read_b64_tr_b16 v[108:109], v45 offset:22528
  v_mfma_f32_16x16x32_bf16 v[16:19], a[60:63], a[16:19], v[16:19]
  ds_read_b64_tr_b16 v[110:111], v45 offset:23040
  v_mfma_f32_16x16x32_bf16 v[20:23], a[64:67], a[16:19], v[20:23]
  ds_read_b128 a[116:119], v43 offset:0
  v_mfma_f32_16x16x32_bf16 v[24:27], a[60:63], a[24:27], v[24:27]
  ds_read_b64_tr_b16 v[112:113], v44 offset:23552
  v_mfma_f32_16x16x32_bf16 v[28:31], a[64:67], a[24:27], v[28:31]
  ds_read_b64_tr_b16 v[114:115], v44 offset:24064
  v_mfma_f32_16x16x32_bf16 v[32:35], a[60:63], a[32:35], v[32:35]
  ds_read_b64_tr_b16 v[116:117], v45 offset:23552
  v_mfma_f32_16x16x32_bf16 v[36:39], a[64:67], a[32:35], v[36:39]
  s_lshr_b32 s24, s34, 7
  ds_read_b64_tr_b16 v[118:119], v45 offset:24064
  v_mfma_f32_16x16x32_bf16 v[8:11], a[68:71], a[12:15], v[8:11]
  s_sub_u32 s24, 3, s24
  ds_read_b128 a[120:123], v43 offset:4352
  v_mfma_f32_16x16x32_bf16 v[12:15], a[72:75], a[12:15], v[12:15]
  s_and_b32 s24, s24, 7
  ds_read_b64_tr_b16 v[120:121], v44 offset:24576
  v_mfma_f32_16x16x32_bf16 v[16:19], a[68:71], a[20:23], v[16:19]
  s_lshl_b32 s24, s24, 7
  ds_read_b64_tr_b16 v[122:123], v44 offset:25088
  v_mfma_f32_16x16x32_bf16 v[20:23], a[72:75], a[20:23], v[20:23]
  s_lshl_b32 s25, s5, 10
  ds_read_b64_tr_b16 v[124:125], v45 offset:24576
  v_mfma_f32_16x16x32_bf16 v[24:27], a[68:71], a[28:31], v[24:27]
  s_add_u32 s24, s24, s25
  ds_read_b64_tr_b16 v[126:127], v45 offset:25088
  v_mfma_f32_16x16x32_bf16 v[28:31], a[72:75], a[28:31], v[28:31]
  s_add_u32 s25, s60, s3
  ds_read_b128 a[124:127], v43 offset:8704
  v_mfma_f32_16x16x32_bf16 v[32:35], a[68:71], a[36:39], v[32:35]
  s_add_u32 s25, s25, 4
  v_mfma_f32_16x16x32_bf16 v[36:39], a[72:75], a[36:39], v[36:39]
  s_and_b32 s25, s25, 15
  v_mfma_f32_16x16x32_bf16 v[8:11], a[76:79], a[16:19], v[8:11]
  s_lshl_b32 s25, s25, 15
  v_mfma_f32_16x16x32_bf16 v[12:15], a[80:83], a[16:19], v[12:15]
  s_add_u32 s24, s24, s25
  v_mfma_f32_16x16x32_bf16 v[16:19], a[76:79], a[24:27], v[16:19]
  v_lshlrev_b32 v1, 19, v0
  v_mfma_f32_16x16x32_bf16 v[20:23], a[80:83], a[24:27], v[20:23]
  v_add_u32 v1, s24, v1
  v_mfma_f32_16x16x32_bf16 v[24:27], a[76:79], a[32:35], v[24:27]
  s_mov_b64 exec, 0x1f
  v_mfma_f32_16x16x32_bf16 v[28:31], a[80:83], a[32:35], v[28:31]
  global_load_dword v68, v1, s[34:35]
  v_mfma_f32_16x16x32_bf16 v[32:35], a[76:79], a[40:43], v[32:35]
  s_mov_b64 exec, -1
  v_mfma_f32_16x16x32_bf16 v[36:39], a[80:83], a[40:43], v[36:39]
  s_waitcnt lgkmcnt(0)
  s_barrier
  v_mfma_f32_16x16x32_bf16 v[8:11], v[88:91], a[84:87], v[8:11]
  ds_read_b64_tr_b16 a[44:45], v46 offset:0
  ds_read_b64_tr_b16 a[46:47], v46 offset:512
  v_mfma_f32_16x16x32_bf16 v[12:15], v[92:95], a[84:87], v[12:15]
  ds_read_b64_tr_b16 a[48:49], v47 offset:0
  v_mfma_f32_16x16x32_bf16 v[16:19], v[88:91], a[92:95], v[16:19]
  ds_read_b64_tr_b16 a[50:51], v47 offset:512
  v_mfma_f32_16x16x32_bf16 v[20:23], v[92:95], a[92:95], v[20:23]
  ds_read_b128 a[0:3], v40 offset:34816
  v_mfma_f32_16x16x32_bf16 v[24:27], v[88:91], a[100:103], v[24:27]
  ds_read_b128 a[8:11], v40 offset:43520
  v_mfma_f32_16x16x32_bf16 v[28:31], v[92:95], a[100:103], v[28:31]
  ds_read_b128 a[16:19], v40 offset:52224
  v_mfma_f32_16x16x32_bf16 v[32:35], v[88:91], a[108:111], v[32:35]
  ds_read_b128 a[24:27], v40 offset:60928
  v_mfma_f32_16x16x32_bf16 v[36:39], v[92:95], a[108:111], v[36:39]
  ds_read_b64_tr_b16 a[52:53], v46 offset:1024
  v_mfma_f32_16x16x32_bf16 v[8:11], v[96:99], a[88:91], v[8:11]
  ds_read_b64_tr_b16 a[54:55], v46 offset:1536
  v_mfma_f32_16x16x32_bf16 v[12:15], v[100:103], a[88:91], v[12:15]
  ds_read_b64_tr_b16 a[56:57], v47 offset:1024
  v_mfma_f32_16x16x32_bf16 v[16:19], v[96:99], a[96:99], v[16:19]
  ds_read_b64_tr_b16 a[58:59], v47 offset:1536
  v_mfma_f32_16x16x32_bf16 v[20:23], v[100:103], a[96:99], v[20:23]
  ds_read_b128 a[4:7], v40 offset:39168
  v_mfma_f32_16x16x32_bf16 v[24:27], v[96:99], a[104:107], v[24:27]
  ds_read_b128 a[12:15], v40 offset:47872
  v_mfma_f32_16x16x32_bf16 v[28:31], v[100:103], a[104:107], v[28:31]
  ds_read_b128 a[20:23], v40 offset:56576
  v_mfma_f32_16x16x32_bf16 v[32:35], v[96:99], a[112:115], v[32:35]
  ds_read_b128 a[28:31], v40 offset:65280
  v_mfma_f32_16x16x32_bf16 v[36:39], v[100:103], a[112:115], v[36:39]
  ds_read_b64_tr_b16 a[60:61], v46 offset:2048
  v_mfma_f32_16x16x32_bf16 v[8:11], v[104:107], a[92:95], v[8:11]
  ds_read_b64_tr_b16 a[62:63], v46 offset:2560
  v_mfma_f32_16x16x32_bf16 v[12:15], v[108:111], a[92:95], v[12:15]
  ds_read_b64_tr_b16 a[64:65], v47 offset:2048
  v_mfma_f32_16x16x32_bf16 v[16:19], v[104:107], a[100:103], v[16:19]
  ds_read_b64_tr_b16 a[66:67], v47 offset:2560
  v_mfma_f32_16x16x32_bf16 v[20:23], v[108:111], a[100:103], v[20:23]
  ds_read_b128 a[32:35], v42 offset:34816
  v_mfma_f32_16x16x32_bf16 v[24:27], v[104:107], a[108:111], v[24:27]
  ds_read_b64_tr_b16 a[68:69], v46 offset:3072
  v_mfma_f32_16x16x32_bf16 v[28:31], v[108:111], a[108:111], v[28:31]
  ds_read_b64_tr_b16 a[70:71], v46 offset:3584
  v_mfma_f32_16x16x32_bf16 v[32:35], v[104:107], a[116:119], v[32:35]
  ds_read_b64_tr_b16 a[72:73], v47 offset:3072
  v_mfma_f32_16x16x32_bf16 v[36:39], v[108:111], a[116:119], v[36:39]
  ds_read_b64_tr_b16 a[74:75], v47 offset:3584
  v_mfma_f32_16x16x32_bf16 v[8:11], v[112:115], a[96:99], v[8:11]
  ds_read_b128 a[36:39], v42 offset:39168
  v_mfma_f32_16x16x32_bf16 v[12:15], v[116:119], a[96:99], v[12:15]
  ds_read_b64_tr_b16 a[76:77], v46 offset:4096
  v_mfma_f32_16x16x32_bf16 v[16:19], v[112:115], a[104:107], v[16:19]
  ds_read_b64_tr_b16 a[78:79], v46 offset:4608
  v_mfma_f32_16x16x32_bf16 v[20:23], v[116:119], a[104:107], v[20:23]
  ds_read_b64_tr_b16 a[80:81], v47 offset:4096
  v_mfma_f32_16x16x32_bf16 v[24:27], v[112:115], a[112:115], v[24:27]
  ds_read_b64_tr_b16 a[82:83], v47 offset:4608
  v_mfma_f32_16x16x32_bf16 v[28:31], v[116:119], a[112:115], v[28:31]
  ds_read_b128 a[40:43], v42 offset:43520
  v_mfma_f32_16x16x32_bf16 v[32:35], v[112:115], a[120:123], v[32:35]
  v_mfma_f32_16x16x32_bf16 v[36:39], v[116:119], a[120:123], v[36:39]
  v_mfma_f32_16x16x32_bf16 v[8:11], v[120:123], a[100:103], v[8:11]
  v_mfma_f32_16x16x32_bf16 v[12:15], v[124:127], a[100:103], v[12:15]
  v_mfma_f32_16x16x32_bf16 v[16:19], v[120:123], a[108:111], v[16:19]
  v_mfma_f32_16x16x32_bf16 v[20:23], v[124:127], a[108:111], v[20:23]
  v_mfma_f32_16x16x32_bf16 v[24:27], v[120:123], a[116:119], v[24:27]
  v_mfma_f32_16x16x32_bf16 v[28:31], v[124:127], a[116:119], v[28:31]
  v_mfma_f32_16x16x32_bf16 v[32:35], v[120:123], a[124:127], v[32:35]
  v_mfma_f32_16x16x32_bf16 v[36:39], v[124:127], a[124:127], v[36:39]
  s_waitcnt lgkmcnt(0)
  s_barrier
  v_mfma_f32_16x16x32_bf16 v[8:11], a[44:47], a[0:3], v[8:11]
  ds_read_b64_tr_b16 v[88:89], v46 offset:20480
  ds_read_b64_tr_b16 v[90:91], v46 offset:20992
  v_mfma_f32_16x16x32_bf16 v[12:15], a[48:51], a[0:3], v[12:15]
  ds_read_b64_tr_b16 v[92:93], v47 offset:20480
  v_mfma_f32_16x16x32_bf16 v[16:19], a[44:47], a[8:11], v[16:19]
  ds_read_b64_tr_b16 v[94:95], v47 offset:20992
  v_mfma_f32_16x16x32_bf16 v[20:23], a[48:51], a[8:11], v[20:23]
  ds_read_b128 a[84:87], v41 offset:34816
  v_mfma_f32_16x16x32_bf16 v[24:27], a[44:47], a[16:19], v[24:27]
  ds_read_b128 a[92:95], v41 offset:43520
  v_mfma_f32_16x16x32_bf16 v[28:31], a[48:51], a[16:19], v[28:31]
  ds_read_b128 a[100:103], v41 offset:52224
  v_mfma_f32_16x16x32_bf16 v[32:35], a[44:47], a[24:27], v[32:35]
  ds_read_b128 a[108:111], v41 offset:60928
  v_mfma_f32_16x16x32_bf16 v[36:39], a[48:51], a[24:27], v[36:39]
  ds_read_b64_tr_b16 v[96:97], v46 offset:21504
  v_mfma_f32_16x16x32_bf16 v[8:11], a[52:55], a[4:7], v[8:11]
  ds_read_b64_tr_b16 v[98:99], v46 offset:22016
  v_mfma_f32_16x16x32_bf16 v[12:15], a[56:59], a[4:7], v[12:15]
  ds_read_b64_tr_b16 v[100:101], v47 offset:21504
  v_mfma_f32_16x16x32_bf16 v[16:19], a[52:55], a[12:15], v[16:19]
  ds_read_b64_tr_b16 v[102:103], v47 offset:22016
  v_mfma_f32_16x16x32_bf16 v[20:23], a[56:59], a[12:15], v[20:23]
  ds_read_b128 a[88:91], v41 offset:39168
  v_mfma_f32_16x16x32_bf16 v[24:27], a[52:55], a[20:23], v[24:27]
  ds_read_b128 a[96:99], v41 offset:47872
  v_mfma_f32_16x16x32_bf16 v[28:31], a[56:59], a[20:23], v[28:31]
  ds_read_b128 a[104:107], v41 offset:56576
  v_mfma_f32_16x16x32_bf16 v[32:35], a[52:55], a[28:31], v[32:35]
  ds_read_b128 a[112:115], v41 offset:65280
  v_mfma_f32_16x16x32_bf16 v[36:39], a[56:59], a[28:31], v[36:39]
  ds_read_b64_tr_b16 v[104:105], v46 offset:22528
  v_mfma_f32_16x16x32_bf16 v[8:11], a[60:63], a[8:11], v[8:11]
  ds_read_b64_tr_b16 v[106:107], v46 offset:23040
  v_mfma_f32_16x16x32_bf16 v[12:15], a[64:67], a[8:11], v[12:15]
  ds_read_b64_tr_b16 v[108:109], v47 offset:22528
  v_mfma_f32_16x16x32_bf16 v[16:19], a[60:63], a[16:19], v[16:19]
  ds_read_b64_tr_b16 v[110:111], v47 offset:23040
  v_mfma_f32_16x16x32_bf16 v[20:23], a[64:67], a[16:19], v[20:23]
  s_lshr_b32 s26, s60, 1
  ds_read_b128 a[116:119], v43 offset:34816
  v_mfma_f32_16x16x32_bf16 v[24:27], a[60:63], a[24:27], v[24:27]
  s_add_u32 s26, s26, 4
  ds_read_b64_tr_b16 v[112:113], v46 offset:23552
  v_mfma_f32_16x16x32_bf16 v[28:31], a[64:67], a[24:27], v[28:31]
  s_and_b32 s26, s26, 7
  ds_read_b64_tr_b16 v[114:115], v46 offset:24064
  v_mfma_f32_16x16x32_bf16 v[32:35], a[60:63], a[32:35], v[32:35]
  s_lshl_b32 s26, s26, 7
  ds_read_b64_tr_b16 v[116:117], v47 offset:23552
  v_mfma_f32_16x16x32_bf16 v[36:39], a[64:67], a[32:35], v[36:39]
  s_mul_i32 s27, s6, 4096000
  ds_read_b64_tr_b16 v[118:119], v47 offset:24064
  v_mfma_f32_16x16x32_bf16 v[8:11], a[68:71], a[12:15], v[8:11]
  s_add_u32 s26, s26, s27
  ds_read_b128 a[120:123], v43 offset:39168
  v_mfma_f32_16x16x32_bf16 v[12:15], a[72:75], a[12:15], v[12:15]
  s_lshl_b32 s24, s5, 5
  ds_read_b64_tr_b16 v[120:121], v46 offset:24576
  v_mfma_f32_16x16x32_bf16 v[16:19], a[68:71], a[20:23], v[16:19]
  s_mul_i32 s27, s7, 1000
  ds_read_b64_tr_b16 v[122:123], v46 offset:25088
  v_mfma_f32_16x16x32_bf16 v[20:23], a[72:75], a[20:23], v[20:23]
  s_add_u32 s24, s24, s27
  ds_read_b64_tr_b16 v[124:125], v47 offset:24576
  v_mfma_f32_16x16x32_bf16 v[24:27], a[68:71], a[28:31], v[24:27]
  s_lshl_b32 s27, s3, 3
  ds_read_b64_tr_b16 v[126:127], v47 offset:25088
  v_mfma_f32_16x16x32_bf16 v[28:31], a[72:75], a[28:31], v[28:31]
  s_add_u32 s24, s24, s27
  ds_read_b128 a[124:127], v43 offset:43520
  v_mfma_f32_16x16x32_bf16 v[32:35], a[68:71], a[36:39], v[32:35]
  s_sub_u32 s24, s24, 6
  v_mfma_f32_16x16x32_bf16 v[36:39], a[72:75], a[36:39], v[36:39]
  v_add_u32 v1, s24, v0
  v_mfma_f32_16x16x32_bf16 v[8:11], a[76:79], a[16:19], v[8:11]
  v_max_i32 v1, 0, v1
  v_mfma_f32_16x16x32_bf16 v[12:15], a[80:83], a[16:19], v[12:15]
  v_min_i32 v1, 3999, v1
  v_mfma_f32_16x16x32_bf16 v[16:19], a[76:79], a[24:27], v[16:19]
  v_lshlrev_b32 v1, 10, v1
  v_mfma_f32_16x16x32_bf16 v[20:23], a[80:83], a[24:27], v[20:23]
  v_add_u32 v1, s26, v1
  v_mfma_f32_16x16x32_bf16 v[24:27], a[76:79], a[32:35], v[24:27]
  s_mov_b64 exec, 0xff
  v_mfma_f32_16x16x32_bf16 v[28:31], a[80:83], a[32:35], v[28:31]
  global_load_dword v67, v1, s[32:33]
  v_mfma_f32_16x16x32_bf16 v[32:35], a[76:79], a[40:43], v[32:35]
  s_mov_b64 exec, -1
  v_mfma_f32_16x16x32_bf16 v[36:39], a[80:83], a[40:43], v[36:39]
  s_waitcnt lgkmcnt(0)
  s_barrier
  v_mfma_f32_16x16x32_bf16 v[8:11], v[88:91], a[84:87], v[8:11]
  ds_read_b64_tr_b16 a[44:45], v44 offset:0
  ds_read_b64_tr_b16 a[46:47], v44 offset:512
  v_mfma_f32_16x16x32_bf16 v[12:15], v[92:95], a[84:87], v[12:15]
  ds_read_b64_tr_b16 a[48:49], v45 offset:0
  v_mfma_f32_16x16x32_bf16 v[16:19], v[88:91], a[92:95], v[16:19]
  ds_read_b64_tr_b16 a[50:51], v45 offset:512
  v_mfma_f32_16x16x32_bf16 v[20:23], v[92:95], a[92:95], v[20:23]
  ds_read_b128 a[0:3], v40 offset:0
  v_mfma_f32_16x16x32_bf16 v[24:27], v[88:91], a[100:103], v[24:27]
  ds_read_b128 a[8:11], v40 offset:8704
  v_mfma_f32_16x16x32_bf16 v[28:31], v[92:95], a[100:103], v[28:31]
  ds_read_b128 a[16:19], v40 offset:17408
  v_mfma_f32_16x16x32_bf16 v[32:35], v[88:91], a[108:111], v[32:35]
  ds_read_b128 a[24:27], v40 offset:26112
  v_mfma_f32_16x16x32_bf16 v[36:39], v[92:95], a[108:111], v[36:39]
  ds_read_b64_tr_b16 a[52:53], v44 offset:1024
  v_mfma_f32_16x16x32_bf16 v[8:11], v[96:99], a[88:91], v[8:11]
  ds_read_b64_tr_b16 a[54:55], v44 offset:1536
  v_mfma_f32_16x16x32_bf16 v[12:15], v[100:103], a[88:91], v[12:15]
  ds_read_b64_tr_b16 a[56:57], v45 offset:1024
  v_mfma_f32_16x16x32_bf16 v[16:19], v[96:99], a[96:99], v[16:19]
  ds_read_b64_tr_b16 a[58:59], v45 offset:1536
  v_mfma_f32_16x16x32_bf16 v[20:23], v[100:103], a[96:99], v[20:23]
  ds_read_b128 a[4:7], v40 offset:4352
  v_mfma_f32_16x16x32_bf16 v[24:27], v[96:99], a[104:107], v[24:27]
  ds_read_b128 a[12:15], v40 offset:13056
  v_mfma_f32_16x16x32_bf16 v[28:31], v[100:103], a[104:107], v[28:31]
  ds_read_b128 a[20:23], v40 offset:21760
  v_mfma_f32_16x16x32_bf16 v[32:35], v[96:99], a[112:115], v[32:35]
  ds_read_b128 a[28:31], v40 offset:30464
  v_mfma_f32_16x16x32_bf16 v[36:39], v[100:103], a[112:115], v[36:39]
  ds_read_b64_tr_b16 a[60:61], v44 offset:2048
  v_mfma_f32_16x16x32_bf16 v[8:11], v[104:107], a[92:95], v[8:11]
  ds_read_b64_tr_b16 a[62:63], v44 offset:2560
  v_mfma_f32_16x16x32_bf16 v[12:15], v[108:111], a[92:95], v[12:15]
  ds_read_b64_tr_b16 a[64:65], v45 offset:2048
  v_mfma_f32_16x16x32_bf16 v[16:19], v[104:107], a[100:103], v[16:19]
  ds_read_b64_tr_b16 a[66:67], v45 offset:2560
  v_mfma_f32_16x16x32_bf16 v[20:23], v[108:111], a[100:103], v[20:23]
  ds_read_b128 a[32:35], v42 offset:0
  v_mfma_f32_16x16x32_bf16 v[24:27], v[104:107], a[108:111], v[24:27]
  ds_read_b64_tr_b16 a[68:69], v44 offset:3072
  v_mfma_f32_16x16x32_bf16 v[28:31], v[108:111], a[108:111], v[28:31]
  ds_read_b64_tr_b16 a[70:71], v44 offset:3584
  v_mfma_f32_16x16x32_bf16 v[32:35], v[104:107], a[116:119], v[32:35]
  ds_read_b64_tr_b16 a[72:73], v45 offset:3072
  v_mfma_f32_16x16x32_bf16 v[36:39], v[108:111], a[116:119], v[36:39]
  s_lshr_b32 s24, s34, 7
  ds_read_b64_tr_b16 a[74:75], v45 offset:3584
  v_mfma_f32_16x16x32_bf16 v[8:11], v[112:115], a[96:99], v[8:11]
  s_sub_u32 s24, 3, s24
  ds_read_b128 a[36:39], v42 offset:4352
  v_mfma_f32_16x16x32_bf16 v[12:15], v[116:119], a[96:99], v[12:15]
  s_and_b32 s24, s24, 7
  ds_read_b64_tr_b16 a[76:77], v44 offset:4096
  v_mfma_f32_16x16x32_bf16 v[16:19], v[112:115], a[104:107], v[16:19]
  s_lshl_b32 s24, s24, 7
  ds_read_b64_tr_b16 a[78:79], v44 offset:4608
  v_mfma_f32_16x16x32_bf16 v[20:23], v[116:119], a[104:107], v[20:23]
  s_lshl_b32 s25, s5, 10
  ds_read_b64_tr_b16 a[80:81], v45 offset:4096
  v_mfma_f32_16x16x32_bf16 v[24:27], v[112:115], a[112:115], v[24:27]
  s_add_u32 s24, s24, s25
  ds_read_b64_tr_b16 a[82:83], v45 offset:4608
  v_mfma_f32_16x16x32_bf16 v[28:31], v[116:119], a[112:115], v[28:31]
  s_add_u32 s25, s60, s3
  ds_read_b128 a[40:43], v42 offset:8704
  v_mfma_f32_16x16x32_bf16 v[32:35], v[112:115], a[120:123], v[32:35]
  s_add_u32 s25, s25, 8
  v_mfma_f32_16x16x32_bf16 v[36:39], v[116:119], a[120:123], v[36:39]
  s_and_b32 s25, s25, 15
  v_mfma_f32_16x16x32_bf16 v[8:11], v[120:123], a[100:103], v[8:11]
  s_lshl_b32 s25, s25, 15
  v_mfma_f32_16x16x32_bf16 v[12:15], v[124:127], a[100:103], v[12:15]
  s_add_u32 s24, s24, s25
  v_mfma_f32_16x16x32_bf16 v[16:19], v[120:123], a[108:111], v[16:19]
  v_lshlrev_b32 v1, 19, v0
  v_mfma_f32_16x16x32_bf16 v[20:23], v[124:127], a[108:111], v[20:23]
  v_add_u32 v1, s24, v1
  v_mfma_f32_16x16x32_bf16 v[24:27], v[120:123], a[116:119], v[24:27]
  s_mov_b64 exec, 0x1f
  v_mfma_f32_16x16x32_bf16 v[28:31], v[124:127], a[116:119], v[28:31]
  global_load_dword v68, v1, s[34:35]
  v_mfma_f32_16x16x32_bf16 v[32:35], v[120:123], a[124:127], v[32:35]
  s_mov_b64 exec, -1
  v_mfma_f32_16x16x32_bf16 v[36:39], v[124:127], a[124:127], v[36:39]
  s_waitcnt lgkmcnt(0)
  s_barrier
  v_mfma_f32_16x16x32_bf16 v[8:11], a[44:47], a[0:3], v[8:11]
  ds_read_b64_tr_b16 v[88:89], v44 offset:20480
  ds_read_b64_tr_b16 v[90:91], v44 offset:20992
  v_mfma_f32_16x16x32_bf16 v[12:15], a[48:51], a[0:3], v[12:15]
  ds_read_b64_tr_b16 v[92:93], v45 offset:20480
  v_mfma_f32_16x16x32_bf16 v[16:19], a[44:47], a[8:11], v[16:19]
  ds_read_b64_tr_b16 v[94:95], v45 offset:20992
  v_mfma_f32_16x16x32_bf16 v[20:23], a[48:51], a[8:11], v[20:23]
  ds_read_b128 a[84:87], v41 offset:0
  v_mfma_f32_16x16x32_bf16 v[24:27], a[44:47], a[16:19], v[24:27]
  ds_read_b128 a[92:95], v41 offset:8704
  v_mfma_f32_16x16x32_bf16 v[28:31], a[48:51], a[16:19], v[28:31]
  ds_read_b128 a[100:103], v41 offset:17408
  v_mfma_f32_16x16x32_bf16 v[32:35], a[44:47], a[24:27], v[32:35]
  ds_read_b128 a[108:111], v41 offset:26112
  v_mfma_f32_16x16x32_bf16 v[36:39], a[48:51], a[24:27], v[36:39]
  ds_read_b64_tr_b16 v[96:97], v44 offset:21504
  v_mfma_f32_16x16x32_bf16 v[8:11], a[52:55], a[4:7], v[8:11]
  ds_read_b64_tr_b16 v[98:99], v44 offset:22016
  v_mfma_f32_16x16x32_bf16 v[12:15], a[56:59], a[4:7], v[12:15]
  ds_read_b64_tr_b16 v[100:101], v45 offset:21504
  v_mfma_f32_16x16x32_bf16 v[16:19], a[52:55], a[12:15], v[16:19]
  ds_read_b64_tr_b16 v[102:103], v45 offset:22016
  v_mfma_f32_16x16x32_bf16 v[20:23], a[56:59], a[12:15], v[20:23]
  ds_read_b128 a[88:91], v41 offset:4352
  v_mfma_f32_16x16x32_bf16 v[24:27], a[52:55], a[20:23], v[24:27]
  ds_read_b128 a[96:99], v41 offset:13056
  v_mfma_f32_16x16x32_bf16 v[28:31], a[56:59], a[20:23], v[28:31]
  ds_read_b128 a[104:107], v41 offset:21760
  v_mfma_f32_16x16x32_bf16 v[32:35], a[52:55], a[28:31], v[32:35]
  ds_read_b128 a[112:115], v41 offset:30464
  v_mfma_f32_16x16x32_bf16 v[36:39], a[56:59], a[28:31], v[36:39]
  ds_read_b64_tr_b16 v[104:105], v44 offset:22528
  v_mfma_f32_16x16x32_bf16 v[8:11], a[60:63], a[8:11], v[8:11]
  ds_read_b64_tr_b16 v[106:107], v44 offset:23040
  v_mfma_f32_16x16x32_bf16 v[12:15], a[64:67], a[8:11], v[12:15]
  ds_read_b64_tr_b16 v[108:109], v45 offset:22528
  v_mfma_f32_16x16x32_bf16 v[16:19], a[60:63], a[16:19], v[16:19]
  ds_read_b64_tr_b16 v[110:111], v45 offset:23040
  v_mfma_f32_16x16x32_bf16 v[20:23], a[64:67], a[16:19], v[20:23]
  s_lshr_b32 s26, s60, 1
  ds_read_b128 a[116:119], v43 offset:0
  v_mfma_f32_16x16x32_bf16 v[24:27], a[60:63], a[24:27], v[24:27]
  s_add_u32 s26, s26, 5
  ds_read_b64_tr_b16 v[112:113], v44 offset:23552
  v_mfma_f32_16x16x32_bf16 v[28:31], a[64:67], a[24:27], v[28:31]
  s_and_b32 s26, s26, 7
  ds_read_b64_tr_b16 v[114:115], v44 offset:24064
  v_mfma_f32_16x16x32_bf16 v[32:35], a[60:63], a[32:35], v[32:35]
  s_lshl_b32 s26, s26, 7
  ds_read_b64_tr_b16 v[116:117], v45 offset:23552
  v_mfma_f32_16x16x32_bf16 v[36:39], a[64:67], a[32:35], v[36:39]
  s_mul_i32 s27, s6, 4096000
  ds_read_b64_tr_b16 v[118:119], v45 offset:24064
  v_mfma_f32_16x16x32_bf16 v[8:11], a[68:71], a[12:15], v[8:11]
  s_add_u32 s26, s26, s27
  ds_read_b128 a[120:123], v43 offset:4352
  v_mfma_f32_16x16x32_bf16 v[12:15], a[72:75], a[12:15], v[12:15]
  s_lshl_b32 s24, s5, 5
  ds_read_b64_tr_b16 v[120:121], v44 offset:24576
  v_mfma_f32_16x16x32_bf16 v[16:19], a[68:71], a[20:23], v[16:19]
  s_mul_i32 s27, s7, 1000
  ds_read_b64_tr_b16 v[122:123], v44 offset:25088
  v_mfma_f32_16x16x32_bf16 v[20:23], a[72:75], a[20:23], v[20:23]
  s_add_u32 s24, s24, s27
  ds_read_b64_tr_b16 v[124:125], v45 offset:24576
  v_mfma_f32_16x16x32_bf16 v[24:27], a[68:71], a[28:31], v[24:27]
  s_lshl_b32 s27, s3, 3
  ds_read_b64_tr_b16 v[126:127], v45 offset:25088
  v_mfma_f32_16x16x32_bf16 v[28:31], a[72:75], a[28:31], v[28:31]
  s_add_u32 s24, s24, s27
  ds_read_b128 a[124:127], v43 offset:8704
  v_mfma_f32_16x16x32_bf16 v[32:35], a[68:71], a[36:39], v[32:35]
  s_sub_u32 s24, s24, 6
  v_mfma_f32_16x16x32_bf16 v[36:39], a[72:75], a[36:39], v[36:39]
  v_add_u32 v1, s24, v0
  v_mfma_f32_16x16x32_bf16 v[8:11], a[76:79], a[16:19], v[8:11]
  v_max_i32 v1, 0, v1
  v_mfma_f32_16x16x32_bf16 v[12:15], a[80:83], a[16:19], v[12:15]
  v_min_i32 v1, 3999, v1
  v_mfma_f32_16x16x32_bf16 v[16:19], a[76:79], a[24:27], v[16:19]
  v_lshlrev_b32 v1, 10, v1
  v_mfma_f32_16x16x32_bf16 v[20:23], a[80:83], a[24:27], v[20:23]
  v_add_u32 v1, s26, v1
  v_mfma_f32_16x16x32_bf16 v[24:27], a[76:79], a[32:35], v[24:27]
  s_mov_b64 exec, 0xff
  v_mfma_f32_16x16x32_bf16 v[28:31], a[80:83], a[32:35], v[28:31]
  global_load_dword v67, v1, s[32:33]
  v_mfma_f32_16x16x32_bf16 v[32:35], a[76:79], a[40:43], v[32:35]
  s_mov_b64 exec, -1
  v_mfma_f32_16x16x32_bf16 v[36:39], a[80:83], a[40:43], v[36:39]
  s_waitcnt lgkmcnt(0)
  s_barrier
  v_mfma_f32_16x16x32_bf16 v[8:11], v[88:91], a[84:87], v[8:11]
  ds_read_b64_tr_b16 a[44:45], v46 offset:0
  ds_read_b64_tr_b16 a[46:47], v46 offset:512
  v_mfma_f32_16x16x32_bf16 v[12:15], v[92:95], a[84:87], v[12:15]
  ds_read_b64_tr_b16 a[48:49], v47 offset:0
  v_mfma_f32_16x16x32_bf16 v[16:19], v[88:91], a[92:95], v[16:19]
  ds_read_b64_tr_b16 a[50:51], v47 offset:512
  v_mfma_f32_16x16x32_bf16 v[20:23], v[92:95], a[92:95], v[20:23]
  ds_read_b128 a[0:3], v40 offset:34816
  v_mfma_f32_16x16x32_bf16 v[24:27], v[88:91], a[100:103], v[24:27]
  ds_read_b128 a[8:11], v40 offset:43520
  v_mfma_f32_16x16x32_bf16 v[28:31], v[92:95], a[100:103], v[28:31]
  ds_read_b128 a[16:19], v40 offset:52224
  v_mfma_f32_16x16x32_bf16 v[32:35], v[88:91], a[108:111], v[32:35]
  ds_read_b128 a[24:27], v40 offset:60928
  v_mfma_f32_16x16x32_bf16 v[36:39], v[92:95], a[108:111], v[36:39]
  ds_read_b64_tr_b16 a[52:53], v46 offset:1024
  v_mfma_f32_16x16x32_bf16 v[8:11], v[96:99], a[88:91], v[8:11]
  ds_read_b64_tr_b16 a[54:55], v46 offset:1536
  v_mfma_f32_16x16x32_bf16 v[12:15], v[100:103], a[88:91], v[12:15]
  ds_read_b64_tr_b16 a[56:57], v47 offset:1024
  v_mfma_f32_16x16x32_bf16 v[16:19], v[96:99], a[96:99], v[16:19]
  ds_read_b64_tr_b16 a[58:59], v47 offset:1536
  v_mfma_f32_16x16x32_bf16 v[20:23], v[100:103], a[96:99], v[20:23]
  ds_read_b128 a[4:7], v40 offset:39168
  v_mfma_f32_16x16x32_bf16 v[24:27], v[96:99], a[104:107], v[24:27]
  ds_read_b128 a[12:15], v40 offset:47872
  v_mfma_f32_16x16x32_bf16 v[28:31], v[100:103], a[104:107], v[28:31]
  ds_read_b128 a[20:23], v40 offset:56576
  v_mfma_f32_16x16x32_bf16 v[32:35], v[96:99], a[112:115], v[32:35]
  ds_read_b128 a[28:31], v40 offset:65280
  v_mfma_f32_16x16x32_bf16 v[36:39], v[100:103], a[112:115], v[36:39]
  ds_read_b64_tr_b16 a[60:61], v46 offset:2048
  v_mfma_f32_16x16x32_bf16 v[8:11], v[104:107], a[92:95], v[8:11]
  ds_read_b64_tr_b16 a[62:63], v46 offset:2560
  v_mfma_f32_16x16x32_bf16 v[12:15], v[108:111], a[92:95], v[12:15]
  ds_read_b64_tr_b16 a[64:65], v47 offset:2048
  v_mfma_f32_16x16x32_bf16 v[16:19], v[104:107], a[100:103], v[16:19]
  ds_read_b64_tr_b16 a[66:67], v47 offset:2560
  v_mfma_f32_16x16x32_bf16 v[20:23], v[108:111], a[100:103], v[20:23]
  ds_read_b128 a[32:35], v42 offset:34816
  v_mfma_f32_16x16x32_bf16 v[24:27], v[104:107], a[108:111], v[24:27]
  ds_read_b64_tr_b16 a[68:69], v46 offset:3072
  v_mfma_f32_16x16x32_bf16 v[28:31], v[108:111], a[108:111], v[28:31]
  ds_read_b64_tr_b16 a[70:71], v46 offset:3584
  v_mfma_f32_16x16x32_bf16 v[32:35], v[104:107], a[116:119], v[32:35]
  ds_read_b64_tr_b16 a[72:73], v47 offset:3072
  v_mfma_f32_16x16x32_bf16 v[36:39], v[108:111], a[116:119], v[36:39]
  ds_read_b64_tr_b16 a[74:75], v47 offset:3584
  v_mfma_f32_16x16x32_bf16 v[8:11], v[112:115], a[96:99], v[8:11]
  ds_read_b128 a[36:39], v42 offset:39168
  v_mfma_f32_16x16x32_bf16 v[12:15], v[116:119], a[96:99], v[12:15]
  ds_read_b64_tr_b16 a[76:77], v46 offset:4096
  v_mfma_f32_16x16x32_bf16 v[16:19], v[112:115], a[104:107], v[16:19]
  ds_read_b64_tr_b16 a[78:79], v46 offset:4608
  v_mfma_f32_16x16x32_bf16 v[20:23], v[116:119], a[104:107], v[20:23]
  ds_read_b64_tr_b16 a[80:81], v47 offset:4096
  v_mfma_f32_16x16x32_bf16 v[24:27], v[112:115], a[112:115], v[24:27]
  ds_read_b64_tr_b16 a[82:83], v47 offset:4608
  v_mfma_f32_16x16x32_bf16 v[28:31], v[116:119], a[112:115], v[28:31]
  ds_read_b128 a[40:43], v42 offset:43520
  v_mfma_f32_16x16x32_bf16 v[32:35], v[112:115], a[120:123], v[32:35]
  v_mfma_f32_16x16x32_bf16 v[36:39], v[116:119], a[120:123], v[36:39]
  v_mfma_f32_16x16x32_bf16 v[8:11], v[120:123], a[100:103], v[8:11]
  v_mfma_f32_16x16x32_bf16 v[12:15], v[124:127], a[100:103], v[12:15]
  v_mfma_f32_16x16x32_bf16 v[16:19], v[120:123], a[108:111], v[16:19]
  v_mfma_f32_16x16x32_bf16 v[20:23], v[124:127], a[108:111], v[20:23]
  v_mfma_f32_16x16x32_bf16 v[24:27], v[120:123], a[116:119], v[24:27]
  v_mfma_f32_16x16x32_bf16 v[28:31], v[124:127], a[116:119], v[28:31]
  v_mfma_f32_16x16x32_bf16 v[32:35], v[120:123], a[124:127], v[32:35]
  global_load_dwordx2 v[64:65], v66, s[48:49] sc1
  v_mfma_f32_16x16x32_bf16 v[36:39], v[124:127], a[124:127], v[36:39]
  s_waitcnt lgkmcnt(0)
  s_barrier
  v_mfma_f32_16x16x32_bf16 v[8:11], a[44:47], a[0:3], v[8:11]
  ds_read_b64_tr_b16 v[88:89], v46 offset:20480
  ds_read_b64_tr_b16 v[90:91], v46 offset:20992
  v_mfma_f32_16x16x32_bf16 v[12:15], a[48:51], a[0:3], v[12:15]
  ds_read_b64_tr_b16 v[92:93], v47 offset:20480
  v_mfma_f32_16x16x32_bf16 v[16:19], a[44:47], a[8:11], v[16:19]
  ds_read_b64_tr_b16 v[94:95], v47 offset:20992
  v_mfma_f32_16x16x32_bf16 v[20:23], a[48:51], a[8:11], v[20:23]
  ds_read_b128 a[84:87], v41 offset:34816
  v_mfma_f32_16x16x32_bf16 v[24:27], a[44:47], a[16:19], v[24:27]
  ds_read_b128 a[92:95], v41 offset:43520
  v_mfma_f32_16x16x32_bf16 v[28:31], a[48:51], a[16:19], v[28:31]
  ds_read_b128 a[100:103], v41 offset:52224
  v_mfma_f32_16x16x32_bf16 v[32:35], a[44:47], a[24:27], v[32:35]
  ds_read_b128 a[108:111], v41 offset:60928
  v_mfma_f32_16x16x32_bf16 v[36:39], a[48:51], a[24:27], v[36:39]
  ds_read_b64_tr_b16 v[96:97], v46 offset:21504
  v_mfma_f32_16x16x32_bf16 v[8:11], a[52:55], a[4:7], v[8:11]
  ds_read_b64_tr_b16 v[98:99], v46 offset:22016
  v_mfma_f32_16x16x32_bf16 v[12:15], a[56:59], a[4:7], v[12:15]
  ds_read_b64_tr_b16 v[100:101], v47 offset:21504
  v_mfma_f32_16x16x32_bf16 v[16:19], a[52:55], a[12:15], v[16:19]
  ds_read_b64_tr_b16 v[102:103], v47 offset:22016
  v_mfma_f32_16x16x32_bf16 v[20:23], a[56:59], a[12:15], v[20:23]
  ds_read_b128 a[88:91], v41 offset:39168
  v_mfma_f32_16x16x32_bf16 v[24:27], a[52:55], a[20:23], v[24:27]
  ds_read_b128 a[96:99], v41 offset:47872
  v_mfma_f32_16x16x32_bf16 v[28:31], a[56:59], a[20:23], v[28:31]
  ds_read_b128 a[104:107], v41 offset:56576
  v_mfma_f32_16x16x32_bf16 v[32:35], a[52:55], a[28:31], v[32:35]
  ds_read_b128 a[112:115], v41 offset:65280
  v_mfma_f32_16x16x32_bf16 v[36:39], a[56:59], a[28:31], v[36:39]
  ds_read_b64_tr_b16 v[104:105], v46 offset:22528
  v_mfma_f32_16x16x32_bf16 v[8:11], a[60:63], a[8:11], v[8:11]
  ds_read_b64_tr_b16 v[106:107], v46 offset:23040
  v_mfma_f32_16x16x32_bf16 v[12:15], a[64:67], a[8:11], v[12:15]
  ds_read_b64_tr_b16 v[108:109], v47 offset:22528
  v_mfma_f32_16x16x32_bf16 v[16:19], a[60:63], a[16:19], v[16:19]
  ds_read_b64_tr_b16 v[110:111], v47 offset:23040
  v_mfma_f32_16x16x32_bf16 v[20:23], a[64:67], a[16:19], v[20:23]
  s_lshr_b32 s26, s60, 1
  ds_read_b128 a[116:119], v43 offset:34816
  v_mfma_f32_16x16x32_bf16 v[24:27], a[60:63], a[24:27], v[24:27]
  s_add_u32 s26, s26, 6
  ds_read_b64_tr_b16 v[112:113], v46 offset:23552
  v_mfma_f32_16x16x32_bf16 v[28:31], a[64:67], a[24:27], v[28:31]
  s_and_b32 s26, s26, 7
  ds_read_b64_tr_b16 v[114:115], v46 offset:24064
  v_mfma_f32_16x16x32_bf16 v[32:35], a[60:63], a[32:35], v[32:35]
  s_lshl_b32 s26, s26, 7
  ds_read_b64_tr_b16 v[116:117], v47 offset:23552
  v_mfma_f32_16x16x32_bf16 v[36:39], a[64:67], a[32:35], v[36:39]
  s_mul_i32 s27, s6, 4096000
  ds_read_b64_tr_b16 v[118:119], v47 offset:24064
  v_mfma_f32_16x16x32_bf16 v[8:11], a[68:71], a[12:15], v[8:11]
  s_add_u32 s26, s26, s27
  ds_read_b128 a[120:123], v43 offset:39168
  v_mfma_f32_16x16x32_bf16 v[12:15], a[72:75], a[12:15], v[12:15]
  s_lshl_b32 s24, s5, 5
  ds_read_b64_tr_b16 v[120:121], v46 offset:24576
  v_mfma_f32_16x16x32_bf16 v[16:19], a[68:71], a[20:23], v[16:19]
  s_mul_i32 s27, s7, 1000
  ds_read_b64_tr_b16 v[122:123], v46 offset:25088
  v_mfma_f32_16x16x32_bf16 v[20:23], a[72:75], a[20:23], v[20:23]
  s_add_u32 s24, s24, s27
  ds_read_b64_tr_b16 v[124:125], v47 offset:24576
  v_mfma_f32_16x16x32_bf16 v[24:27], a[68:71], a[28:31], v[24:27]
  s_lshl_b32 s27, s3, 3
  ds_read_b64_tr_b16 v[126:127], v47 offset:25088
  v_mfma_f32_16x16x32_bf16 v[28:31], a[72:75], a[28:31], v[28:31]
  s_add_u32 s24, s24, s27
  ds_read_b128 a[124:127], v43 offset:43520
  v_mfma_f32_16x16x32_bf16 v[32:35], a[68:71], a[36:39], v[32:35]
  s_sub_u32 s24, s24, 6
  v_mfma_f32_16x16x32_bf16 v[36:39], a[72:75], a[36:39], v[36:39]
  v_add_u32 v1, s24, v0
  v_mfma_f32_16x16x32_bf16 v[8:11], a[76:79], a[16:19], v[8:11]
  v_max_i32 v1, 0, v1
  v_mfma_f32_16x16x32_bf16 v[12:15], a[80:83], a[16:19], v[12:15]
  v_min_i32 v1, 3999, v1
  v_mfma_f32_16x16x32_bf16 v[16:19], a[76:79], a[24:27], v[16:19]
  v_lshlrev_b32 v1, 10, v1
  v_mfma_f32_16x16x32_bf16 v[20:23], a[80:83], a[24:27], v[20:23]
  v_add_u32 v1, s26, v1
  v_mfma_f32_16x16x32_bf16 v[24:27], a[76:79], a[32:35], v[24:27]
  s_mov_b64 exec, 0xff
  v_mfma_f32_16x16x32_bf16 v[28:31], a[80:83], a[32:35], v[28:31]
  global_load_dword v67, v1, s[32:33]
  v_mfma_f32_16x16x32_bf16 v[32:35], a[76:79], a[40:43], v[32:35]
  s_mov_b64 exec, -1
  v_mfma_f32_16x16x32_bf16 v[36:39], a[80:83], a[40:43], v[36:39]
  s_waitcnt lgkmcnt(0)
  s_barrier
  v_mfma_f32_16x16x32_bf16 v[8:11], v[88:91], a[84:87], v[8:11]
  ds_read_b64_tr_b16 a[44:45], v44 offset:0
  ds_read_b64_tr_b16 a[46:47], v44 offset:512
  v_mfma_f32_16x16x32_bf16 v[12:15], v[92:95], a[84:87], v[12:15]
  ds_read_b64_tr_b16 a[48:49], v45 offset:0
  v_mfma_f32_16x16x32_bf16 v[16:19], v[88:91], a[92:95], v[16:19]
  ds_read_b64_tr_b16 a[50:51], v45 offset:512
  v_mfma_f32_16x16x32_bf16 v[20:23], v[92:95], a[92:95], v[20:23]
  ds_read_b128 a[0:3], v40 offset:0
  v_mfma_f32_16x16x32_bf16 v[24:27], v[88:91], a[100:103], v[24:27]
  ds_read_b128 a[8:11], v40 offset:8704
  v_mfma_f32_16x16x32_bf16 v[28:31], v[92:95], a[100:103], v[28:31]
  ds_read_b128 a[16:19], v40 offset:17408
  v_mfma_f32_16x16x32_bf16 v[32:35], v[88:91], a[108:111], v[32:35]
  ds_read_b128 a[24:27], v40 offset:26112
  v_mfma_f32_16x16x32_bf16 v[36:39], v[92:95], a[108:111], v[36:39]
  ds_read_b64_tr_b16 a[52:53], v44 offset:1024
  v_mfma_f32_16x16x32_bf16 v[8:11], v[96:99], a[88:91], v[8:11]
  ds_read_b64_tr_b16 a[54:55], v44 offset:1536
  v_mfma_f32_16x16x32_bf16 v[12:15], v[100:103], a[88:91], v[12:15]
  ds_read_b64_tr_b16 a[56:57], v45 offset:1024
  v_mfma_f32_16x16x32_bf16 v[16:19], v[96:99], a[96:99], v[16:19]
  ds_read_b64_tr_b16 a[58:59], v45 offset:1536
  v_mfma_f32_16x16x32_bf16 v[20:23], v[100:103], a[96:99], v[20:23]
  ds_read_b128 a[4:7], v40 offset:4352
  v_mfma_f32_16x16x32_bf16 v[24:27], v[96:99], a[104:107], v[24:27]
  ds_read_b128 a[12:15], v40 offset:13056
  v_mfma_f32_16x16x32_bf16 v[28:31], v[100:103], a[104:107], v[28:31]
  ds_read_b128 a[20:23], v40 offset:21760
  v_mfma_f32_16x16x32_bf16 v[32:35], v[96:99], a[112:115], v[32:35]
  ds_read_b128 a[28:31], v40 offset:30464
  v_mfma_f32_16x16x32_bf16 v[36:39], v[100:103], a[112:115], v[36:39]
  ds_read_b64_tr_b16 a[60:61], v44 offset:2048
  v_mfma_f32_16x16x32_bf16 v[8:11], v[104:107], a[92:95], v[8:11]
  ds_read_b64_tr_b16 a[62:63], v44 offset:2560
  v_mfma_f32_16x16x32_bf16 v[12:15], v[108:111], a[92:95], v[12:15]
  ds_read_b64_tr_b16 a[64:65], v45 offset:2048
  v_mfma_f32_16x16x32_bf16 v[16:19], v[104:107], a[100:103], v[16:19]
  ds_read_b64_tr_b16 a[66:67], v45 offset:2560
  v_mfma_f32_16x16x32_bf16 v[20:23], v[108:111], a[100:103], v[20:23]
  ds_read_b128 a[32:35], v42 offset:0
  v_mfma_f32_16x16x32_bf16 v[24:27], v[104:107], a[108:111], v[24:27]
  ds_read_b64_tr_b16 a[68:69], v44 offset:3072
  v_mfma_f32_16x16x32_bf16 v[28:31], v[108:111], a[108:111], v[28:31]
  ds_read_b64_tr_b16 a[70:71], v44 offset:3584
  v_mfma_f32_16x16x32_bf16 v[32:35], v[104:107], a[116:119], v[32:35]
  ds_read_b64_tr_b16 a[72:73], v45 offset:3072
  v_mfma_f32_16x16x32_bf16 v[36:39], v[108:111], a[116:119], v[36:39]
  s_lshr_b32 s24, s34, 7
  ds_read_b64_tr_b16 a[74:75], v45 offset:3584
  v_mfma_f32_16x16x32_bf16 v[8:11], v[112:115], a[96:99], v[8:11]
  s_sub_u32 s24, 3, s24
  ds_read_b128 a[36:39], v42 offset:4352
  v_mfma_f32_16x16x32_bf16 v[12:15], v[116:119], a[96:99], v[12:15]
  s_and_b32 s24, s24, 7
  ds_read_b64_tr_b16 a[76:77], v44 offset:4096
  v_mfma_f32_16x16x32_bf16 v[16:19], v[112:115], a[104:107], v[16:19]
  s_lshl_b32 s24, s24, 7
  ds_read_b64_tr_b16 a[78:79], v44 offset:4608
  v_mfma_f32_16x16x32_bf16 v[20:23], v[116:119], a[104:107], v[20:23]
  s_lshl_b32 s25, s5, 10
  ds_read_b64_tr_b16 a[80:81], v45 offset:4096
  v_mfma_f32_16x16x32_bf16 v[24:27], v[112:115], a[112:115], v[24:27]
  s_add_u32 s24, s24, s25
  ds_read_b64_tr_b16 a[82:83], v45 offset:4608
  v_mfma_f32_16x16x32_bf16 v[28:31], v[116:119], a[112:115], v[28:31]
  s_add_u32 s25, s60, s3
  ds_read_b128 a[40:43], v42 offset:8704
  v_mfma_f32_16x16x32_bf16 v[32:35], v[112:115], a[120:123], v[32:35]
  s_add_u32 s25, s25, 12
  v_mfma_f32_16x16x32_bf16 v[36:39], v[116:119], a[120:123], v[36:39]
  s_and_b32 s25, s25, 15
  v_mfma_f32_16x16x32_bf16 v[8:11], v[120:123], a[100:103], v[8:11]
  s_lshl_b32 s25, s25, 15
  v_mfma_f32_16x16x32_bf16 v[12:15], v[124:127], a[100:103], v[12:15]
  s_add_u32 s24, s24, s25
  v_mfma_f32_16x16x32_bf16 v[16:19], v[120:123], a[108:111], v[16:19]
  v_lshlrev_b32 v1, 19, v0
  v_mfma_f32_16x16x32_bf16 v[20:23], v[124:127], a[108:111], v[20:23]
  v_add_u32 v1, s24, v1
  v_mfma_f32_16x16x32_bf16 v[24:27], v[120:123], a[116:119], v[24:27]
  s_mov_b64 exec, 0x1f
  v_mfma_f32_16x16x32_bf16 v[28:31], v[124:127], a[116:119], v[28:31]
  global_load_dword v68, v1, s[34:35]
  v_mfma_f32_16x16x32_bf16 v[32:35], v[120:123], a[124:127], v[32:35]
  s_mov_b64 exec, -1
  v_mfma_f32_16x16x32_bf16 v[36:39], v[124:127], a[124:127], v[36:39]
  s_waitcnt lgkmcnt(0)
  s_barrier
  v_mfma_f32_16x16x32_bf16 v[8:11], a[44:47], a[0:3], v[8:11]
  ds_read_b64_tr_b16 v[88:89], v44 offset:20480
  ds_read_b64_tr_b16 v[90:91], v44 offset:20992
  v_mfma_f32_16x16x32_bf16 v[12:15], a[48:51], a[0:3], v[12:15]
  ds_read_b64_tr_b16 v[92:93], v45 offset:20480
  v_mfma_f32_16x16x32_bf16 v[16:19], a[44:47], a[8:11], v[16:19]
  ds_read_b64_tr_b16 v[94:95], v45 offset:20992
  v_mfma_f32_16x16x32_bf16 v[20:23], a[48:51], a[8:11], v[20:23]
  ds_read_b128 a[84:87], v41 offset:0
  v_mfma_f32_16x16x32_bf16 v[24:27], a[44:47], a[16:19], v[24:27]
  ds_read_b128 a[92:95], v41 offset:8704
  v_mfma_f32_16x16x32_bf16 v[28:31], a[48:51], a[16:19], v[28:31]
  ds_read_b128 a[100:103], v41 offset:17408
  v_mfma_f32_16x16x32_bf16 v[32:35], a[44:47], a[24:27], v[32:35]
  ds_read_b128 a[108:111], v41 offset:26112
  v_mfma_f32_16x16x32_bf16 v[36:39], a[48:51], a[24:27], v[36:39]
  ds_read_b64_tr_b16 v[96:97], v44 offset:21504
  v_mfma_f32_16x16x32_bf16 v[8:11], a[52:55], a[4:7], v[8:11]
  ds_read_b64_tr_b16 v[98:99], v44 offset:22016
  v_mfma_f32_16x16x32_bf16 v[12:15], a[56:59], a[4:7], v[12:15]
  ds_read_b64_tr_b16 v[100:101], v45 offset:21504
  v_mfma_f32_16x16x32_bf16 v[16:19], a[52:55], a[12:15], v[16:19]
  ds_read_b64_tr_b16 v[102:103], v45 offset:22016
  v_mfma_f32_16x16x32_bf16 v[20:23], a[56:59], a[12:15], v[20:23]
  ds_read_b128 a[88:91], v41 offset:4352
  v_mfma_f32_16x16x32_bf16 v[24:27], a[52:55], a[20:23], v[24:27]
  ds_read_b128 a[96:99], v41 offset:13056
  v_mfma_f32_16x16x32_bf16 v[28:31], a[56:59], a[20:23], v[28:31]
  ds_read_b128 a[104:107], v41 offset:21760
  v_mfma_f32_16x16x32_bf16 v[32:35], a[52:55], a[28:31], v[32:35]
  ds_read_b128 a[112:115], v41 offset:30464
  v_mfma_f32_16x16x32_bf16 v[36:39], a[56:59], a[28:31], v[36:39]
  ds_read_b64_tr_b16 v[104:105], v44 offset:22528
  v_mfma_f32_16x16x32_bf16 v[8:11], a[60:63], a[8:11], v[8:11]
  ds_read_b64_tr_b16 v[106:107], v44 offset:23040
  v_mfma_f32_16x16x32_bf16 v[12:15], a[64:67], a[8:11], v[12:15]
  ds_read_b64_tr_b16 v[108:109], v45 offset:22528
  v_mfma_f32_16x16x32_bf16 v[16:19], a[60:63], a[16:19], v[16:19]
  ds_read_b64_tr_b16 v[110:111], v45 offset:23040
  v_mfma_f32_16x16x32_bf16 v[20:23], a[64:67], a[16:19], v[20:23]
  s_lshr_b32 s26, s60, 1
  ds_read_b128 a[116:119], v43 offset:0
  v_mfma_f32_16x16x32_bf16 v[24:27], a[60:63], a[24:27], v[24:27]
  s_add_u32 s26, s26, 7
  ds_read_b64_tr_b16 v[112:113], v44 offset:23552
  v_mfma_f32_16x16x32_bf16 v[28:31], a[64:67], a[24:27], v[28:31]
  s_and_b32 s26, s26, 7
  ds_read_b64_tr_b16 v[114:115], v44 offset:24064
  v_mfma_f32_16x16x32_bf16 v[32:35], a[60:63], a[32:35], v[32:35]
  s_lshl_b32 s26, s26, 7
  ds_read_b64_tr_b16 v[116:117], v45 offset:23552
  v_mfma_f32_16x16x32_bf16 v[36:39], a[64:67], a[32:35], v[36:39]
  s_mul_i32 s27, s6, 4096000
  ds_read_b64_tr_b16 v[118:119], v45 offset:24064
  v_mfma_f32_16x16x32_bf16 v[8:11], a[68:71], a[12:15], v[8:11]
  s_add_u32 s26, s26, s27
  ds_read_b128 a[120:123], v43 offset:4352
  v_mfma_f32_16x16x32_bf16 v[12:15], a[72:75], a[12:15], v[12:15]
  s_lshl_b32 s24, s5, 5
  ds_read_b64_tr_b16 v[120:121], v44 offset:24576
  v_mfma_f32_16x16x32_bf16 v[16:19], a[68:71], a[20:23], v[16:19]
  s_mul_i32 s27, s7, 1000
  ds_read_b64_tr_b16 v[122:123], v44 offset:25088
  v_mfma_f32_16x16x32_bf16 v[20:23], a[72:75], a[20:23], v[20:23]
  s_add_u32 s24, s24, s27
  ds_read_b64_tr_b16 v[124:125], v45 offset:24576
  v_mfma_f32_16x16x32_bf16 v[24:27], a[68:71], a[28:31], v[24:27]
  s_lshl_b32 s27, s3, 3
  ds_read_b64_tr_b16 v[126:127], v45 offset:25088
  v_mfma_f32_16x16x32_bf16 v[28:31], a[72:75], a[28:31], v[28:31]
  s_add_u32 s24, s24, s27
  ds_read_b128 a[124:127], v43 offset:8704
  v_mfma_f32_16x16x32_bf16 v[32:35], a[68:71], a[36:39], v[32:35]
  s_sub_u32 s24, s24, 6
  v_mfma_f32_16x16x32_bf16 v[36:39], a[72:75], a[36:39], v[36:39]
  v_add_u32 v1, s24, v0
  v_mfma_f32_16x16x32_bf16 v[8:11], a[76:79], a[16:19], v[8:11]
  v_max_i32 v1, 0, v1
  v_mfma_f32_16x16x32_bf16 v[12:15], a[80:83], a[16:19], v[12:15]
  v_min_i32 v1, 3999, v1
  v_mfma_f32_16x16x32_bf16 v[16:19], a[76:79], a[24:27], v[16:19]
  v_lshlrev_b32 v1, 10, v1
  v_mfma_f32_16x16x32_bf16 v[20:23], a[80:83], a[24:27], v[20:23]
  v_add_u32 v1, s26, v1
  v_mfma_f32_16x16x32_bf16 v[24:27], a[76:79], a[32:35], v[24:27]
  s_mov_b64 exec, 0xff
  v_mfma_f32_16x16x32_bf16 v[28:31], a[80:83], a[32:35], v[28:31]
  global_load_dword v67, v1, s[32:33]
  v_mfma_f32_16x16x32_bf16 v[32:35], a[76:79], a[40:43], v[32:35]
  s_mov_b64 exec, -1
  v_mfma_f32_16x16x32_bf16 v[36:39], a[80:83], a[40:43], v[36:39]
  s_waitcnt lgkmcnt(0)
  s_barrier
  v_mfma_f32_16x16x32_bf16 v[8:11], v[88:91], a[84:87], v[8:11]
  ds_read_b64_tr_b16 a[44:45], v46 offset:0
  ds_read_b64_tr_b16 a[46:47], v46 offset:512
  v_mfma_f32_16x16x32_bf16 v[12:15], v[92:95], a[84:87], v[12:15]
  ds_read_b64_tr_b16 a[48:49], v47 offset:0
  v_mfma_f32_16x16x32_bf16 v[16:19], v[88:91], a[92:95], v[16:19]
  ds_read_b64_tr_b16 a[50:51], v47 offset:512
  v_mfma_f32_16x16x32_bf16 v[20:23], v[92:95], a[92:95], v[20:23]
  ds_read_b128 a[0:3], v40 offset:34816
  v_mfma_f32_16x16x32_bf16 v[24:27], v[88:91], a[100:103], v[24:27]
  ds_read_b128 a[8:11], v40 offset:43520
  v_mfma_f32_16x16x32_bf16 v[28:31], v[92:95], a[100:103], v[28:31]
  ds_read_b128 a[16:19], v40 offset:52224
  v_mfma_f32_16x16x32_bf16 v[32:35], v[88:91], a[108:111], v[32:35]
  ds_read_b128 a[24:27], v40 offset:60928
  v_mfma_f32_16x16x32_bf16 v[36:39], v[92:95], a[108:111], v[36:39]
  ds_read_b64_tr_b16 a[52:53], v46 offset:1024
  v_mfma_f32_16x16x32_bf16 v[8:11], v[96:99], a[88:91], v[8:11]
  ds_read_b64_tr_b16 a[54:55], v46 offset:1536
  v_mfma_f32_16x16x32_bf16 v[12:15], v[100:103], a[88:91], v[12:15]
  ds_read_b64_tr_b16 a[56:57], v47 offset:1024
  v_mfma_f32_16x16x32_bf16 v[16:19], v[96:99], a[96:99], v[16:19]
  ds_read_b64_tr_b16 a[58:59], v47 offset:1536
  v_mfma_f32_16x16x32_bf16 v[20:23], v[100:103], a[96:99], v[20:23]
  ds_read_b128 a[4:7], v40 offset:39168
  v_mfma_f32_16x16x32_bf16 v[24:27], v[96:99], a[104:107], v[24:27]
  ds_read_b128 a[12:15], v40 offset:47872
  v_mfma_f32_16x16x32_bf16 v[28:31], v[100:103], a[104:107], v[28:31]
  ds_read_b128 a[20:23], v40 offset:56576
  v_mfma_f32_16x16x32_bf16 v[32:35], v[96:99], a[112:115], v[32:35]
  ds_read_b128 a[28:31], v40 offset:65280
  v_mfma_f32_16x16x32_bf16 v[36:39], v[100:103], a[112:115], v[36:39]
  ds_read_b64_tr_b16 a[60:61], v46 offset:2048
  v_mfma_f32_16x16x32_bf16 v[8:11], v[104:107], a[92:95], v[8:11]
  ds_read_b64_tr_b16 a[62:63], v46 offset:2560
  v_mfma_f32_16x16x32_bf16 v[12:15], v[108:111], a[92:95], v[12:15]
  ds_read_b64_tr_b16 a[64:65], v47 offset:2048
  v_mfma_f32_16x16x32_bf16 v[16:19], v[104:107], a[100:103], v[16:19]
  ds_read_b64_tr_b16 a[66:67], v47 offset:2560
  v_mfma_f32_16x16x32_bf16 v[20:23], v[108:111], a[100:103], v[20:23]
  ds_read_b128 a[32:35], v42 offset:34816
  v_mfma_f32_16x16x32_bf16 v[24:27], v[104:107], a[108:111], v[24:27]
  ds_read_b64_tr_b16 a[68:69], v46 offset:3072
  v_mfma_f32_16x16x32_bf16 v[28:31], v[108:111], a[108:111], v[28:31]
  ds_read_b64_tr_b16 a[70:71], v46 offset:3584
  v_mfma_f32_16x16x32_bf16 v[32:35], v[104:107], a[116:119], v[32:35]
  ds_read_b64_tr_b16 a[72:73], v47 offset:3072
  v_mfma_f32_16x16x32_bf16 v[36:39], v[108:111], a[116:119], v[36:39]
  ds_read_b64_tr_b16 a[74:75], v47 offset:3584
  v_mfma_f32_16x16x32_bf16 v[8:11], v[112:115], a[96:99], v[8:11]
  ds_read_b128 a[36:39], v42 offset:39168
  v_mfma_f32_16x16x32_bf16 v[12:15], v[116:119], a[96:99], v[12:15]
  ds_read_b64_tr_b16 a[76:77], v46 offset:4096
  v_mfma_f32_16x16x32_bf16 v[16:19], v[112:115], a[104:107], v[16:19]
  ds_read_b64_tr_b16 a[78:79], v46 offset:4608
  v_mfma_f32_16x16x32_bf16 v[20:23], v[116:119], a[104:107], v[20:23]
  ds_read_b64_tr_b16 a[80:81], v47 offset:4096
  v_mfma_f32_16x16x32_bf16 v[24:27], v[112:115], a[112:115], v[24:27]
  ds_read_b64_tr_b16 a[82:83], v47 offset:4608
  v_mfma_f32_16x16x32_bf16 v[28:31], v[116:119], a[112:115], v[28:31]
  ds_read_b128 a[40:43], v42 offset:43520
  v_mfma_f32_16x16x32_bf16 v[32:35], v[112:115], a[120:123], v[32:35]
  v_mfma_f32_16x16x32_bf16 v[36:39], v[116:119], a[120:123], v[36:39]
  v_mfma_f32_16x16x32_bf16 v[8:11], v[120:123], a[100:103], v[8:11]
  v_mfma_f32_16x16x32_bf16 v[12:15], v[124:127], a[100:103], v[12:15]
  v_mfma_f32_16x16x32_bf16 v[16:19], v[120:123], a[108:111], v[16:19]
  v_mfma_f32_16x16x32_bf16 v[20:23], v[124:127], a[108:111], v[20:23]
  v_mfma_f32_16x16x32_bf16 v[24:27], v[120:123], a[116:119], v[24:27]
  v_mfma_f32_16x16x32_bf16 v[28:31], v[124:127], a[116:119], v[28:31]
  v_mfma_f32_16x16x32_bf16 v[32:35], v[120:123], a[124:127], v[32:35]
  v_mfma_f32_16x16x32_bf16 v[36:39], v[124:127], a[124:127], v[36:39]
  s_waitcnt lgkmcnt(0)
  s_barrier
  v_mfma_f32_16x16x32_bf16 v[8:11], a[44:47], a[0:3], v[8:11]
  ds_read_b64_tr_b16 v[88:89], v46 offset:20480
  ds_read_b64_tr_b16 v[90:91], v46 offset:20992
  v_mfma_f32_16x16x32_bf16 v[12:15], a[48:51], a[0:3], v[12:15]
  ds_read_b64_tr_b16 v[92:93], v47 offset:20480
  v_mfma_f32_16x16x32_bf16 v[16:19], a[44:47], a[8:11], v[16:19]
  ds_read_b64_tr_b16 v[94:95], v47 offset:20992
  v_mfma_f32_16x16x32_bf16 v[20:23], a[48:51], a[8:11], v[20:23]
  ds_read_b128 a[84:87], v41 offset:34816
  v_mfma_f32_16x16x32_bf16 v[24:27], a[44:47], a[16:19], v[24:27]
  ds_read_b128 a[92:95], v41 offset:43520
  v_mfma_f32_16x16x32_bf16 v[28:31], a[48:51], a[16:19], v[28:31]
  ds_read_b128 a[100:103], v41 offset:52224
  v_mfma_f32_16x16x32_bf16 v[32:35], a[44:47], a[24:27], v[32:35]
  ds_read_b128 a[108:111], v41 offset:60928
  v_mfma_f32_16x16x32_bf16 v[36:39], a[48:51], a[24:27], v[36:39]
  ds_read_b64_tr_b16 v[96:97], v46 offset:21504
  v_mfma_f32_16x16x32_bf16 v[8:11], a[52:55], a[4:7], v[8:11]
  ds_read_b64_tr_b16 v[98:99], v46 offset:22016
  v_mfma_f32_16x16x32_bf16 v[12:15], a[56:59], a[4:7], v[12:15]
  ds_read_b64_tr_b16 v[100:101], v47 offset:21504
  v_mfma_f32_16x16x32_bf16 v[16:19], a[52:55], a[12:15], v[16:19]
  ds_read_b64_tr_b16 v[102:103], v47 offset:22016
  v_mfma_f32_16x16x32_bf16 v[20:23], a[56:59], a[12:15], v[20:23]
  ds_read_b128 a[88:91], v41 offset:39168
  v_mfma_f32_16x16x32_bf16 v[24:27], a[52:55], a[20:23], v[24:27]
  ds_read_b128 a[96:99], v41 offset:47872
  v_mfma_f32_16x16x32_bf16 v[28:31], a[56:59], a[20:23], v[28:31]
  ds_read_b128 a[104:107], v41 offset:56576
  v_mfma_f32_16x16x32_bf16 v[32:35], a[52:55], a[28:31], v[32:35]
  ds_read_b128 a[112:115], v41 offset:65280
  v_mfma_f32_16x16x32_bf16 v[36:39], a[56:59], a[28:31], v[36:39]
  ds_read_b64_tr_b16 v[104:105], v46 offset:22528
  v_mfma_f32_16x16x32_bf16 v[8:11], a[60:63], a[8:11], v[8:11]
  ds_read_b64_tr_b16 v[106:107], v46 offset:23040
  v_mfma_f32_16x16x32_bf16 v[12:15], a[64:67], a[8:11], v[12:15]
  ds_read_b64_tr_b16 v[108:109], v47 offset:22528
  v_mfma_f32_16x16x32_bf16 v[16:19], a[60:63], a[16:19], v[16:19]
  ds_read_b64_tr_b16 v[110:111], v47 offset:23040
  v_mfma_f32_16x16x32_bf16 v[20:23], a[64:67], a[16:19], v[20:23]
  ds_read_b128 a[116:119], v43 offset:34816
  v_mfma_f32_16x16x32_bf16 v[24:27], a[60:63], a[24:27], v[24:27]
  ds_read_b64_tr_b16 v[112:113], v46 offset:23552
  v_mfma_f32_16x16x32_bf16 v[28:31], a[64:67], a[24:27], v[28:31]
  ds_read_b64_tr_b16 v[114:115], v46 offset:24064
  v_mfma_f32_16x16x32_bf16 v[32:35], a[60:63], a[32:35], v[32:35]
  ds_read_b64_tr_b16 v[116:117], v47 offset:23552
  v_mfma_f32_16x16x32_bf16 v[36:39], a[64:67], a[32:35], v[36:39]
  ds_read_b64_tr_b16 v[118:119], v47 offset:24064
  v_mfma_f32_16x16x32_bf16 v[8:11], a[68:71], a[12:15], v[8:11]
  ds_read_b128 a[120:123], v43 offset:39168
  v_mfma_f32_16x16x32_bf16 v[12:15], a[72:75], a[12:15], v[12:15]
  ds_read_b64_tr_b16 v[120:121], v46 offset:24576
  v_mfma_f32_16x16x32_bf16 v[16:19], a[68:71], a[20:23], v[16:19]
  ds_read_b64_tr_b16 v[122:123], v46 offset:25088
  v_mfma_f32_16x16x32_bf16 v[20:23], a[72:75], a[20:23], v[20:23]
  ds_read_b64_tr_b16 v[124:125], v47 offset:24576
  v_mfma_f32_16x16x32_bf16 v[24:27], a[68:71], a[28:31], v[24:27]
  ds_read_b64_tr_b16 v[126:127], v47 offset:25088
  v_mfma_f32_16x16x32_bf16 v[28:31], a[72:75], a[28:31], v[28:31]
  ds_read_b128 a[124:127], v43 offset:43520
  v_mfma_f32_16x16x32_bf16 v[32:35], a[68:71], a[36:39], v[32:35]
  v_mfma_f32_16x16x32_bf16 v[36:39], a[72:75], a[36:39], v[36:39]
  v_mfma_f32_16x16x32_bf16 v[8:11], a[76:79], a[16:19], v[8:11]
  v_mfma_f32_16x16x32_bf16 v[12:15], a[80:83], a[16:19], v[12:15]
  v_mfma_f32_16x16x32_bf16 v[16:19], a[76:79], a[24:27], v[16:19]
  v_mfma_f32_16x16x32_bf16 v[20:23], a[80:83], a[24:27], v[20:23]
  v_mfma_f32_16x16x32_bf16 v[24:27], a[76:79], a[32:35], v[24:27]
  v_mfma_f32_16x16x32_bf16 v[28:31], a[80:83], a[32:35], v[28:31]
  v_mfma_f32_16x16x32_bf16 v[32:35], a[76:79], a[40:43], v[32:35]
  v_mfma_f32_16x16x32_bf16 v[36:39], a[80:83], a[40:43], v[36:39]
  s_waitcnt lgkmcnt(0)
  s_barrier
  v_mfma_f32_16x16x32_bf16 v[8:11], v[88:91], a[84:87], v[8:11]
  ds_read_b64_tr_b16 a[44:45], v44 offset:0
  ds_read_b64_tr_b16 a[46:47], v44 offset:512
  v_mfma_f32_16x16x32_bf16 v[12:15], v[92:95], a[84:87], v[12:15]
  ds_read_b64_tr_b16 a[48:49], v45 offset:0
  v_mfma_f32_16x16x32_bf16 v[16:19], v[88:91], a[92:95], v[16:19]
  ds_read_b64_tr_b16 a[50:51], v45 offset:512
  v_mfma_f32_16x16x32_bf16 v[20:23], v[92:95], a[92:95], v[20:23]
  ds_read_b128 a[0:3], v40 offset:0
  v_mfma_f32_16x16x32_bf16 v[24:27], v[88:91], a[100:103], v[24:27]
  ds_read_b128 a[8:11], v40 offset:8704
  v_mfma_f32_16x16x32_bf16 v[28:31], v[92:95], a[100:103], v[28:31]
  ds_read_b128 a[16:19], v40 offset:17408
  v_mfma_f32_16x16x32_bf16 v[32:35], v[88:91], a[108:111], v[32:35]
  ds_read_b128 a[24:27], v40 offset:26112
  v_mfma_f32_16x16x32_bf16 v[36:39], v[92:95], a[108:111], v[36:39]
  ds_read_b64_tr_b16 a[52:53], v44 offset:1024
  v_mfma_f32_16x16x32_bf16 v[8:11], v[96:99], a[88:91], v[8:11]
  ds_read_b64_tr_b16 a[54:55], v44 offset:1536
  v_mfma_f32_16x16x32_bf16 v[12:15], v[100:103], a[88:91], v[12:15]
  ds_read_b64_tr_b16 a[56:57], v45 offset:1024
  v_mfma_f32_16x16x32_bf16 v[16:19], v[96:99], a[96:99], v[16:19]
  ds_read_b64_tr_b16 a[58:59], v45 offset:1536
  v_mfma_f32_16x16x32_bf16 v[20:23], v[100:103], a[96:99], v[20:23]
  ds_read_b128 a[4:7], v40 offset:4352
  v_mfma_f32_16x16x32_bf16 v[24:27], v[96:99], a[104:107], v[24:27]
  ds_read_b128 a[12:15], v40 offset:13056
  v_mfma_f32_16x16x32_bf16 v[28:31], v[100:103], a[104:107], v[28:31]
  ds_read_b128 a[20:23], v40 offset:21760
  v_mfma_f32_16x16x32_bf16 v[32:35], v[96:99], a[112:115], v[32:35]
  ds_read_b128 a[28:31], v40 offset:30464
  v_mfma_f32_16x16x32_bf16 v[36:39], v[100:103], a[112:115], v[36:39]
  ds_read_b64_tr_b16 a[60:61], v44 offset:2048
  v_mfma_f32_16x16x32_bf16 v[8:11], v[104:107], a[92:95], v[8:11]
  ds_read_b64_tr_b16 a[62:63], v44 offset:2560
  v_mfma_f32_16x16x32_bf16 v[12:15], v[108:111], a[92:95], v[12:15]
  ds_read_b64_tr_b16 a[64:65], v45 offset:2048
  v_mfma_f32_16x16x32_bf16 v[16:19], v[104:107], a[100:103], v[16:19]
  ds_read_b64_tr_b16 a[66:67], v45 offset:2560
  v_mfma_f32_16x16x32_bf16 v[20:23], v[108:111], a[100:103], v[20:23]
  ds_read_b128 a[32:35], v42 offset:0
  v_mfma_f32_16x16x32_bf16 v[24:27], v[104:107], a[108:111], v[24:27]
  ds_read_b64_tr_b16 a[68:69], v44 offset:3072
  v_mfma_f32_16x16x32_bf16 v[28:31], v[108:111], a[108:111], v[28:31]
  ds_read_b64_tr_b16 a[70:71], v44 offset:3584
  v_mfma_f32_16x16x32_bf16 v[32:35], v[104:107], a[116:119], v[32:35]
  ds_read_b64_tr_b16 a[72:73], v45 offset:3072
  v_mfma_f32_16x16x32_bf16 v[36:39], v[108:111], a[116:119], v[36:39]
  s_lshr_b32 s24, s36, 7
  ds_read_b64_tr_b16 a[74:75], v45 offset:3584
  v_mfma_f32_16x16x32_bf16 v[8:11], v[112:115], a[96:99], v[8:11]
  s_sub_u32 s24, 3, s24
  ds_read_b128 a[36:39], v42 offset:4352
  v_mfma_f32_16x16x32_bf16 v[12:15], v[116:119], a[96:99], v[12:15]
  s_and_b32 s24, s24, 7
  ds_read_b64_tr_b16 a[76:77], v44 offset:4096
  v_mfma_f32_16x16x32_bf16 v[16:19], v[112:115], a[104:107], v[16:19]
  s_lshl_b32 s24, s24, 7
  ds_read_b64_tr_b16 a[78:79], v44 offset:4608
  v_mfma_f32_16x16x32_bf16 v[20:23], v[116:119], a[104:107], v[20:23]
  s_lshl_b32 s25, s5, 10
  ds_read_b64_tr_b16 a[80:81], v45 offset:4096
  v_mfma_f32_16x16x32_bf16 v[24:27], v[112:115], a[112:115], v[24:27]
  s_add_u32 s24, s24, s25
  ds_read_b64_tr_b16 a[82:83], v45 offset:4608
  v_mfma_f32_16x16x32_bf16 v[28:31], v[116:119], a[112:115], v[28:31]
  s_add_u32 s25, s60, s3
  ds_read_b128 a[40:43], v42 offset:8704
  v_mfma_f32_16x16x32_bf16 v[32:35], v[112:115], a[120:123], v[32:35]
  s_add_u32 s25, s25, 0
  v_mfma_f32_16x16x32_bf16 v[36:39], v[116:119], a[120:123], v[36:39]
  s_and_b32 s25, s25, 15
  v_mfma_f32_16x16x32_bf16 v[8:11], v[120:123], a[100:103], v[8:11]
  s_lshl_b32 s25, s25, 15
  v_mfma_f32_16x16x32_bf16 v[12:15], v[124:127], a[100:103], v[12:15]
  s_add_u32 s24, s24, s25
  v_mfma_f32_16x16x32_bf16 v[16:19], v[120:123], a[108:111], v[16:19]
  v_lshlrev_b32 v1, 19, v0
  v_mfma_f32_16x16x32_bf16 v[20:23], v[124:127], a[108:111], v[20:23]
  v_add_u32 v1, s24, v1
  v_mfma_f32_16x16x32_bf16 v[24:27], v[120:123], a[116:119], v[24:27]
  s_mov_b64 exec, 0x1f
  v_mfma_f32_16x16x32_bf16 v[28:31], v[124:127], a[116:119], v[28:31]
  global_load_dword v68, v1, s[36:37]
  v_mfma_f32_16x16x32_bf16 v[32:35], v[120:123], a[124:127], v[32:35]
  s_mov_b64 exec, -1
  v_mfma_f32_16x16x32_bf16 v[36:39], v[124:127], a[124:127], v[36:39]
  s_waitcnt lgkmcnt(0)
  s_barrier
  v_mfma_f32_16x16x32_bf16 v[8:11], a[44:47], a[0:3], v[8:11]
  ds_read_b64_tr_b16 v[88:89], v44 offset:20480
  ds_read_b64_tr_b16 v[90:91], v44 offset:20992
  v_mfma_f32_16x16x32_bf16 v[12:15], a[48:51], a[0:3], v[12:15]
  ds_read_b64_tr_b16 v[92:93], v45 offset:20480
  v_mfma_f32_16x16x32_bf16 v[16:19], a[44:47], a[8:11], v[16:19]
  ds_read_b64_tr_b16 v[94:95], v45 offset:20992
  v_mfma_f32_16x16x32_bf16 v[20:23], a[48:51], a[8:11], v[20:23]
  ds_read_b128 a[84:87], v41 offset:0
  v_mfma_f32_16x16x32_bf16 v[24:27], a[44:47], a[16:19], v[24:27]
  ds_read_b128 a[92:95], v41 offset:8704
  v_mfma_f32_16x16x32_bf16 v[28:31], a[48:51], a[16:19], v[28:31]
  ds_read_b128 a[100:103], v41 offset:17408
  v_mfma_f32_16x16x32_bf16 v[32:35], a[44:47], a[24:27], v[32:35]
  ds_read_b128 a[108:111], v41 offset:26112
  v_mfma_f32_16x16x32_bf16 v[36:39], a[48:51], a[24:27], v[36:39]
  ds_read_b64_tr_b16 v[96:97], v44 offset:21504
  v_mfma_f32_16x16x32_bf16 v[8:11], a[52:55], a[4:7], v[8:11]
  ds_read_b64_tr_b16 v[98:99], v44 offset:22016
  v_mfma_f32_16x16x32_bf16 v[12:15], a[56:59], a[4:7], v[12:15]
  ds_read_b64_tr_b16 v[100:101], v45 offset:21504
  v_mfma_f32_16x16x32_bf16 v[16:19], a[52:55], a[12:15], v[16:19]
  ds_read_b64_tr_b16 v[102:103], v45 offset:22016
  v_mfma_f32_16x16x32_bf16 v[20:23], a[56:59], a[12:15], v[20:23]
  ds_read_b128 a[88:91], v41 offset:4352
  v_mfma_f32_16x16x32_bf16 v[24:27], a[52:55], a[20:23], v[24:27]
  ds_read_b128 a[96:99], v41 offset:13056
  v_mfma_f32_16x16x32_bf16 v[28:31], a[56:59], a[20:23], v[28:31]
  ds_read_b128 a[104:107], v41 offset:21760
  v_mfma_f32_16x16x32_bf16 v[32:35], a[52:55], a[28:31], v[32:35]
  ds_read_b128 a[112:115], v41 offset:30464
  v_mfma_f32_16x16x32_bf16 v[36:39], a[56:59], a[28:31], v[36:39]
  ds_read_b64_tr_b16 v[104:105], v44 offset:22528
  v_mfma_f32_16x16x32_bf16 v[8:11], a[60:63], a[8:11], v[8:11]
  ds_read_b64_tr_b16 v[106:107], v44 offset:23040
  v_mfma_f32_16x16x32_bf16 v[12:15], a[64:67], a[8:11], v[12:15]
  ds_read_b64_tr_b16 v[108:109], v45 offset:22528
  v_mfma_f32_16x16x32_bf16 v[16:19], a[60:63], a[16:19], v[16:19]
  ds_read_b64_tr_b16 v[110:111], v45 offset:23040
  v_mfma_f32_16x16x32_bf16 v[20:23], a[64:67], a[16:19], v[20:23]
  ds_read_b128 a[116:119], v43 offset:0
  v_mfma_f32_16x16x32_bf16 v[24:27], a[60:63], a[24:27], v[24:27]
  ds_read_b64_tr_b16 v[112:113], v44 offset:23552
  v_mfma_f32_16x16x32_bf16 v[28:31], a[64:67], a[24:27], v[28:31]
  ds_read_b64_tr_b16 v[114:115], v44 offset:24064
  v_mfma_f32_16x16x32_bf16 v[32:35], a[60:63], a[32:35], v[32:35]
  ds_read_b64_tr_b16 v[116:117], v45 offset:23552
  v_mfma_f32_16x16x32_bf16 v[36:39], a[64:67], a[32:35], v[36:39]
  ds_read_b64_tr_b16 v[118:119], v45 offset:24064
  v_mfma_f32_16x16x32_bf16 v[8:11], a[68:71], a[12:15], v[8:11]
  ds_read_b128 a[120:123], v43 offset:4352
  v_mfma_f32_16x16x32_bf16 v[12:15], a[72:75], a[12:15], v[12:15]
  ds_read_b64_tr_b16 v[120:121], v44 offset:24576
  v_mfma_f32_16x16x32_bf16 v[16:19], a[68:71], a[20:23], v[16:19]
  ds_read_b64_tr_b16 v[122:123], v44 offset:25088
  v_mfma_f32_16x16x32_bf16 v[20:23], a[72:75], a[20:23], v[20:23]
  ds_read_b64_tr_b16 v[124:125], v45 offset:24576
  v_mfma_f32_16x16x32_bf16 v[24:27], a[68:71], a[28:31], v[24:27]
  ds_read_b64_tr_b16 v[126:127], v45 offset:25088
  v_mfma_f32_16x16x32_bf16 v[28:31], a[72:75], a[28:31], v[28:31]
  ds_read_b128 a[124:127], v43 offset:8704
  v_mfma_f32_16x16x32_bf16 v[32:35], a[68:71], a[36:39], v[32:35]
  v_mfma_f32_16x16x32_bf16 v[36:39], a[72:75], a[36:39], v[36:39]
  v_mfma_f32_16x16x32_bf16 v[8:11], a[76:79], a[16:19], v[8:11]
  v_mfma_f32_16x16x32_bf16 v[12:15], a[80:83], a[16:19], v[12:15]
  v_mfma_f32_16x16x32_bf16 v[16:19], a[76:79], a[24:27], v[16:19]
  v_mfma_f32_16x16x32_bf16 v[20:23], a[80:83], a[24:27], v[20:23]
  v_mfma_f32_16x16x32_bf16 v[24:27], a[76:79], a[32:35], v[24:27]
  v_mfma_f32_16x16x32_bf16 v[28:31], a[80:83], a[32:35], v[28:31]
  v_mfma_f32_16x16x32_bf16 v[32:35], a[76:79], a[40:43], v[32:35]
  v_mfma_f32_16x16x32_bf16 v[36:39], a[80:83], a[40:43], v[36:39]
  s_waitcnt lgkmcnt(0)
  s_barrier
  v_mfma_f32_16x16x32_bf16 v[8:11], v[88:91], a[84:87], v[8:11]
  ds_read_b64_tr_b16 a[44:45], v46 offset:0
  ds_read_b64_tr_b16 a[46:47], v46 offset:512
  v_mfma_f32_16x16x32_bf16 v[12:15], v[92:95], a[84:87], v[12:15]
  ds_read_b64_tr_b16 a[48:49], v47 offset:0
  v_mfma_f32_16x16x32_bf16 v[16:19], v[88:91], a[92:95], v[16:19]
  ds_read_b64_tr_b16 a[50:51], v47 offset:512
  v_mfma_f32_16x16x32_bf16 v[20:23], v[92:95], a[92:95], v[20:23]
  ds_read_b128 a[0:3], v40 offset:34816
  v_mfma_f32_16x16x32_bf16 v[24:27], v[88:91], a[100:103], v[24:27]
  ds_read_b128 a[8:11], v40 offset:43520
  v_mfma_f32_16x16x32_bf16 v[28:31], v[92:95], a[100:103], v[28:31]
  ds_read_b128 a[16:19], v40 offset:52224
  v_mfma_f32_16x16x32_bf16 v[32:35], v[88:91], a[108:111], v[32:35]
  ds_read_b128 a[24:27], v40 offset:60928
  v_mfma_f32_16x16x32_bf16 v[36:39], v[92:95], a[108:111], v[36:39]
  ds_read_b64_tr_b16 a[52:53], v46 offset:1024
  v_mfma_f32_16x16x32_bf16 v[8:11], v[96:99], a[88:91], v[8:11]
  ds_read_b64_tr_b16 a[54:55], v46 offset:1536
  v_mfma_f32_16x16x32_bf16 v[12:15], v[100:103], a[88:91], v[12:15]
  ds_read_b64_tr_b16 a[56:57], v47 offset:1024
  v_mfma_f32_16x16x32_bf16 v[16:19], v[96:99], a[96:99], v[16:19]
  ds_read_b64_tr_b16 a[58:59], v47 offset:1536
  v_mfma_f32_16x16x32_bf16 v[20:23], v[100:103], a[96:99], v[20:23]
  ds_read_b128 a[4:7], v40 offset:39168
  v_mfma_f32_16x16x32_bf16 v[24:27], v[96:99], a[104:107], v[24:27]
  ds_read_b128 a[12:15], v40 offset:47872
  v_mfma_f32_16x16x32_bf16 v[28:31], v[100:103], a[104:107], v[28:31]
  ds_read_b128 a[20:23], v40 offset:56576
  v_mfma_f32_16x16x32_bf16 v[32:35], v[96:99], a[112:115], v[32:35]
  ds_read_b128 a[28:31], v40 offset:65280
  v_mfma_f32_16x16x32_bf16 v[36:39], v[100:103], a[112:115], v[36:39]
  ds_read_b64_tr_b16 a[60:61], v46 offset:2048
  v_mfma_f32_16x16x32_bf16 v[8:11], v[104:107], a[92:95], v[8:11]
  ds_read_b64_tr_b16 a[62:63], v46 offset:2560
  v_mfma_f32_16x16x32_bf16 v[12:15], v[108:111], a[92:95], v[12:15]
  ds_read_b64_tr_b16 a[64:65], v47 offset:2048
  v_mfma_f32_16x16x32_bf16 v[16:19], v[104:107], a[100:103], v[16:19]
  ds_read_b64_tr_b16 a[66:67], v47 offset:2560
  v_mfma_f32_16x16x32_bf16 v[20:23], v[108:111], a[100:103], v[20:23]
  ds_read_b128 a[32:35], v42 offset:34816
  v_mfma_f32_16x16x32_bf16 v[24:27], v[104:107], a[108:111], v[24:27]
  ds_read_b64_tr_b16 a[68:69], v46 offset:3072
  v_mfma_f32_16x16x32_bf16 v[28:31], v[108:111], a[108:111], v[28:31]
  ds_read_b64_tr_b16 a[70:71], v46 offset:3584
  v_mfma_f32_16x16x32_bf16 v[32:35], v[104:107], a[116:119], v[32:35]
  ds_read_b64_tr_b16 a[72:73], v47 offset:3072
  v_mfma_f32_16x16x32_bf16 v[36:39], v[108:111], a[116:119], v[36:39]
  s_lshr_b32 s24, s36, 7
  ds_read_b64_tr_b16 a[74:75], v47 offset:3584
  v_mfma_f32_16x16x32_bf16 v[8:11], v[112:115], a[96:99], v[8:11]
  s_sub_u32 s24, 3, s24
  ds_read_b128 a[36:39], v42 offset:39168
  v_mfma_f32_16x16x32_bf16 v[12:15], v[116:119], a[96:99], v[12:15]
  s_and_b32 s24, s24, 7
  ds_read_b64_tr_b16 a[76:77], v46 offset:4096
  v_mfma_f32_16x16x32_bf16 v[16:19], v[112:115], a[104:107], v[16:19]
  s_lshl_b32 s24, s24, 7
  ds_read_b64_tr_b16 a[78:79], v46 offset:4608
  v_mfma_f32_16x16x32_bf16 v[20:23], v[116:119], a[104:107], v[20:23]
  s_lshl_b32 s25, s5, 10
  ds_read_b64_tr_b16 a[80:81], v47 offset:4096
  v_mfma_f32_16x16x32_bf16 v[24:27], v[112:115], a[112:115], v[24:27]
  s_add_u32 s24, s24, s25
  ds_read_b64_tr_b16 a[82:83], v47 offset:4608
  v_mfma_f32_16x16x32_bf16 v[28:31], v[116:119], a[112:115], v[28:31]
  s_add_u32 s25, s60, s3
  ds_read_b128 a[40:43], v42 offset:43520
  v_mfma_f32_16x16x32_bf16 v[32:35], v[112:115], a[120:123], v[32:35]
  s_add_u32 s25, s25, 4
  v_mfma_f32_16x16x32_bf16 v[36:39], v[116:119], a[120:123], v[36:39]
  s_and_b32 s25, s25, 15
  v_mfma_f32_16x16x32_bf16 v[8:11], v[120:123], a[100:103], v[8:11]
  s_lshl_b32 s25, s25, 15
  v_mfma_f32_16x16x32_bf16 v[12:15], v[124:127], a[100:103], v[12:15]
  s_add_u32 s24, s24, s25
  v_mfma_f32_16x16x32_bf16 v[16:19], v[120:123], a[108:111], v[16:19]
  v_lshlrev_b32 v1, 19, v0
  v_mfma_f32_16x16x32_bf16 v[20:23], v[124:127], a[108:111], v[20:23]
  v_add_u32 v1, s24, v1
  v_mfma_f32_16x16x32_bf16 v[24:27], v[120:123], a[116:119], v[24:27]
  s_mov_b64 exec, 0x1f
  v_mfma_f32_16x16x32_bf16 v[28:31], v[124:127], a[116:119], v[28:31]
  global_load_dword v68, v1, s[36:37]
  v_mfma_f32_16x16x32_bf16 v[32:35], v[120:123], a[124:127], v[32:35]
  s_mov_b64 exec, -1
  v_mfma_f32_16x16x32_bf16 v[36:39], v[124:127], a[124:127], v[36:39]
  s_waitcnt lgkmcnt(0)
  s_barrier
  v_mfma_f32_16x16x32_bf16 v[8:11], a[44:47], a[0:3], v[8:11]
  ds_read_b64_tr_b16 v[88:89], v46 offset:20480
  ds_read_b64_tr_b16 v[90:91], v46 offset:20992
  v_mfma_f32_16x16x32_bf16 v[12:15], a[48:51], a[0:3], v[12:15]
  ds_read_b64_tr_b16 v[92:93], v47 offset:20480
  v_mfma_f32_16x16x32_bf16 v[16:19], a[44:47], a[8:11], v[16:19]
  ds_read_b64_tr_b16 v[94:95], v47 offset:20992
  v_mfma_f32_16x16x32_bf16 v[20:23], a[48:51], a[8:11], v[20:23]
  ds_read_b128 a[84:87], v41 offset:34816
  v_mfma_f32_16x16x32_bf16 v[24:27], a[44:47], a[16:19], v[24:27]
  ds_read_b128 a[92:95], v41 offset:43520
  v_mfma_f32_16x16x32_bf16 v[28:31], a[48:51], a[16:19], v[28:31]
  ds_read_b128 a[100:103], v41 offset:52224
  v_mfma_f32_16x16x32_bf16 v[32:35], a[44:47], a[24:27], v[32:35]
  ds_read_b128 a[108:111], v41 offset:60928
  v_mfma_f32_16x16x32_bf16 v[36:39], a[48:51], a[24:27], v[36:39]
  ds_read_b64_tr_b16 v[96:97], v46 offset:21504
  v_mfma_f32_16x16x32_bf16 v[8:11], a[52:55], a[4:7], v[8:11]
  ds_read_b64_tr_b16 v[98:99], v46 offset:22016
  v_mfma_f32_16x16x32_bf16 v[12:15], a[56:59], a[4:7], v[12:15]
  ds_read_b64_tr_b16 v[100:101], v47 offset:21504
  v_mfma_f32_16x16x32_bf16 v[16:19], a[52:55], a[12:15], v[16:19]
  ds_read_b64_tr_b16 v[102:103], v47 offset:22016
  v_mfma_f32_16x16x32_bf16 v[20:23], a[56:59], a[12:15], v[20:23]
  ds_read_b128 a[88:91], v41 offset:39168
  v_mfma_f32_16x16x32_bf16 v[24:27], a[52:55], a[20:23], v[24:27]
  ds_read_b128 a[96:99], v41 offset:47872
  v_mfma_f32_16x16x32_bf16 v[28:31], a[56:59], a[20:23], v[28:31]
  ds_read_b128 a[104:107], v41 offset:56576
  v_mfma_f32_16x16x32_bf16 v[32:35], a[52:55], a[28:31], v[32:35]
  ds_read_b128 a[112:115], v41 offset:65280
  v_mfma_f32_16x16x32_bf16 v[36:39], a[56:59], a[28:31], v[36:39]
  ds_read_b64_tr_b16 v[104:105], v46 offset:22528
  v_mfma_f32_16x16x32_bf16 v[8:11], a[60:63], a[8:11], v[8:11]
  ds_read_b64_tr_b16 v[106:107], v46 offset:23040
  v_mfma_f32_16x16x32_bf16 v[12:15], a[64:67], a[8:11], v[12:15]
  ds_read_b64_tr_b16 v[108:109], v47 offset:22528
  v_mfma_f32_16x16x32_bf16 v[16:19], a[60:63], a[16:19], v[16:19]
  ds_read_b64_tr_b16 v[110:111], v47 offset:23040
  v_mfma_f32_16x16x32_bf16 v[20:23], a[64:67], a[16:19], v[20:23]
  ds_read_b128 a[116:119], v43 offset:34816
  v_mfma_f32_16x16x32_bf16 v[24:27], a[60:63], a[24:27], v[24:27]
  ds_read_b64_tr_b16 v[112:113], v46 offset:23552
  v_mfma_f32_16x16x32_bf16 v[28:31], a[64:67], a[24:27], v[28:31]
  ds_read_b64_tr_b16 v[114:115], v46 offset:24064
  v_mfma_f32_16x16x32_bf16 v[32:35], a[60:63], a[32:35], v[32:35]
  ds_read_b64_tr_b16 v[116:117], v47 offset:23552
  v_mfma_f32_16x16x32_bf16 v[36:39], a[64:67], a[32:35], v[36:39]
  ds_read_b64_tr_b16 v[118:119], v47 offset:24064
  v_mfma_f32_16x16x32_bf16 v[8:11], a[68:71], a[12:15], v[8:11]
  ds_read_b128 a[120:123], v43 offset:39168
  v_mfma_f32_16x16x32_bf16 v[12:15], a[72:75], a[12:15], v[12:15]
  ds_read_b64_tr_b16 v[120:121], v46 offset:24576
  v_mfma_f32_16x16x32_bf16 v[16:19], a[68:71], a[20:23], v[16:19]
  ds_read_b64_tr_b16 v[122:123], v46 offset:25088
  v_mfma_f32_16x16x32_bf16 v[20:23], a[72:75], a[20:23], v[20:23]
  ds_read_b64_tr_b16 v[124:125], v47 offset:24576
  v_mfma_f32_16x16x32_bf16 v[24:27], a[68:71], a[28:31], v[24:27]
  ds_read_b64_tr_b16 v[126:127], v47 offset:25088
  v_mfma_f32_16x16x32_bf16 v[28:31], a[72:75], a[28:31], v[28:31]
  ds_read_b128 a[124:127], v43 offset:43520
  v_mfma_f32_16x16x32_bf16 v[32:35], a[68:71], a[36:39], v[32:35]
  v_mfma_f32_16x16x32_bf16 v[36:39], a[72:75], a[36:39], v[36:39]
  v_mfma_f32_16x16x32_bf16 v[8:11], a[76:79], a[16:19], v[8:11]
  v_mfma_f32_16x16x32_bf16 v[12:15], a[80:83], a[16:19], v[12:15]
  v_mfma_f32_16x16x32_bf16 v[16:19], a[76:79], a[24:27], v[16:19]
  v_mfma_f32_16x16x32_bf16 v[20:23], a[80:83], a[24:27], v[20:23]
  v_mfma_f32_16x16x32_bf16 v[24:27], a[76:79], a[32:35], v[24:27]
  v_mfma_f32_16x16x32_bf16 v[28:31], a[80:83], a[32:35], v[28:31]
  v_mfma_f32_16x16x32_bf16 v[32:35], a[76:79], a[40:43], v[32:35]
  v_mfma_f32_16x16x32_bf16 v[36:39], a[80:83], a[40:43], v[36:39]
  s_waitcnt lgkmcnt(0)
  s_barrier
  v_mfma_f32_16x16x32_bf16 v[8:11], v[88:91], a[84:87], v[8:11]
  s_mov_b32 s52, 0xbdd2d3e8
  v_mfma_f32_16x16x32_bf16 v[12:15], v[92:95], a[84:87], v[12:15]
  s_mov_b32 s53, 0xbdd2d3e8
  v_mfma_f32_16x16x32_bf16 v[16:19], v[88:91], a[92:95], v[16:19]
  v_mov_b32 v2, 0xc0135761
  v_mfma_f32_16x16x32_bf16 v[20:23], v[92:95], a[92:95], v[20:23]
  v_mfma_f32_16x16x32_bf16 v[24:27], v[88:91], a[100:103], v[24:27]
  v_mov_b32 v3, 0xc0135761
  v_mfma_f32_16x16x32_bf16 v[28:31], v[92:95], a[100:103], v[28:31]
  s_lshr_b32 s63, s3, 1
  v_mfma_f32_16x16x32_bf16 v[32:35], v[88:91], a[108:111], v[32:35]
  s_and_b32 s80, s3, 1
  v_mfma_f32_16x16x32_bf16 v[36:39], v[92:95], a[108:111], v[36:39]
  v_mfma_f32_16x16x32_bf16 v[8:11], v[96:99], a[88:91], v[8:11]
  v_and_b32 v4, 15, v0
  v_mfma_f32_16x16x32_bf16 v[12:15], v[100:103], a[88:91], v[12:15]
  v_lshrrev_b32 v5, 4, v0
  v_mfma_f32_16x16x32_bf16 v[16:19], v[96:99], a[96:99], v[16:19]
  v_and_b32 v6, 1, v5
  v_mfma_f32_16x16x32_bf16 v[20:23], v[100:103], a[96:99], v[20:23]
  v_mfma_f32_16x16x32_bf16 v[24:27], v[96:99], a[104:107], v[24:27]
  v_lshlrev_b32 v6, 5, v6
  v_mfma_f32_16x16x32_bf16 v[28:31], v[100:103], a[104:107], v[28:31]
  v_and_b32 v5, 2, v5
  v_mfma_f32_16x16x32_bf16 v[32:35], v[96:99], a[112:115], v[32:35]
  v_lshlrev_b32 v5, 3, v5
  v_mfma_f32_16x16x32_bf16 v[36:39], v[100:103], a[112:115], v[36:39]
  v_mfma_f32_16x16x32_bf16 v[8:11], v[104:107], a[92:95], v[8:11]
  v_add_u32 v5, v5, v6
  v_mfma_f32_16x16x32_bf16 v[12:15], v[108:111], a[92:95], v[12:15]
  s_lshl_b32 s24, s62, 7
  v_mfma_f32_16x16x32_bf16 v[16:19], v[104:107], a[100:103], v[16:19]
  s_lshl_b32 s25, s80, 6
  v_mfma_f32_16x16x32_bf16 v[20:23], v[108:111], a[100:103], v[20:23]
  v_mfma_f32_16x16x32_bf16 v[24:27], v[104:107], a[108:111], v[24:27]
  s_add_u32 s24, s24, s25
  v_mfma_f32_16x16x32_bf16 v[28:31], v[108:111], a[108:111], v[28:31]
  v_add_u32 v5, s24, v5
  v_mfma_f32_16x16x32_bf16 v[32:35], v[104:107], a[116:119], v[32:35]
  s_mul_i32 s24, s61, 128
  v_mfma_f32_16x16x32_bf16 v[36:39], v[108:111], a[116:119], v[36:39]
  v_mfma_f32_16x16x32_bf16 v[8:11], v[112:115], a[96:99], v[8:11]
  s_mul_i32 s25, s63, 64
  v_mfma_f32_16x16x32_bf16 v[12:15], v[116:119], a[96:99], v[12:15]
  s_add_u32 s24, s24, s25
  v_mfma_f32_16x16x32_bf16 v[16:19], v[112:115], a[104:107], v[16:19]
  v_mul_u32_u24 v4, 4, v4
  v_mfma_f32_16x16x32_bf16 v[20:23], v[116:119], a[104:107], v[20:23]
  v_mfma_f32_16x16x32_bf16 v[24:27], v[112:115], a[112:115], v[24:27]
  v_add_u32 v4, s24, v4
  v_mfma_f32_16x16x32_bf16 v[28:31], v[116:119], a[112:115], v[28:31]
  v_lshlrev_b32 v6, 10, v4
  v_mfma_f32_16x16x32_bf16 v[32:35], v[112:115], a[120:123], v[32:35]
  v_add_u32 v6, v6, v5
  v_mfma_f32_16x16x32_bf16 v[36:39], v[116:119], a[120:123], v[36:39]
  v_mfma_f32_16x16x32_bf16 v[8:11], v[120:123], a[100:103], v[8:11]
  s_mul_i32 s25, s7, 500
  v_mfma_f32_16x16x32_bf16 v[12:15], v[124:127], a[100:103], v[12:15]
  s_sub_u32 s25, s25, 2
  v_mfma_f32_16x16x32_bf16 v[16:19], v[120:123], a[108:111], v[16:19]
  v_add_u32 v4, s25, v4
  v_mfma_f32_16x16x32_bf16 v[20:23], v[124:127], a[108:111], v[20:23]
  v_mfma_f32_16x16x32_bf16 v[24:27], v[120:123], a[116:119], v[24:27]
  v_mfma_f32_16x16x32_bf16 v[28:31], v[124:127], a[116:119], v[28:31]
  v_mfma_f32_16x16x32_bf16 v[32:35], v[120:123], a[124:127], v[32:35]
  v_mfma_f32_16x16x32_bf16 v[36:39], v[124:127], a[124:127], v[36:39]
  s_nop 7
  v_add_u32 v7, 0, v4
  s_movk_i32 s24, 2000
  v_cmp_gt_u32 s[82:83], s24, v7
  v_pk_mul_f32 v[48:49], v[8:9], v[8:9]
  v_pk_mul_f32 v[50:51], v[10:11], v[10:11]
  v_pk_mul_f32 v[52:53], v[12:13], v[12:13]
  v_pk_mul_f32 v[54:55], v[14:15], v[14:15]
  v_pk_fma_f32 v[48:49], v[48:49], s[52:53], v[2:3]
  v_pk_fma_f32 v[50:51], v[50:51], s[52:53], v[2:3]
  v_pk_fma_f32 v[52:53], v[52:53], s[52:53], v[2:3]
  v_pk_fma_f32 v[54:55], v[54:55], s[52:53], v[2:3]
  v_pk_mul_f32 v[48:49], v[48:49], v[8:9]
  v_pk_mul_f32 v[50:51], v[50:51], v[10:11]
  v_pk_mul_f32 v[52:53], v[52:53], v[12:13]
  v_pk_mul_f32 v[54:55], v[54:55], v[14:15]
  v_exp_f32 v48, v48
  v_exp_f32 v49, v49
  v_exp_f32 v50, v50
  v_exp_f32 v51, v51
  v_exp_f32 v52, v52
  v_exp_f32 v53, v53
  v_exp_f32 v54, v54
  v_exp_f32 v55, v55
  v_pk_add_f32 v[48:49], v[48:49], 1.0 op_sel_hi:[1,0]
  v_pk_add_f32 v[50:51], v[50:51], 1.0 op_sel_hi:[1,0]
  v_pk_add_f32 v[52:53], v[52:53], 1.0 op_sel_hi:[1,0]
  v_pk_add_f32 v[54:55], v[54:55], 1.0 op_sel_hi:[1,0]
  v_rcp_f32 v48, v48
  v_rcp_f32 v49, v49
  v_rcp_f32 v50, v50
  v_rcp_f32 v51, v51
  v_rcp_f32 v52, v52
  v_rcp_f32 v53, v53
  v_rcp_f32 v54, v54
  v_rcp_f32 v55, v55
  v_pk_mul_f32 v[8:9], v[8:9], v[48:49]
  v_pk_mul_f32 v[10:11], v[10:11], v[50:51]
  v_pk_mul_f32 v[12:13], v[12:13], v[52:53]
  v_pk_mul_f32 v[14:15], v[14:15], v[54:55]
  v_cvt_pk_bf16_f32 v56, v8, v9
  v_cvt_pk_bf16_f32 v57, v10, v11
  v_cvt_pk_bf16_f32 v58, v12, v13
  v_cvt_pk_bf16_f32 v59, v14, v15
  v_cndmask_b32 v56, 0, v56, s[82:83]
  v_cndmask_b32 v57, 0, v57, s[82:83]
  v_cndmask_b32 v58, 0, v58, s[82:83]
  v_cndmask_b32 v59, 0, v59, s[82:83]
  s_nop 1
  v_permlane16_swap_b32 v56, v58
  v_permlane16_swap_b32 v57, v59
  buffer_store_dwordx4 v[56:59], v6, s[16:19], 0 offen offset:0
  v_add_u32 v7, 1, v4
  s_movk_i32 s24, 2000
  v_cmp_gt_u32 s[82:83], s24, v7
  v_pk_mul_f32 v[48:49], v[16:17], v[16:17]
  v_pk_mul_f32 v[50:51], v[18:19], v[18:19]
  v_pk_mul_f32 v[52:53], v[20:21], v[20:21]
  v_pk_mul_f32 v[54:55], v[22:23], v[22:23]
  v_pk_fma_f32 v[48:49], v[48:49], s[52:53], v[2:3]
  v_pk_fma_f32 v[50:51], v[50:51], s[52:53], v[2:3]
  v_pk_fma_f32 v[52:53], v[52:53], s[52:53], v[2:3]
  v_pk_fma_f32 v[54:55], v[54:55], s[52:53], v[2:3]
  v_pk_mul_f32 v[48:49], v[48:49], v[16:17]
  v_pk_mul_f32 v[50:51], v[50:51], v[18:19]
  v_pk_mul_f32 v[52:53], v[52:53], v[20:21]
  v_pk_mul_f32 v[54:55], v[54:55], v[22:23]
  v_exp_f32 v48, v48
  v_exp_f32 v49, v49
  v_exp_f32 v50, v50
  v_exp_f32 v51, v51
  v_exp_f32 v52, v52
  v_exp_f32 v53, v53
  v_exp_f32 v54, v54
  v_exp_f32 v55, v55
  v_pk_add_f32 v[48:49], v[48:49], 1.0 op_sel_hi:[1,0]
  v_pk_add_f32 v[50:51], v[50:51], 1.0 op_sel_hi:[1,0]
  v_pk_add_f32 v[52:53], v[52:53], 1.0 op_sel_hi:[1,0]
  v_pk_add_f32 v[54:55], v[54:55], 1.0 op_sel_hi:[1,0]
  v_rcp_f32 v48, v48
  v_rcp_f32 v49, v49
  v_rcp_f32 v50, v50
  v_rcp_f32 v51, v51
  v_rcp_f32 v52, v52
  v_rcp_f32 v53, v53
  v_rcp_f32 v54, v54
  v_rcp_f32 v55, v55
  v_pk_mul_f32 v[16:17], v[16:17], v[48:49]
  v_pk_mul_f32 v[18:19], v[18:19], v[50:51]
  v_pk_mul_f32 v[20:21], v[20:21], v[52:53]
  v_pk_mul_f32 v[22:23], v[22:23], v[54:55]
  v_cvt_pk_bf16_f32 v60, v16, v17
  v_cvt_pk_bf16_f32 v61, v18, v19
  v_cvt_pk_bf16_f32 v62, v20, v21
  v_cvt_pk_bf16_f32 v63, v22, v23
  v_cndmask_b32 v60, 0, v60, s[82:83]
  v_cndmask_b32 v61, 0, v61, s[82:83]
  v_cndmask_b32 v62, 0, v62, s[82:83]
  v_cndmask_b32 v63, 0, v63, s[82:83]
  s_nop 1
  v_permlane16_swap_b32 v60, v62
  v_permlane16_swap_b32 v61, v63
  buffer_store_dwordx4 v[60:63], v6, s[16:19], 0 offen offset:1024
  v_add_u32 v7, 2, v4
  s_movk_i32 s24, 2000
  v_cmp_gt_u32 s[82:83], s24, v7
  v_pk_mul_f32 v[48:49], v[24:25], v[24:25]
  v_pk_mul_f32 v[50:51], v[26:27], v[26:27]
  v_pk_mul_f32 v[52:53], v[28:29], v[28:29]
  v_pk_mul_f32 v[54:55], v[30:31], v[30:31]
  v_pk_fma_f32 v[48:49], v[48:49], s[52:53], v[2:3]
  v_pk_fma_f32 v[50:51], v[50:51], s[52:53], v[2:3]
  v_pk_fma_f32 v[52:53], v[52:53], s[52:53], v[2:3]
  v_pk_fma_f32 v[54:55], v[54:55], s[52:53], v[2:3]
  v_pk_mul_f32 v[48:49], v[48:49], v[24:25]
  v_pk_mul_f32 v[50:51], v[50:51], v[26:27]
  v_pk_mul_f32 v[52:53], v[52:53], v[28:29]
  v_pk_mul_f32 v[54:55], v[54:55], v[30:31]
  v_exp_f32 v48, v48
  v_exp_f32 v49, v49
  v_exp_f32 v50, v50
  v_exp_f32 v51, v51
  v_exp_f32 v52, v52
  v_exp_f32 v53, v53
  v_exp_f32 v54, v54
  v_exp_f32 v55, v55
  v_pk_add_f32 v[48:49], v[48:49], 1.0 op_sel_hi:[1,0]
  v_pk_add_f32 v[50:51], v[50:51], 1.0 op_sel_hi:[1,0]
  v_pk_add_f32 v[52:53], v[52:53], 1.0 op_sel_hi:[1,0]
  v_pk_add_f32 v[54:55], v[54:55], 1.0 op_sel_hi:[1,0]
  v_rcp_f32 v48, v48
  v_rcp_f32 v49, v49
  v_rcp_f32 v50, v50
  v_rcp_f32 v51, v51
  v_rcp_f32 v52, v52
  v_rcp_f32 v53, v53
  v_rcp_f32 v54, v54
  v_rcp_f32 v55, v55
  v_pk_mul_f32 v[24:25], v[24:25], v[48:49]
  v_pk_mul_f32 v[26:27], v[26:27], v[50:51]
  v_pk_mul_f32 v[28:29], v[28:29], v[52:53]
  v_pk_mul_f32 v[30:31], v[30:31], v[54:55]
  v_cvt_pk_bf16_f32 v56, v24, v25
  v_cvt_pk_bf16_f32 v57, v26, v27
  v_cvt_pk_bf16_f32 v58, v28, v29
  v_cvt_pk_bf16_f32 v59, v30, v31
  v_cndmask_b32 v56, 0, v56, s[82:83]
  v_cndmask_b32 v57, 0, v57, s[82:83]
  v_cndmask_b32 v58, 0, v58, s[82:83]
  v_cndmask_b32 v59, 0, v59, s[82:83]
  s_nop 1
  v_permlane16_swap_b32 v56, v58
  v_permlane16_swap_b32 v57, v59
  buffer_store_dwordx4 v[56:59], v6, s[16:19], 0 offen offset:2048
  v_add_u32 v7, 3, v4
  s_movk_i32 s24, 2000
  v_cmp_gt_u32 s[82:83], s24, v7
  v_pk_mul_f32 v[48:49], v[32:33], v[32:33]
  v_pk_mul_f32 v[50:51], v[34:35], v[34:35]
  v_pk_mul_f32 v[52:53], v[36:37], v[36:37]
  v_pk_mul_f32 v[54:55], v[38:39], v[38:39]
  v_pk_fma_f32 v[48:49], v[48:49], s[52:53], v[2:3]
  v_pk_fma_f32 v[50:51], v[50:51], s[52:53], v[2:3]
  v_pk_fma_f32 v[52:53], v[52:53], s[52:53], v[2:3]
  v_pk_fma_f32 v[54:55], v[54:55], s[52:53], v[2:3]
  v_pk_mul_f32 v[48:49], v[48:49], v[32:33]
  v_pk_mul_f32 v[50:51], v[50:51], v[34:35]
  v_pk_mul_f32 v[52:53], v[52:53], v[36:37]
  v_pk_mul_f32 v[54:55], v[54:55], v[38:39]
  v_exp_f32 v48, v48
  v_exp_f32 v49, v49
  v_exp_f32 v50, v50
  v_exp_f32 v51, v51
  v_exp_f32 v52, v52
  v_exp_f32 v53, v53
  v_exp_f32 v54, v54
  v_exp_f32 v55, v55
  v_pk_add_f32 v[48:49], v[48:49], 1.0 op_sel_hi:[1,0]
  v_pk_add_f32 v[50:51], v[50:51], 1.0 op_sel_hi:[1,0]
  v_pk_add_f32 v[52:53], v[52:53], 1.0 op_sel_hi:[1,0]
  v_pk_add_f32 v[54:55], v[54:55], 1.0 op_sel_hi:[1,0]
  v_rcp_f32 v48, v48
  v_rcp_f32 v49, v49
  v_rcp_f32 v50, v50
  v_rcp_f32 v51, v51
  v_rcp_f32 v52, v52
  v_rcp_f32 v53, v53
  v_rcp_f32 v54, v54
  v_rcp_f32 v55, v55
  v_pk_mul_f32 v[32:33], v[32:33], v[48:49]
  v_pk_mul_f32 v[34:35], v[34:35], v[50:51]
  v_pk_mul_f32 v[36:37], v[36:37], v[52:53]
  v_pk_mul_f32 v[38:39], v[38:39], v[54:55]
  v_cvt_pk_bf16_f32 v60, v32, v33
  v_cvt_pk_bf16_f32 v61, v34, v35
  v_cvt_pk_bf16_f32 v62, v36, v37
  v_cvt_pk_bf16_f32 v63, v38, v39
  v_cndmask_b32 v60, 0, v60, s[82:83]
  v_cndmask_b32 v61, 0, v61, s[82:83]
  v_cndmask_b32 v62, 0, v62, s[82:83]
  v_cndmask_b32 v63, 0, v63, s[82:83]
  s_nop 1
  v_permlane16_swap_b32 v60, v62
  v_permlane16_swap_b32 v61, v63
  buffer_store_dwordx4 v[60:63], v6, s[16:19], 0 offen offset:3072
  s_lshl_b32 s24, s4, 19
  s_add_u32 s8, s50, s24
  s_addc_u32 s9, s51, 0
  s_mov_b32 s10, 524288
  s_mov_b32 s11, 0x00020000
  v_mov_b32 v4, 0x80000000
  s_lshl_b32 s24, s61, 7
  v_lshrrev_b32 v1, 3, v0
  v_mul_u32_u24 v1, 4, v1
  s_add_u32 s26, s24, s3
  v_add_u32 v1, s26, v1
  v_and_b32 v2, 7, v0
  v_lshrrev_b32 v3, 4, v0
  v_xor_b32 v5, v2, v3
  v_lshlrev_b32 v5, 4, v5
  v_xor_b32 v6, 64, v5
  v_add_u32 v56, 0, v1
  v_cmp_gt_i32 vcc, 0, v56
  v_lshlrev_b32 v56, 10, v56
  v_add_u32 v56, v56, v5
  v_cndmask_b32 v56, v56, v4, vcc
  v_add_u32 v57, 32, v1
  v_cmp_gt_i32 vcc, 0, v57
  v_lshlrev_b32 v57, 10, v57
  v_add_u32 v57, v57, v6
  v_cndmask_b32 v57, v57, v4, vcc
  v_add_u32 v58, 64, v1
  v_cmp_gt_i32 vcc, 0, v58
  v_lshlrev_b32 v58, 10, v58
  v_add_u32 v58, v58, v5
  v_cndmask_b32 v58, v58, v4, vcc
  v_add_u32 v59, 96, v1
  v_cmp_gt_i32 vcc, 0, v59
  v_lshlrev_b32 v59, 10, v59
  v_add_u32 v59, v59, v6
  v_cndmask_b32 v59, v59, v4, vcc
  v_add_u32 v60, 128, v1
  v_cmp_gt_i32 vcc, 0, v60
  v_lshlrev_b32 v60, 10, v60
  v_add_u32 v60, v60, v5
  v_cndmask_b32 v60, v60, v4, vcc
  s_mul_i32 s58, s3, 4352
  s_lshr_b32 s24, s3, 1
  s_and_b32 s25, s3, 1
  v_and_b32 v1, 15, v0
  v_lshrrev_b32 v2, 4, v0
  s_lshl_b32 s26, s24, 4
  v_add_u32 v1, s26, v1
  v_add_u32 v5, 0, v1
  v_bfe_u32 v6, v5, 1, 3
  v_lshlrev_b32 v5, 7, v5
  v_xor_b32 v6, v6, v2
  v_lshlrev_b32 v6, 4, v6
  v_add_u32 v5, v5, v6
  v_mov_b32 v40, v5
  v_xor_b32 v41, 64, v40
  v_add_u32 v5, 1, v1
  v_bfe_u32 v6, v5, 1, 3
  v_lshlrev_b32 v5, 7, v5
  v_xor_b32 v6, v6, v2
  v_lshlrev_b32 v6, 4, v6
  v_add_u32 v5, v5, v6
  v_mov_b32 v42, v5
  v_xor_b32 v43, 64, v42
  v_lshrrev_b32 v5, 4, v0
  v_mul_u32_u24 v6, 5120, v5
  v_bfe_u32 v7, v0, 2, 2
  v_lshlrev_b32 v3, 7, v7
  v_add_u32 v6, v6, v3
  v_lshrrev_b32 v7, 1, v7
  v_and_b32 v5, 1, v5
  v_lshlrev_b32 v5, 1, v5
  v_add_u32 v7, v7, v5
  s_lshl_b32 s26, s25, 1
  v_xor_b32 v7, s26, v7
  v_lshlrev_b32 v7, 5, v7
  v_add_u32 v6, v6, v7
  v_and_b32 v7, 3, v0
  v_lshlrev_b32 v7, 3, v7
  v_add_u32 v6, v6, v7
  v_add_u32 v44, 69632, v6
  v_xor_b32 v45, 32, v44
  s_lshl_b32 s24, s61, 7
  s_cmp_eq_u32 s61, 3
  s_cselect_b32 s26, 31, 63
  v_and_b32 v61, s26, v0
  v_lshlrev_b32 v61, 2, v61
  v_add_u32 v61, s24, v61
  s_waitcnt vmcnt(0)
  s_mov_b32 s27, 0
L_cenp_3:
  v_readfirstlane_b32 s24, v64
  v_readfirstlane_b32 s88, v65
  s_nop 0
  s_and_b32 s25, s24, 63
  s_cmp_eq_u32 s25, 32
  s_cbranch_scc1 L_cenok_4
  s_add_u32 s27, s27, 1
  s_cmp_gt_u32 s27, 400000
  s_cbranch_scc1 L_cenok_4
  s_sleep 4
  global_load_dwordx2 v[64:65], v66, s[48:49] sc1
  s_waitcnt vmcnt(0)
  s_branch L_cenp_3
L_cenok_4:
  s_getreg_b32 s25, hwreg(HW_REG_XCC_ID)
  s_and_b32 s25, s25, 15
  s_mul_i32 s26, s25, s25
  s_lshl_b32 s26, s26, 25
  s_lshl_b32 s25, s25, 13
  s_add_u32 s25, s25, s26
  s_add_u32 s25, s25, 32
  s_cmp_eq_u32 s24, s25
  s_cselect_b32 s89, 1, 0
  s_lshl_b32 s24, s5, 2
  s_add_u32 s24, s24, s3
  s_waitcnt vmcnt(0)
  s_add_u32 s25, s88, 1
  v_mov_b32 v1, s25
  s_lshl_b32 s24, s24, 2
  v_mov_b32 v2, s24
  s_cmp_eq_u32 s89, 0
  s_cbranch_scc1 L_sigs_5
  s_mov_b64 exec, 1
  buffer_store_dword v1, v2, s[84:87], 0 offen offset:0
  s_mov_b64 exec, -1
  s_branch L_sigd_6
L_sigs_5:
  buffer_wbl2 sc1
  s_waitcnt vmcnt(0)
  s_mov_b64 exec, 1
  buffer_store_dword v1, v2, s[84:87], 0 offen offset:0 sc1
  s_mov_b64 exec, -1
L_sigd_6:
  s_lshl_b32 s24, s4, 18
  s_add_u32 s16, s50, s24
  s_addc_u32 s17, s51, 0
  s_add_u32 s16, s16, 4194304
  s_addc_u32 s17, s17, 0
  s_mov_b32 s18, 262144
  s_mov_b32 s19, 0x00020000
  s_add_u32 s25, s88, 1
  s_mov_b32 s27, 0
L_poll_7:
  buffer_load_dword v1, v61, s[84:87], 0 offen sc1
  s_add_u32 s27, s27, 1
  s_cmp_gt_u32 s27, 400000
  s_cbranch_scc1 L_pollx_9
  s_waitcnt vmcnt(0)
  v_cmp_ne_u32 vcc, s25, v1
  s_nop 1
  s_cbranch_vccnz L_poll_7
L_pollx_9:
  s_cmp_eq_u32 s89, 0
  s_cbranch_scc0 L_polld_8
  buffer_inv sc1
  s_waitcnt vmcnt(0)
L_polld_8:
  s_lshr_b32 s30, s60, 1
  s_add_u32 s30, s30, 0
  s_and_b32 s30, s30, 7
  s_lshl_b32 s30, s30, 7
  s_add_u32 m0, s58, 0
  s_nop 0
  buffer_load_dwordx4 v56, s[8:11], s30 offen  lds
  s_add_u32 m0, s58, 1024
  s_nop 0
  buffer_load_dwordx4 v57, s[8:11], s30 offen  lds
  s_add_u32 m0, s58, 2048
  s_nop 0
  buffer_load_dwordx4 v58, s[8:11], s30 offen  lds
  s_add_u32 m0, s58, 3072
  s_nop 0
  buffer_load_dwordx4 v59, s[8:11], s30 offen  lds
  s_add_u32 m0, s58, 4096
  s_mov_b64 exec, 0xff
  buffer_load_dwordx4 v60, s[8:11], s30 offen  lds
  s_mov_b64 exec, -1
  s_waitcnt vmcnt(0)
  v_mov_b32 v8, 0
  v_mov_b32 v9, 0
  v_mov_b32 v10, 0
  v_mov_b32 v11, 0
  v_mov_b32 v12, 0
  v_mov_b32 v13, 0
  v_mov_b32 v14, 0
  v_mov_b32 v15, 0
  v_mov_b32 v16, 0
  v_mov_b32 v17, 0
  v_mov_b32 v18, 0
  v_mov_b32 v19, 0
  v_mov_b32 v20, 0
  v_mov_b32 v21, 0
  v_mov_b32 v22, 0
  v_mov_b32 v23, 0
  v_subrev_u32 v44, 20480, v44
  v_add_u32 v46, 61440, v44
  v_subrev_u32 v45, 20480, v45
  v_add_u32 v47, 61440, v45
  s_barrier
  ds_read_b64_tr_b16 a[28:29], v44 offset:20480
  ds_read_b64_tr_b16 a[30:31], v44 offset:20992
  ds_read_b64_tr_b16 a[32:33], v45 offset:20480
  ds_read_b64_tr_b16 a[34:35], v45 offset:20992
  ds_read_b128 a[0:3], v40 offset:0
  ds_read_b128 a[8:11], v40 offset:8704
  ds_read_b64_tr_b16 a[36:37], v44 offset:21504
  ds_read_b64_tr_b16 a[38:39], v44 offset:22016
  ds_read_b64_tr_b16 a[40:41], v45 offset:21504
  ds_read_b64_tr_b16 a[42:43], v45 offset:22016
  ds_read_b128 a[4:7], v40 offset:4352
  ds_read_b128 a[12:15], v40 offset:13056
  ds_read_b64_tr_b16 a[44:45], v44 offset:22528
  ds_read_b64_tr_b16 a[46:47], v44 offset:23040
  ds_read_b64_tr_b16 a[48:49], v45 offset:22528
  ds_read_b64_tr_b16 a[50:51], v45 offset:23040
  ds_read_b128 a[16:19], v42 offset:0
  ds_read_b64_tr_b16 a[52:53], v44 offset:23552
  ds_read_b64_tr_b16 a[54:55], v44 offset:24064
  ds_read_b64_tr_b16 a[56:57], v45 offset:23552
  ds_read_b64_tr_b16 a[58:59], v45 offset:24064
  ds_read_b128 a[20:23], v42 offset:4352
  ds_read_b64_tr_b16 a[60:61], v44 offset:24576
  ds_read_b64_tr_b16 a[62:63], v44 offset:25088
  ds_read_b64_tr_b16 a[64:65], v45 offset:24576
  ds_read_b64_tr_b16 a[66:67], v45 offset:25088
  ds_read_b128 a[24:27], v42 offset:8704
  s_waitcnt lgkmcnt(0)
  s_barrier
  v_mfma_f32_16x16x32_bf16 v[8:11], a[28:31], a[0:3], v[8:11]
  ds_read_b64_tr_b16 v[88:89], v44 offset:40960
  ds_read_b64_tr_b16 v[90:91], v44 offset:41472
  v_mfma_f32_16x16x32_bf16 v[12:15], a[32:35], a[0:3], v[12:15]
  ds_read_b64_tr_b16 v[92:93], v45 offset:40960
  ds_read_b64_tr_b16 v[94:95], v45 offset:41472
  v_mfma_f32_16x16x32_bf16 v[16:19], a[28:31], a[8:11], v[16:19]
  ds_read_b128 a[68:71], v41 offset:0
  ds_read_b128 a[76:79], v41 offset:8704
  v_mfma_f32_16x16x32_bf16 v[20:23], a[32:35], a[8:11], v[20:23]
  ds_read_b64_tr_b16 v[96:97], v44 offset:41984
  ds_read_b64_tr_b16 v[98:99], v44 offset:42496
  v_mfma_f32_16x16x32_bf16 v[8:11], a[36:39], a[4:7], v[8:11]
  ds_read_b64_tr_b16 v[100:101], v45 offset:41984
  v_mfma_f32_16x16x32_bf16 v[12:15], a[40:43], a[4:7], v[12:15]
  ds_read_b64_tr_b16 v[102:103], v45 offset:42496
  ds_read_b128 a[72:75], v41 offset:4352
  v_mfma_f32_16x16x32_bf16 v[16:19], a[36:39], a[12:15], v[16:19]
  ds_read_b128 a[80:83], v41 offset:13056
  ds_read_b64_tr_b16 v[104:105], v44 offset:43008
  v_mfma_f32_16x16x32_bf16 v[20:23], a[40:43], a[12:15], v[20:23]
  ds_read_b64_tr_b16 v[106:107], v44 offset:43520
  ds_read_b64_tr_b16 v[108:109], v45 offset:43008
  v_mfma_f32_16x16x32_bf16 v[8:11], a[44:47], a[8:11], v[8:11]
  ds_read_b64_tr_b16 v[110:111], v45 offset:43520
  ds_read_b128 a[84:87], v43 offset:0
  v_mfma_f32_16x16x32_bf16 v[12:15], a[48:51], a[8:11], v[12:15]
  ds_read_b64_tr_b16 v[112:113], v44 offset:44032
  v_mfma_f32_16x16x32_bf16 v[16:19], a[44:47], a[16:19], v[16:19]
  ds_read_b64_tr_b16 v[114:115], v44 offset:44544
  ds_read_b64_tr_b16 v[116:117], v45 offset:44032
  v_mfma_f32_16x16x32_bf16 v[20:23], a[48:51], a[16:19], v[20:23]
  ds_read_b64_tr_b16 v[118:119], v45 offset:44544
  ds_read_b128 a[88:91], v43 offset:4352
  v_mfma_f32_16x16x32_bf16 v[8:11], a[52:55], a[12:15], v[8:11]
  ds_read_b64_tr_b16 v[120:121], v44 offset:45056
  ds_read_b64_tr_b16 v[122:123], v44 offset:45568
  v_mfma_f32_16x16x32_bf16 v[12:15], a[56:59], a[12:15], v[12:15]
  ds_read_b64_tr_b16 v[124:125], v45 offset:45056
  ds_read_b64_tr_b16 v[126:127], v45 offset:45568
  v_mfma_f32_16x16x32_bf16 v[16:19], a[52:55], a[20:23], v[16:19]
  ds_read_b128 a[92:95], v43 offset:8704
  v_mfma_f32_16x16x32_bf16 v[20:23], a[56:59], a[20:23], v[20:23]
  v_mfma_f32_16x16x32_bf16 v[8:11], a[60:63], a[16:19], v[8:11]
  v_mfma_f32_16x16x32_bf16 v[12:15], a[64:67], a[16:19], v[12:15]
  v_mfma_f32_16x16x32_bf16 v[16:19], a[60:63], a[24:27], v[16:19]
  v_mfma_f32_16x16x32_bf16 v[20:23], a[64:67], a[24:27], v[20:23]
  s_waitcnt lgkmcnt(0)
  s_barrier
  v_mfma_f32_16x16x32_bf16 v[8:11], v[88:91], a[68:71], v[8:11]
  ds_read_b64_tr_b16 a[28:29], v46 offset:0
  ds_read_b64_tr_b16 a[30:31], v46 offset:512
  v_mfma_f32_16x16x32_bf16 v[12:15], v[92:95], a[68:71], v[12:15]
  ds_read_b64_tr_b16 a[32:33], v47 offset:0
  ds_read_b64_tr_b16 a[34:35], v47 offset:512
  v_mfma_f32_16x16x32_bf16 v[16:19], v[88:91], a[76:79], v[16:19]
  ds_read_b128 a[0:3], v40 offset:17408
  ds_read_b128 a[8:11], v40 offset:26112
  v_mfma_f32_16x16x32_bf16 v[20:23], v[92:95], a[76:79], v[20:23]
  ds_read_b64_tr_b16 a[36:37], v46 offset:1024
  ds_read_b64_tr_b16 a[38:39], v46 offset:1536
  v_mfma_f32_16x16x32_bf16 v[8:11], v[96:99], a[72:75], v[8:11]
  ds_read_b64_tr_b16 a[40:41], v47 offset:1024
  v_mfma_f32_16x16x32_bf16 v[12:15], v[100:103], a[72:75], v[12:15]
  ds_read_b64_tr_b16 a[42:43], v47 offset:1536
  ds_read_b128 a[4:7], v40 offset:21760
  v_mfma_f32_16x16x32_bf16 v[16:19], v[96:99], a[80:83], v[16:19]
  ds_read_b128 a[12:15], v40 offset:30464
  ds_read_b64_tr_b16 a[44:45], v46 offset:2048
  v_mfma_f32_16x16x32_bf16 v[20:23], v[100:103], a[80:83], v[20:23]
  ds_read_b64_tr_b16 a[46:47], v46 offset:2560
  ds_read_b64_tr_b16 a[48:49], v47 offset:2048
  v_mfma_f32_16x16x32_bf16 v[8:11], v[104:107], a[76:79], v[8:11]
  ds_read_b64_tr_b16 a[50:51], v47 offset:2560
  ds_read_b128 a[16:19], v42 offset:17408
  v_mfma_f32_16x16x32_bf16 v[12:15], v[108:111], a[76:79], v[12:15]
  ds_read_b64_tr_b16 a[52:53], v46 offset:3072
  v_mfma_f32_16x16x32_bf16 v[16:19], v[104:107], a[84:87], v[16:19]
  ds_read_b64_tr_b16 a[54:55], v46 offset:3584
  ds_read_b64_tr_b16 a[56:57], v47 offset:3072
  v_mfma_f32_16x16x32_bf16 v[20:23], v[108:111], a[84:87], v[20:23]
  ds_read_b64_tr_b16 a[58:59], v47 offset:3584
  ds_read_b128 a[20:23], v42 offset:21760
  v_mfma_f32_16x16x32_bf16 v[8:11], v[112:115], a[80:83], v[8:11]
  ds_read_b64_tr_b16 a[60:61], v46 offset:4096
  ds_read_b64_tr_b16 a[62:63], v46 offset:4608
  v_mfma_f32_16x16x32_bf16 v[12:15], v[116:119], a[80:83], v[12:15]
  ds_read_b64_tr_b16 a[64:65], v47 offset:4096
  ds_read_b64_tr_b16 a[66:67], v47 offset:4608
  v_mfma_f32_16x16x32_bf16 v[16:19], v[112:115], a[88:91], v[16:19]
  ds_read_b128 a[24:27], v42 offset:26112
  v_mfma_f32_16x16x32_bf16 v[20:23], v[116:119], a[88:91], v[20:23]
  v_mfma_f32_16x16x32_bf16 v[8:11], v[120:123], a[84:87], v[8:11]
  v_mfma_f32_16x16x32_bf16 v[12:15], v[124:127], a[84:87], v[12:15]
  v_mfma_f32_16x16x32_bf16 v[16:19], v[120:123], a[92:95], v[16:19]
  v_mfma_f32_16x16x32_bf16 v[20:23], v[124:127], a[92:95], v[20:23]
  s_waitcnt lgkmcnt(0)
  s_barrier
  v_mfma_f32_16x16x32_bf16 v[8:11], a[28:31], a[0:3], v[8:11]
  ds_read_b64_tr_b16 v[88:89], v46 offset:20480
  ds_read_b64_tr_b16 v[90:91], v46 offset:20992
  v_mfma_f32_16x16x32_bf16 v[12:15], a[32:35], a[0:3], v[12:15]
  ds_read_b64_tr_b16 v[92:93], v47 offset:20480
  ds_read_b64_tr_b16 v[94:95], v47 offset:20992
  v_mfma_f32_16x16x32_bf16 v[16:19], a[28:31], a[8:11], v[16:19]
  ds_read_b128 a[68:71], v41 offset:17408
  ds_read_b128 a[76:79], v41 offset:26112
  v_mfma_f32_16x16x32_bf16 v[20:23], a[32:35], a[8:11], v[20:23]
  s_lshr_b32 s24, s36, 7
  ds_read_b64_tr_b16 v[96:97], v46 offset:21504
  ds_read_b64_tr_b16 v[98:99], v46 offset:22016
  v_mfma_f32_16x16x32_bf16 v[8:11], a[36:39], a[4:7], v[8:11]
  s_sub_u32 s24, 3, s24
  ds_read_b64_tr_b16 v[100:101], v47 offset:21504
  v_mfma_f32_16x16x32_bf16 v[12:15], a[40:43], a[4:7], v[12:15]
  s_and_b32 s24, s24, 7
  ds_read_b64_tr_b16 v[102:103], v47 offset:22016
  ds_read_b128 a[72:75], v41 offset:21760
  v_mfma_f32_16x16x32_bf16 v[16:19], a[36:39], a[12:15], v[16:19]
  s_lshl_b32 s24, s24, 7
  ds_read_b128 a[80:83], v41 offset:30464
  ds_read_b64_tr_b16 v[104:105], v46 offset:22528
  v_mfma_f32_16x16x32_bf16 v[20:23], a[40:43], a[12:15], v[20:23]
  s_lshl_b32 s25, s5, 10
  ds_read_b64_tr_b16 v[106:107], v46 offset:23040
  ds_read_b64_tr_b16 v[108:109], v47 offset:22528
  v_mfma_f32_16x16x32_bf16 v[8:11], a[44:47], a[8:11], v[8:11]
  s_add_u32 s24, s24, s25
  ds_read_b64_tr_b16 v[110:111], v47 offset:23040
  ds_read_b128 a[84:87], v43 offset:17408
  v_mfma_f32_16x16x32_bf16 v[12:15], a[48:51], a[8:11], v[12:15]
  s_add_u32 s25, s60, s3
  ds_read_b64_tr_b16 v[112:113], v46 offset:23552
  v_mfma_f32_16x16x32_bf16 v[16:19], a[44:47], a[16:19], v[16:19]
  s_add_u32 s25, s25, 8
  ds_read_b64_tr_b16 v[114:115], v46 offset:24064
  ds_read_b64_tr_b16 v[116:117], v47 offset:23552
  v_mfma_f32_16x16x32_bf16 v[20:23], a[48:51], a[16:19], v[20:23]
  s_and_b32 s25, s25, 15
  ds_read_b64_tr_b16 v[118:119], v47 offset:24064
  ds_read_b128 a[88:91], v43 offset:21760
  v_mfma_f32_16x16x32_bf16 v[8:11], a[52:55], a[12:15], v[8:11]
  s_lshl_b32 s25, s25, 15
  ds_read_b64_tr_b16 v[120:121], v46 offset:24576
  ds_read_b64_tr_b16 v[122:123], v46 offset:25088
  v_mfma_f32_16x16x32_bf16 v[12:15], a[56:59], a[12:15], v[12:15]
  s_add_u32 s24, s24, s25
  ds_read_b64_tr_b16 v[124:125], v47 offset:24576
  ds_read_b64_tr_b16 v[126:127], v47 offset:25088
  v_mfma_f32_16x16x32_bf16 v[16:19], a[52:55], a[20:23], v[16:19]
  v_lshlrev_b32 v1, 19, v0
  ds_read_b128 a[92:95], v43 offset:26112
  v_mfma_f32_16x16x32_bf16 v[20:23], a[56:59], a[20:23], v[20:23]
  v_add_u32 v1, s24, v1
  v_mfma_f32_16x16x32_bf16 v[8:11], a[60:63], a[16:19], v[8:11]
  s_mov_b64 exec, 0x1f
  v_mfma_f32_16x16x32_bf16 v[12:15], a[64:67], a[16:19], v[12:15]
  global_load_dword v68, v1, s[36:37]
  v_mfma_f32_16x16x32_bf16 v[16:19], a[60:63], a[24:27], v[16:19]
  s_mov_b64 exec, -1
  v_mfma_f32_16x16x32_bf16 v[20:23], a[64:67], a[24:27], v[20:23]
  s_waitcnt lgkmcnt(0)
  s_barrier
  v_mfma_f32_16x16x32_bf16 v[8:11], v[88:91], a[68:71], v[8:11]
  ds_read_b64_tr_b16 a[28:29], v44 offset:0
  ds_read_b64_tr_b16 a[30:31], v44 offset:512
  v_mfma_f32_16x16x32_bf16 v[12:15], v[92:95], a[68:71], v[12:15]
  ds_read_b64_tr_b16 a[32:33], v45 offset:0
  ds_read_b64_tr_b16 a[34:35], v45 offset:512
  v_mfma_f32_16x16x32_bf16 v[16:19], v[88:91], a[76:79], v[16:19]
  ds_read_b128 a[0:3], v40 offset:0
  ds_read_b128 a[8:11], v40 offset:8704
  v_mfma_f32_16x16x32_bf16 v[20:23], v[92:95], a[76:79], v[20:23]
  ds_read_b64_tr_b16 a[36:37], v44 offset:1024
  ds_read_b64_tr_b16 a[38:39], v44 offset:1536
  v_mfma_f32_16x16x32_bf16 v[8:11], v[96:99], a[72:75], v[8:11]
  ds_read_b64_tr_b16 a[40:41], v45 offset:1024
  v_mfma_f32_16x16x32_bf16 v[12:15], v[100:103], a[72:75], v[12:15]
  ds_read_b64_tr_b16 a[42:43], v45 offset:1536
  ds_read_b128 a[4:7], v40 offset:4352
  v_mfma_f32_16x16x32_bf16 v[16:19], v[96:99], a[80:83], v[16:19]
  ds_read_b128 a[12:15], v40 offset:13056
  ds_read_b64_tr_b16 a[44:45], v44 offset:2048
  v_mfma_f32_16x16x32_bf16 v[20:23], v[100:103], a[80:83], v[20:23]
  ds_read_b64_tr_b16 a[46:47], v44 offset:2560
  ds_read_b64_tr_b16 a[48:49], v45 offset:2048
  v_mfma_f32_16x16x32_bf16 v[8:11], v[104:107], a[76:79], v[8:11]
  ds_read_b64_tr_b16 a[50:51], v45 offset:2560
  ds_read_b128 a[16:19], v42 offset:0
  v_mfma_f32_16x16x32_bf16 v[12:15], v[108:111], a[76:79], v[12:15]
  ds_read_b64_tr_b16 a[52:53], v44 offset:3072
  v_mfma_f32_16x16x32_bf16 v[16:19], v[104:107], a[84:87], v[16:19]
  ds_read_b64_tr_b16 a[54:55], v44 offset:3584
  ds_read_b64_tr_b16 a[56:57], v45 offset:3072
  v_mfma_f32_16x16x32_bf16 v[20:23], v[108:111], a[84:87], v[20:23]
  ds_read_b64_tr_b16 a[58:59], v45 offset:3584
  ds_read_b128 a[20:23], v42 offset:4352
  v_mfma_f32_16x16x32_bf16 v[8:11], v[112:115], a[80:83], v[8:11]
  ds_read_b64_tr_b16 a[60:61], v44 offset:4096
  ds_read_b64_tr_b16 a[62:63], v44 offset:4608
  v_mfma_f32_16x16x32_bf16 v[12:15], v[116:119], a[80:83], v[12:15]
  ds_read_b64_tr_b16 a[64:65], v45 offset:4096
  ds_read_b64_tr_b16 a[66:67], v45 offset:4608
  v_mfma_f32_16x16x32_bf16 v[16:19], v[112:115], a[88:91], v[16:19]
  ds_read_b128 a[24:27], v42 offset:8704
  v_mfma_f32_16x16x32_bf16 v[20:23], v[116:119], a[88:91], v[20:23]
  v_mfma_f32_16x16x32_bf16 v[8:11], v[120:123], a[84:87], v[8:11]
  v_mfma_f32_16x16x32_bf16 v[12:15], v[124:127], a[84:87], v[12:15]
  v_mfma_f32_16x16x32_bf16 v[16:19], v[120:123], a[92:95], v[16:19]
  v_mfma_f32_16x16x32_bf16 v[20:23], v[124:127], a[92:95], v[20:23]
  s_waitcnt lgkmcnt(0)
  s_barrier
  v_mfma_f32_16x16x32_bf16 v[8:11], a[28:31], a[0:3], v[8:11]
  ds_read_b64_tr_b16 v[88:89], v44 offset:20480
  ds_read_b64_tr_b16 v[90:91], v44 offset:20992
  v_mfma_f32_16x16x32_bf16 v[12:15], a[32:35], a[0:3], v[12:15]
  ds_read_b64_tr_b16 v[92:93], v45 offset:20480
  ds_read_b64_tr_b16 v[94:95], v45 offset:20992
  v_mfma_f32_16x16x32_bf16 v[16:19], a[28:31], a[8:11], v[16:19]
  ds_read_b128 a[68:71], v41 offset:0
  ds_read_b128 a[76:79], v41 offset:8704
  v_mfma_f32_16x16x32_bf16 v[20:23], a[32:35], a[8:11], v[20:23]
  ds_read_b64_tr_b16 v[96:97], v44 offset:21504
  ds_read_b64_tr_b16 v[98:99], v44 offset:22016
  v_mfma_f32_16x16x32_bf16 v[8:11], a[36:39], a[4:7], v[8:11]
  ds_read_b64_tr_b16 v[100:101], v45 offset:21504
  v_mfma_f32_16x16x32_bf16 v[12:15], a[40:43], a[4:7], v[12:15]
  ds_read_b64_tr_b16 v[102:103], v45 offset:22016
  ds_read_b128 a[72:75], v41 offset:4352
  v_mfma_f32_16x16x32_bf16 v[16:19], a[36:39], a[12:15], v[16:19]
  ds_read_b128 a[80:83], v41 offset:13056
  ds_read_b64_tr_b16 v[104:105], v44 offset:22528
  v_mfma_f32_16x16x32_bf16 v[20:23], a[40:43], a[12:15], v[20:23]
  ds_read_b64_tr_b16 v[106:107], v44 offset:23040
  ds_read_b64_tr_b16 v[108:109], v45 offset:22528
  v_mfma_f32_16x16x32_bf16 v[8:11], a[44:47], a[8:11], v[8:11]
  ds_read_b64_tr_b16 v[110:111], v45 offset:23040
  ds_read_b128 a[84:87], v43 offset:0
  v_mfma_f32_16x16x32_bf16 v[12:15], a[48:51], a[8:11], v[12:15]
  ds_read_b64_tr_b16 v[112:113], v44 offset:23552
  v_mfma_f32_16x16x32_bf16 v[16:19], a[44:47], a[16:19], v[16:19]
  ds_read_b64_tr_b16 v[114:115], v44 offset:24064
  ds_read_b64_tr_b16 v[116:117], v45 offset:23552
  v_mfma_f32_16x16x32_bf16 v[20:23], a[48:51], a[16:19], v[20:23]
  ds_read_b64_tr_b16 v[118:119], v45 offset:24064
  ds_read_b128 a[88:91], v43 offset:4352
  v_mfma_f32_16x16x32_bf16 v[8:11], a[52:55], a[12:15], v[8:11]
  ds_read_b64_tr_b16 v[120:121], v44 offset:24576
  ds_read_b64_tr_b16 v[122:123], v44 offset:25088
  v_mfma_f32_16x16x32_bf16 v[12:15], a[56:59], a[12:15], v[12:15]
  ds_read_b64_tr_b16 v[124:125], v45 offset:24576
  ds_read_b64_tr_b16 v[126:127], v45 offset:25088
  v_mfma_f32_16x16x32_bf16 v[16:19], a[52:55], a[20:23], v[16:19]
  ds_read_b128 a[92:95], v43 offset:8704
  v_mfma_f32_16x16x32_bf16 v[20:23], a[56:59], a[20:23], v[20:23]
  v_mfma_f32_16x16x32_bf16 v[8:11], a[60:63], a[16:19], v[8:11]
  v_mfma_f32_16x16x32_bf16 v[12:15], a[64:67], a[16:19], v[12:15]
  v_mfma_f32_16x16x32_bf16 v[16:19], a[60:63], a[24:27], v[16:19]
  v_mfma_f32_16x16x32_bf16 v[20:23], a[64:67], a[24:27], v[20:23]
  s_waitcnt lgkmcnt(0)
  s_barrier
  v_mfma_f32_16x16x32_bf16 v[8:11], v[88:91], a[68:71], v[8:11]
  ds_read_b64_tr_b16 a[28:29], v44 offset:40960
  ds_read_b64_tr_b16 a[30:31], v44 offset:41472
  v_mfma_f32_16x16x32_bf16 v[12:15], v[92:95], a[68:71], v[12:15]
  ds_read_b64_tr_b16 a[32:33], v45 offset:40960
  ds_read_b64_tr_b16 a[34:35], v45 offset:41472
  v_mfma_f32_16x16x32_bf16 v[16:19], v[88:91], a[76:79], v[16:19]
  ds_read_b128 a[0:3], v40 offset:17408
  ds_read_b128 a[8:11], v40 offset:26112
  v_mfma_f32_16x16x32_bf16 v[20:23], v[92:95], a[76:79], v[20:23]
  s_lshr_b32 s24, s36, 7
  ds_read_b64_tr_b16 a[36:37], v44 offset:41984
  ds_read_b64_tr_b16 a[38:39], v44 offset:42496
  v_mfma_f32_16x16x32_bf16 v[8:11], v[96:99], a[72:75], v[8:11]
  s_sub_u32 s24, 3, s24
  ds_read_b64_tr_b16 a[40:41], v45 offset:41984
  v_mfma_f32_16x16x32_bf16 v[12:15], v[100:103], a[72:75], v[12:15]
  s_and_b32 s24, s24, 7
  ds_read_b64_tr_b16 a[42:43], v45 offset:42496
  ds_read_b128 a[4:7], v40 offset:21760
  v_mfma_f32_16x16x32_bf16 v[16:19], v[96:99], a[80:83], v[16:19]
  s_lshl_b32 s24, s24, 7
  ds_read_b128 a[12:15], v40 offset:30464
  ds_read_b64_tr_b16 a[44:45], v44 offset:43008
  v_mfma_f32_16x16x32_bf16 v[20:23], v[100:103], a[80:83], v[20:23]
  s_lshl_b32 s25, s5, 10
  ds_read_b64_tr_b16 a[46:47], v44 offset:43520
  ds_read_b64_tr_b16 a[48:49], v45 offset:43008
  v_mfma_f32_16x16x32_bf16 v[8:11], v[104:107], a[76:79], v[8:11]
  s_add_u32 s24, s24, s25
  ds_read_b64_tr_b16 a[50:51], v45 offset:43520
  ds_read_b128 a[16:19], v42 offset:17408
  v_mfma_f32_16x16x32_bf16 v[12:15], v[108:111], a[76:79], v[12:15]
  s_add_u32 s25, s60, s3
  ds_read_b64_tr_b16 a[52:53], v44 offset:44032
  v_mfma_f32_16x16x32_bf16 v[16:19], v[104:107], a[84:87], v[16:19]
  s_add_u32 s25, s25, 12
  ds_read_b64_tr_b16 a[54:55], v44 offset:44544
  ds_read_b64_tr_b16 a[56:57], v45 offset:44032
  v_mfma_f32_16x16x32_bf16 v[20:23], v[108:111], a[84:87], v[20:23]
  s_and_b32 s25, s25, 15
  ds_read_b64_tr_b16 a[58:59], v45 offset:44544
  ds_read_b128 a[20:23], v42 offset:21760
  v_mfma_f32_16x16x32_bf16 v[8:11], v[112:115], a[80:83], v[8:11]
  s_lshl_b32 s25, s25, 15
  ds_read_b64_tr_b16 a[60:61], v44 offset:45056
  ds_read_b64_tr_b16 a[62:63], v44 offset:45568
  v_mfma_f32_16x16x32_bf16 v[12:15], v[116:119], a[80:83], v[12:15]
  s_add_u32 s24, s24, s25
  ds_read_b64_tr_b16 a[64:65], v45 offset:45056
  ds_read_b64_tr_b16 a[66:67], v45 offset:45568
  v_mfma_f32_16x16x32_bf16 v[16:19], v[112:115], a[88:91], v[16:19]
  v_lshlrev_b32 v1, 19, v0
  ds_read_b128 a[24:27], v42 offset:26112
  v_mfma_f32_16x16x32_bf16 v[20:23], v[116:119], a[88:91], v[20:23]
  v_add_u32 v1, s24, v1
  v_mfma_f32_16x16x32_bf16 v[8:11], v[120:123], a[84:87], v[8:11]
  s_mov_b64 exec, 0x1f
  v_mfma_f32_16x16x32_bf16 v[12:15], v[124:127], a[84:87], v[12:15]
  global_load_dword v68, v1, s[36:37]
  v_mfma_f32_16x16x32_bf16 v[16:19], v[120:123], a[92:95], v[16:19]
  s_mov_b64 exec, -1
  v_mfma_f32_16x16x32_bf16 v[20:23], v[124:127], a[92:95], v[20:23]
  s_waitcnt lgkmcnt(0)
  s_barrier
  v_mfma_f32_16x16x32_bf16 v[8:11], a[28:31], a[0:3], v[8:11]
  ds_read_b64_tr_b16 v[88:89], v46 offset:0
  ds_read_b64_tr_b16 v[90:91], v46 offset:512
  v_mfma_f32_16x16x32_bf16 v[12:15], a[32:35], a[0:3], v[12:15]
  ds_read_b64_tr_b16 v[92:93], v47 offset:0
  ds_read_b64_tr_b16 v[94:95], v47 offset:512
  v_mfma_f32_16x16x32_bf16 v[16:19], a[28:31], a[8:11], v[16:19]
  ds_read_b128 a[68:71], v41 offset:17408
  ds_read_b128 a[76:79], v41 offset:26112
  v_mfma_f32_16x16x32_bf16 v[20:23], a[32:35], a[8:11], v[20:23]
  ds_read_b64_tr_b16 v[96:97], v46 offset:1024
  ds_read_b64_tr_b16 v[98:99], v46 offset:1536
  v_mfma_f32_16x16x32_bf16 v[8:11], a[36:39], a[4:7], v[8:11]
  ds_read_b64_tr_b16 v[100:101], v47 offset:1024
  v_mfma_f32_16x16x32_bf16 v[12:15], a[40:43], a[4:7], v[12:15]
  ds_read_b64_tr_b16 v[102:103], v47 offset:1536
  ds_read_b128 a[72:75], v41 offset:21760
  v_mfma_f32_16x16x32_bf16 v[16:19], a[36:39], a[12:15], v[16:19]
  ds_read_b128 a[80:83], v41 offset:30464
  ds_read_b64_tr_b16 v[104:105], v46 offset:2048
  v_mfma_f32_16x16x32_bf16 v[20:23], a[40:43], a[12:15], v[20:23]
  ds_read_b64_tr_b16 v[106:107], v46 offset:2560
  ds_read_b64_tr_b16 v[108:109], v47 offset:2048
  v_mfma_f32_16x16x32_bf16 v[8:11], a[44:47], a[8:11], v[8:11]
  ds_read_b64_tr_b16 v[110:111], v47 offset:2560
  ds_read_b128 a[84:87], v43 offset:17408
  v_mfma_f32_16x16x32_bf16 v[12:15], a[48:51], a[8:11], v[12:15]
  ds_read_b64_tr_b16 v[112:113], v46 offset:3072
  v_mfma_f32_16x16x32_bf16 v[16:19], a[44:47], a[16:19], v[16:19]
  ds_read_b64_tr_b16 v[114:115], v46 offset:3584
  ds_read_b64_tr_b16 v[116:117], v47 offset:3072
  v_mfma_f32_16x16x32_bf16 v[20:23], a[48:51], a[16:19], v[20:23]
  ds_read_b64_tr_b16 v[118:119], v47 offset:3584
  ds_read_b128 a[88:91], v43 offset:21760
  v_mfma_f32_16x16x32_bf16 v[8:11], a[52:55], a[12:15], v[8:11]
  ds_read_b64_tr_b16 v[120:121], v46 offset:4096
  ds_read_b64_tr_b16 v[122:123], v46 offset:4608
  v_mfma_f32_16x16x32_bf16 v[12:15], a[56:59], a[12:15], v[12:15]
  ds_read_b64_tr_b16 v[124:125], v47 offset:4096
  ds_read_b64_tr_b16 v[126:127], v47 offset:4608
  v_mfma_f32_16x16x32_bf16 v[16:19], a[52:55], a[20:23], v[16:19]
  ds_read_b128 a[92:95], v43 offset:26112
  v_mfma_f32_16x16x32_bf16 v[20:23], a[56:59], a[20:23], v[20:23]
  v_mfma_f32_16x16x32_bf16 v[8:11], a[60:63], a[16:19], v[8:11]
  v_mfma_f32_16x16x32_bf16 v[12:15], a[64:67], a[16:19], v[12:15]
  v_mfma_f32_16x16x32_bf16 v[16:19], a[60:63], a[24:27], v[16:19]
  v_mfma_f32_16x16x32_bf16 v[20:23], a[64:67], a[24:27], v[20:23]
  s_waitcnt lgkmcnt(0)
  s_barrier
  v_mfma_f32_16x16x32_bf16 v[8:11], v[88:91], a[68:71], v[8:11]
  ds_read_b64_tr_b16 a[28:29], v46 offset:20480
  ds_read_b64_tr_b16 a[30:31], v46 offset:20992
  v_mfma_f32_16x16x32_bf16 v[12:15], v[92:95], a[68:71], v[12:15]
  ds_read_b64_tr_b16 a[32:33], v47 offset:20480
  ds_read_b64_tr_b16 a[34:35], v47 offset:20992
  v_mfma_f32_16x16x32_bf16 v[16:19], v[88:91], a[76:79], v[16:19]
  ds_read_b128 a[0:3], v40 offset:0
  ds_read_b128 a[8:11], v40 offset:8704
  v_mfma_f32_16x16x32_bf16 v[20:23], v[92:95], a[76:79], v[20:23]
  ds_read_b64_tr_b16 a[36:37], v46 offset:21504
  ds_read_b64_tr_b16 a[38:39], v46 offset:22016
  v_mfma_f32_16x16x32_bf16 v[8:11], v[96:99], a[72:75], v[8:11]
  ds_read_b64_tr_b16 a[40:41], v47 offset:21504
  v_mfma_f32_16x16x32_bf16 v[12:15], v[100:103], a[72:75], v[12:15]
  ds_read_b64_tr_b16 a[42:43], v47 offset:22016
  ds_read_b128 a[4:7], v40 offset:4352
  v_mfma_f32_16x16x32_bf16 v[16:19], v[96:99], a[80:83], v[16:19]
  ds_read_b128 a[12:15], v40 offset:13056
  ds_read_b64_tr_b16 a[44:45], v46 offset:22528
  v_mfma_f32_16x16x32_bf16 v[20:23], v[100:103], a[80:83], v[20:23]
  ds_read_b64_tr_b16 a[46:47], v46 offset:23040
  ds_read_b64_tr_b16 a[48:49], v47 offset:22528
  v_mfma_f32_16x16x32_bf16 v[8:11], v[104:107], a[76:79], v[8:11]
  ds_read_b64_tr_b16 a[50:51], v47 offset:23040
  ds_read_b128 a[16:19], v42 offset:0
  v_mfma_f32_16x16x32_bf16 v[12:15], v[108:111], a[76:79], v[12:15]
  ds_read_b64_tr_b16 a[52:53], v46 offset:23552
  v_mfma_f32_16x16x32_bf16 v[16:19], v[104:107], a[84:87], v[16:19]
  ds_read_b64_tr_b16 a[54:55], v46 offset:24064
  ds_read_b64_tr_b16 a[56:57], v47 offset:23552
  v_mfma_f32_16x16x32_bf16 v[20:23], v[108:111], a[84:87], v[20:23]
  ds_read_b64_tr_b16 a[58:59], v47 offset:24064
  ds_read_b128 a[20:23], v42 offset:4352
  v_mfma_f32_16x16x32_bf16 v[8:11], v[112:115], a[80:83], v[8:11]
  ds_read_b64_tr_b16 a[60:61], v46 offset:24576
  ds_read_b64_tr_b16 a[62:63], v46 offset:25088
  v_mfma_f32_16x16x32_bf16 v[12:15], v[116:119], a[80:83], v[12:15]
  ds_read_b64_tr_b16 a[64:65], v47 offset:24576
  ds_read_b64_tr_b16 a[66:67], v47 offset:25088
  v_mfma_f32_16x16x32_bf16 v[16:19], v[112:115], a[88:91], v[16:19]
  ds_read_b128 a[24:27], v42 offset:8704
  v_mfma_f32_16x16x32_bf16 v[20:23], v[116:119], a[88:91], v[20:23]
  v_mfma_f32_16x16x32_bf16 v[8:11], v[120:123], a[84:87], v[8:11]
  v_mfma_f32_16x16x32_bf16 v[12:15], v[124:127], a[84:87], v[12:15]
  v_mfma_f32_16x16x32_bf16 v[16:19], v[120:123], a[92:95], v[16:19]
  v_mfma_f32_16x16x32_bf16 v[20:23], v[124:127], a[92:95], v[20:23]
  s_waitcnt lgkmcnt(0)
  s_barrier
  v_mfma_f32_16x16x32_bf16 v[8:11], a[28:31], a[0:3], v[8:11]
  ds_read_b64_tr_b16 v[88:89], v44 offset:0
  ds_read_b64_tr_b16 v[90:91], v44 offset:512
  v_mfma_f32_16x16x32_bf16 v[12:15], a[32:35], a[0:3], v[12:15]
  ds_read_b64_tr_b16 v[92:93], v45 offset:0
  ds_read_b64_tr_b16 v[94:95], v45 offset:512
  v_mfma_f32_16x16x32_bf16 v[16:19], a[28:31], a[8:11], v[16:19]
  ds_read_b128 a[68:71], v41 offset:0
  ds_read_b128 a[76:79], v41 offset:8704
  v_mfma_f32_16x16x32_bf16 v[20:23], a[32:35], a[8:11], v[20:23]
  ds_read_b64_tr_b16 v[96:97], v44 offset:1024
  ds_read_b64_tr_b16 v[98:99], v44 offset:1536
  v_mfma_f32_16x16x32_bf16 v[8:11], a[36:39], a[4:7], v[8:11]
  ds_read_b64_tr_b16 v[100:101], v45 offset:1024
  v_mfma_f32_16x16x32_bf16 v[12:15], a[40:43], a[4:7], v[12:15]
  ds_read_b64_tr_b16 v[102:103], v45 offset:1536
  ds_read_b128 a[72:75], v41 offset:4352
  v_mfma_f32_16x16x32_bf16 v[16:19], a[36:39], a[12:15], v[16:19]
  ds_read_b128 a[80:83], v41 offset:13056
  ds_read_b64_tr_b16 v[104:105], v44 offset:2048
  v_mfma_f32_16x16x32_bf16 v[20:23], a[40:43], a[12:15], v[20:23]
  ds_read_b64_tr_b16 v[106:107], v44 offset:2560
  ds_read_b64_tr_b16 v[108:109], v45 offset:2048
  v_mfma_f32_16x16x32_bf16 v[8:11], a[44:47], a[8:11], v[8:11]
  ds_read_b64_tr_b16 v[110:111], v45 offset:2560
  ds_read_b128 a[84:87], v43 offset:0
  v_mfma_f32_16x16x32_bf16 v[12:15], a[48:51], a[8:11], v[12:15]
  ds_read_b64_tr_b16 v[112:113], v44 offset:3072
  v_mfma_f32_16x16x32_bf16 v[16:19], a[44:47], a[16:19], v[16:19]
  ds_read_b64_tr_b16 v[114:115], v44 offset:3584
  ds_read_b64_tr_b16 v[116:117], v45 offset:3072
  v_mfma_f32_16x16x32_bf16 v[20:23], a[48:51], a[16:19], v[20:23]
  ds_read_b64_tr_b16 v[118:119], v45 offset:3584
  ds_read_b128 a[88:91], v43 offset:4352
  v_mfma_f32_16x16x32_bf16 v[8:11], a[52:55], a[12:15], v[8:11]
  ds_read_b64_tr_b16 v[120:121], v44 offset:4096
  ds_read_b64_tr_b16 v[122:123], v44 offset:4608
  v_mfma_f32_16x16x32_bf16 v[12:15], a[56:59], a[12:15], v[12:15]
  ds_read_b64_tr_b16 v[124:125], v45 offset:4096
  ds_read_b64_tr_b16 v[126:127], v45 offset:4608
  v_mfma_f32_16x16x32_bf16 v[16:19], a[52:55], a[20:23], v[16:19]
  ds_read_b128 a[92:95], v43 offset:8704
  v_mfma_f32_16x16x32_bf16 v[20:23], a[56:59], a[20:23], v[20:23]
  v_mfma_f32_16x16x32_bf16 v[8:11], a[60:63], a[16:19], v[8:11]
  v_mfma_f32_16x16x32_bf16 v[12:15], a[64:67], a[16:19], v[12:15]
  v_mfma_f32_16x16x32_bf16 v[16:19], a[60:63], a[24:27], v[16:19]
  v_mfma_f32_16x16x32_bf16 v[20:23], a[64:67], a[24:27], v[20:23]
  s_waitcnt lgkmcnt(0)
  s_barrier
  v_mfma_f32_16x16x32_bf16 v[8:11], v[88:91], a[68:71], v[8:11]
  ds_read_b64_tr_b16 a[28:29], v44 offset:20480
  ds_read_b64_tr_b16 a[30:31], v44 offset:20992
  v_mfma_f32_16x16x32_bf16 v[12:15], v[92:95], a[68:71], v[12:15]
  ds_read_b64_tr_b16 a[32:33], v45 offset:20480
  ds_read_b64_tr_b16 a[34:35], v45 offset:20992
  v_mfma_f32_16x16x32_bf16 v[16:19], v[88:91], a[76:79], v[16:19]
  ds_read_b128 a[0:3], v40 offset:17408
  ds_read_b128 a[8:11], v40 offset:26112
  v_mfma_f32_16x16x32_bf16 v[20:23], v[92:95], a[76:79], v[20:23]
  ds_read_b64_tr_b16 a[36:37], v44 offset:21504
  ds_read_b64_tr_b16 a[38:39], v44 offset:22016
  v_mfma_f32_16x16x32_bf16 v[8:11], v[96:99], a[72:75], v[8:11]
  ds_read_b64_tr_b16 a[40:41], v45 offset:21504
  v_mfma_f32_16x16x32_bf16 v[12:15], v[100:103], a[72:75], v[12:15]
  ds_read_b64_tr_b16 a[42:43], v45 offset:22016
  ds_read_b128 a[4:7], v40 offset:21760
  v_mfma_f32_16x16x32_bf16 v[16:19], v[96:99], a[80:83], v[16:19]
  ds_read_b128 a[12:15], v40 offset:30464
  ds_read_b64_tr_b16 a[44:45], v44 offset:22528
  v_mfma_f32_16x16x32_bf16 v[20:23], v[100:103], a[80:83], v[20:23]
  ds_read_b64_tr_b16 a[46:47], v44 offset:23040
  ds_read_b64_tr_b16 a[48:49], v45 offset:22528
  v_mfma_f32_16x16x32_bf16 v[8:11], v[104:107], a[76:79], v[8:11]
  ds_read_b64_tr_b16 a[50:51], v45 offset:23040
  ds_read_b128 a[16:19], v42 offset:17408
  v_mfma_f32_16x16x32_bf16 v[12:15], v[108:111], a[76:79], v[12:15]
  ds_read_b64_tr_b16 a[52:53], v44 offset:23552
  v_mfma_f32_16x16x32_bf16 v[16:19], v[104:107], a[84:87], v[16:19]
  ds_read_b64_tr_b16 a[54:55], v44 offset:24064
  ds_read_b64_tr_b16 a[56:57], v45 offset:23552
  v_mfma_f32_16x16x32_bf16 v[20:23], v[108:111], a[84:87], v[20:23]
  ds_read_b64_tr_b16 a[58:59], v45 offset:24064
  ds_read_b128 a[20:23], v42 offset:21760
  v_mfma_f32_16x16x32_bf16 v[8:11], v[112:115], a[80:83], v[8:11]
  ds_read_b64_tr_b16 a[60:61], v44 offset:24576
  ds_read_b64_tr_b16 a[62:63], v44 offset:25088
  v_mfma_f32_16x16x32_bf16 v[12:15], v[116:119], a[80:83], v[12:15]
  ds_read_b64_tr_b16 a[64:65], v45 offset:24576
  ds_read_b64_tr_b16 a[66:67], v45 offset:25088
  v_mfma_f32_16x16x32_bf16 v[16:19], v[112:115], a[88:91], v[16:19]
  ds_read_b128 a[24:27], v42 offset:26112
  v_mfma_f32_16x16x32_bf16 v[20:23], v[116:119], a[88:91], v[20:23]
  v_mfma_f32_16x16x32_bf16 v[8:11], v[120:123], a[84:87], v[8:11]
  v_mfma_f32_16x16x32_bf16 v[12:15], v[124:127], a[84:87], v[12:15]
  v_mfma_f32_16x16x32_bf16 v[16:19], v[120:123], a[92:95], v[16:19]
  v_mfma_f32_16x16x32_bf16 v[20:23], v[124:127], a[92:95], v[20:23]
  s_waitcnt lgkmcnt(0)
  s_barrier
  v_mfma_f32_16x16x32_bf16 v[8:11], a[28:31], a[0:3], v[8:11]
  ds_read_b64_tr_b16 v[88:89], v44 offset:40960
  ds_read_b64_tr_b16 v[90:91], v44 offset:41472
  v_mfma_f32_16x16x32_bf16 v[12:15], a[32:35], a[0:3], v[12:15]
  ds_read_b64_tr_b16 v[92:93], v45 offset:40960
  ds_read_b64_tr_b16 v[94:95], v45 offset:41472
  v_mfma_f32_16x16x32_bf16 v[16:19], a[28:31], a[8:11], v[16:19]
  ds_read_b128 a[68:71], v41 offset:17408
  ds_read_b128 a[76:79], v41 offset:26112
  v_mfma_f32_16x16x32_bf16 v[20:23], a[32:35], a[8:11], v[20:23]
  ds_read_b64_tr_b16 v[96:97], v44 offset:41984
  ds_read_b64_tr_b16 v[98:99], v44 offset:42496
  v_mfma_f32_16x16x32_bf16 v[8:11], a[36:39], a[4:7], v[8:11]
  ds_read_b64_tr_b16 v[100:101], v45 offset:41984
  v_mfma_f32_16x16x32_bf16 v[12:15], a[40:43], a[4:7], v[12:15]
  ds_read_b64_tr_b16 v[102:103], v45 offset:42496
  ds_read_b128 a[72:75], v41 offset:21760
  v_mfma_f32_16x16x32_bf16 v[16:19], a[36:39], a[12:15], v[16:19]
  ds_read_b128 a[80:83], v41 offset:30464
  ds_read_b64_tr_b16 v[104:105], v44 offset:43008
  v_mfma_f32_16x16x32_bf16 v[20:23], a[40:43], a[12:15], v[20:23]
  ds_read_b64_tr_b16 v[106:107], v44 offset:43520
  ds_read_b64_tr_b16 v[108:109], v45 offset:43008
  v_mfma_f32_16x16x32_bf16 v[8:11], a[44:47], a[8:11], v[8:11]
  ds_read_b64_tr_b16 v[110:111], v45 offset:43520
  ds_read_b128 a[84:87], v43 offset:17408
  v_mfma_f32_16x16x32_bf16 v[12:15], a[48:51], a[8:11], v[12:15]
  ds_read_b64_tr_b16 v[112:113], v44 offset:44032
  v_mfma_f32_16x16x32_bf16 v[16:19], a[44:47], a[16:19], v[16:19]
  ds_read_b64_tr_b16 v[114:115], v44 offset:44544
  ds_read_b64_tr_b16 v[116:117], v45 offset:44032
  v_mfma_f32_16x16x32_bf16 v[20:23], a[48:51], a[16:19], v[20:23]
  ds_read_b64_tr_b16 v[118:119], v45 offset:44544
  ds_read_b128 a[88:91], v43 offset:21760
  v_mfma_f32_16x16x32_bf16 v[8:11], a[52:55], a[12:15], v[8:11]
  ds_read_b64_tr_b16 v[120:121], v44 offset:45056
  ds_read_b64_tr_b16 v[122:123], v44 offset:45568
  v_mfma_f32_16x16x32_bf16 v[12:15], a[56:59], a[12:15], v[12:15]
  ds_read_b64_tr_b16 v[124:125], v45 offset:45056
  ds_read_b64_tr_b16 v[126:127], v45 offset:45568
  v_mfma_f32_16x16x32_bf16 v[16:19], a[52:55], a[20:23], v[16:19]
  ds_read_b128 a[92:95], v43 offset:26112
  v_mfma_f32_16x16x32_bf16 v[20:23], a[56:59], a[20:23], v[20:23]
  v_mfma_f32_16x16x32_bf16 v[8:11], a[60:63], a[16:19], v[8:11]
  v_mfma_f32_16x16x32_bf16 v[12:15], a[64:67], a[16:19], v[12:15]
  v_mfma_f32_16x16x32_bf16 v[16:19], a[60:63], a[24:27], v[16:19]
  v_mfma_f32_16x16x32_bf16 v[20:23], a[64:67], a[24:27], v[20:23]
  s_waitcnt lgkmcnt(0)
  s_barrier
  v_mfma_f32_16x16x32_bf16 v[8:11], v[88:91], a[68:71], v[8:11]
  ds_read_b64_tr_b16 a[28:29], v46 offset:0
  ds_read_b64_tr_b16 a[30:31], v46 offset:512
  v_mfma_f32_16x16x32_bf16 v[12:15], v[92:95], a[68:71], v[12:15]
  ds_read_b64_tr_b16 a[32:33], v47 offset:0
  ds_read_b64_tr_b16 a[34:35], v47 offset:512
  v_mfma_f32_16x16x32_bf16 v[16:19], v[88:91], a[76:79], v[16:19]
  ds_read_b128 a[0:3], v40 offset:0
  ds_read_b128 a[8:11], v40 offset:8704
  v_mfma_f32_16x16x32_bf16 v[20:23], v[92:95], a[76:79], v[20:23]
  ds_read_b64_tr_b16 a[36:37], v46 offset:1024
  ds_read_b64_tr_b16 a[38:39], v46 offset:1536
  v_mfma_f32_16x16x32_bf16 v[8:11], v[96:99], a[72:75], v[8:11]
  ds_read_b64_tr_b16 a[40:41], v47 offset:1024
  v_mfma_f32_16x16x32_bf16 v[12:15], v[100:103], a[72:75], v[12:15]
  ds_read_b64_tr_b16 a[42:43], v47 offset:1536
  ds_read_b128 a[4:7], v40 offset:4352
  v_mfma_f32_16x16x32_bf16 v[16:19], v[96:99], a[80:83], v[16:19]
  ds_read_b128 a[12:15], v40 offset:13056
  ds_read_b64_tr_b16 a[44:45], v46 offset:2048
  v_mfma_f32_16x16x32_bf16 v[20:23], v[100:103], a[80:83], v[20:23]
  ds_read_b64_tr_b16 a[46:47], v46 offset:2560
  ds_read_b64_tr_b16 a[48:49], v47 offset:2048
  v_mfma_f32_16x16x32_bf16 v[8:11], v[104:107], a[76:79], v[8:11]
  ds_read_b64_tr_b16 a[50:51], v47 offset:2560
  ds_read_b128 a[16:19], v42 offset:0
  v_mfma_f32_16x16x32_bf16 v[12:15], v[108:111], a[76:79], v[12:15]
  ds_read_b64_tr_b16 a[52:53], v46 offset:3072
  v_mfma_f32_16x16x32_bf16 v[16:19], v[104:107], a[84:87], v[16:19]
  ds_read_b64_tr_b16 a[54:55], v46 offset:3584
  ds_read_b64_tr_b16 a[56:57], v47 offset:3072
  v_mfma_f32_16x16x32_bf16 v[20:23], v[108:111], a[84:87], v[20:23]
  ds_read_b64_tr_b16 a[58:59], v47 offset:3584
  ds_read_b128 a[20:23], v42 offset:4352
  v_mfma_f32_16x16x32_bf16 v[8:11], v[112:115], a[80:83], v[8:11]
  ds_read_b64_tr_b16 a[60:61], v46 offset:4096
  ds_read_b64_tr_b16 a[62:63], v46 offset:4608
  v_mfma_f32_16x16x32_bf16 v[12:15], v[116:119], a[80:83], v[12:15]
  ds_read_b64_tr_b16 a[64:65], v47 offset:4096
  ds_read_b64_tr_b16 a[66:67], v47 offset:4608
  v_mfma_f32_16x16x32_bf16 v[16:19], v[112:115], a[88:91], v[16:19]
  ds_read_b128 a[24:27], v42 offset:8704
  v_mfma_f32_16x16x32_bf16 v[20:23], v[116:119], a[88:91], v[20:23]
  v_mfma_f32_16x16x32_bf16 v[8:11], v[120:123], a[84:87], v[8:11]
  v_mfma_f32_16x16x32_bf16 v[12:15], v[124:127], a[84:87], v[12:15]
  v_mfma_f32_16x16x32_bf16 v[16:19], v[120:123], a[92:95], v[16:19]
  v_mfma_f32_16x16x32_bf16 v[20:23], v[124:127], a[92:95], v[20:23]
  s_waitcnt lgkmcnt(0)
  s_barrier
  v_mfma_f32_16x16x32_bf16 v[8:11], a[28:31], a[0:3], v[8:11]
  ds_read_b64_tr_b16 v[88:89], v46 offset:20480
  ds_read_b64_tr_b16 v[90:91], v46 offset:20992
  v_mfma_f32_16x16x32_bf16 v[12:15], a[32:35], a[0:3], v[12:15]
  ds_read_b64_tr_b16 v[92:93], v47 offset:20480
  ds_read_b64_tr_b16 v[94:95], v47 offset:20992
  v_mfma_f32_16x16x32_bf16 v[16:19], a[28:31], a[8:11], v[16:19]
  ds_read_b128 a[68:71], v41 offset:0
  ds_read_b128 a[76:79], v41 offset:8704
  v_mfma_f32_16x16x32_bf16 v[20:23], a[32:35], a[8:11], v[20:23]
  ds_read_b64_tr_b16 v[96:97], v46 offset:21504
  ds_read_b64_tr_b16 v[98:99], v46 offset:22016
  v_mfma_f32_16x16x32_bf16 v[8:11], a[36:39], a[4:7], v[8:11]
  ds_read_b64_tr_b16 v[100:101], v47 offset:21504
  v_mfma_f32_16x16x32_bf16 v[12:15], a[40:43], a[4:7], v[12:15]
  ds_read_b64_tr_b16 v[102:103], v47 offset:22016
  ds_read_b128 a[72:75], v41 offset:4352
  v_mfma_f32_16x16x32_bf16 v[16:19], a[36:39], a[12:15], v[16:19]
  ds_read_b128 a[80:83], v41 offset:13056
  ds_read_b64_tr_b16 v[104:105], v46 offset:22528
  v_mfma_f32_16x16x32_bf16 v[20:23], a[40:43], a[12:15], v[20:23]
  ds_read_b64_tr_b16 v[106:107], v46 offset:23040
  ds_read_b64_tr_b16 v[108:109], v47 offset:22528
  v_mfma_f32_16x16x32_bf16 v[8:11], a[44:47], a[8:11], v[8:11]
  ds_read_b64_tr_b16 v[110:111], v47 offset:23040
  ds_read_b128 a[84:87], v43 offset:0
  v_mfma_f32_16x16x32_bf16 v[12:15], a[48:51], a[8:11], v[12:15]
  ds_read_b64_tr_b16 v[112:113], v46 offset:23552
  v_mfma_f32_16x16x32_bf16 v[16:19], a[44:47], a[16:19], v[16:19]
  ds_read_b64_tr_b16 v[114:115], v46 offset:24064
  ds_read_b64_tr_b16 v[116:117], v47 offset:23552
  v_mfma_f32_16x16x32_bf16 v[20:23], a[48:51], a[16:19], v[20:23]
  ds_read_b64_tr_b16 v[118:119], v47 offset:24064
  ds_read_b128 a[88:91], v43 offset:4352
  v_mfma_f32_16x16x32_bf16 v[8:11], a[52:55], a[12:15], v[8:11]
  ds_read_b64_tr_b16 v[120:121], v46 offset:24576
  ds_read_b64_tr_b16 v[122:123], v46 offset:25088
  v_mfma_f32_16x16x32_bf16 v[12:15], a[56:59], a[12:15], v[12:15]
  ds_read_b64_tr_b16 v[124:125], v47 offset:24576
  ds_read_b64_tr_b16 v[126:127], v47 offset:25088
  v_mfma_f32_16x16x32_bf16 v[16:19], a[52:55], a[20:23], v[16:19]
  ds_read_b128 a[92:95], v43 offset:8704
  v_mfma_f32_16x16x32_bf16 v[20:23], a[56:59], a[20:23], v[20:23]
  v_mfma_f32_16x16x32_bf16 v[8:11], a[60:63], a[16:19], v[8:11]
  v_mfma_f32_16x16x32_bf16 v[12:15], a[64:67], a[16:19], v[12:15]
  v_mfma_f32_16x16x32_bf16 v[16:19], a[60:63], a[24:27], v[16:19]
  v_mfma_f32_16x16x32_bf16 v[20:23], a[64:67], a[24:27], v[20:23]
  s_waitcnt lgkmcnt(0)
  s_barrier
  v_mfma_f32_16x16x32_bf16 v[8:11], v[88:91], a[68:71], v[8:11]
  ds_read_b64_tr_b16 a[28:29], v44 offset:0
  ds_read_b64_tr_b16 a[30:31], v44 offset:512
  v_mfma_f32_16x16x32_bf16 v[12:15], v[92:95], a[68:71], v[12:15]
  ds_read_b64_tr_b16 a[32:33], v45 offset:0
  ds_read_b64_tr_b16 a[34:35], v45 offset:512
  v_mfma_f32_16x16x32_bf16 v[16:19], v[88:91], a[76:79], v[16:19]
  ds_read_b128 a[0:3], v40 offset:17408
  ds_read_b128 a[8:11], v40 offset:26112
  v_mfma_f32_16x16x32_bf16 v[20:23], v[92:95], a[76:79], v[20:23]
  ds_read_b64_tr_b16 a[36:37], v44 offset:1024
  ds_read_b64_tr_b16 a[38:39], v44 offset:1536
  v_mfma_f32_16x16x32_bf16 v[8:11], v[96:99], a[72:75], v[8:11]
  ds_read_b64_tr_b16 a[40:41], v45 offset:1024
  v_mfma_f32_16x16x32_bf16 v[12:15], v[100:103], a[72:75], v[12:15]
  ds_read_b64_tr_b16 a[42:43], v45 offset:1536
  ds_read_b128 a[4:7], v40 offset:21760
  v_mfma_f32_16x16x32_bf16 v[16:19], v[96:99], a[80:83], v[16:19]
  ds_read_b128 a[12:15], v40 offset:30464
  ds_read_b64_tr_b16 a[44:45], v44 offset:2048
  v_mfma_f32_16x16x32_bf16 v[20:23], v[100:103], a[80:83], v[20:23]
  ds_read_b64_tr_b16 a[46:47], v44 offset:2560
  ds_read_b64_tr_b16 a[48:49], v45 offset:2048
  v_mfma_f32_16x16x32_bf16 v[8:11], v[104:107], a[76:79], v[8:11]
  ds_read_b64_tr_b16 a[50:51], v45 offset:2560
  ds_read_b128 a[16:19], v42 offset:17408
  v_mfma_f32_16x16x32_bf16 v[12:15], v[108:111], a[76:79], v[12:15]
  ds_read_b64_tr_b16 a[52:53], v44 offset:3072
  v_mfma_f32_16x16x32_bf16 v[16:19], v[104:107], a[84:87], v[16:19]
  ds_read_b64_tr_b16 a[54:55], v44 offset:3584
  ds_read_b64_tr_b16 a[56:57], v45 offset:3072
  v_mfma_f32_16x16x32_bf16 v[20:23], v[108:111], a[84:87], v[20:23]
  ds_read_b64_tr_b16 a[58:59], v45 offset:3584
  ds_read_b128 a[20:23], v42 offset:21760
  v_mfma_f32_16x16x32_bf16 v[8:11], v[112:115], a[80:83], v[8:11]
  ds_read_b64_tr_b16 a[60:61], v44 offset:4096
  ds_read_b64_tr_b16 a[62:63], v44 offset:4608
  v_mfma_f32_16x16x32_bf16 v[12:15], v[116:119], a[80:83], v[12:15]
  ds_read_b64_tr_b16 a[64:65], v45 offset:4096
  ds_read_b64_tr_b16 a[66:67], v45 offset:4608
  v_mfma_f32_16x16x32_bf16 v[16:19], v[112:115], a[88:91], v[16:19]
  ds_read_b128 a[24:27], v42 offset:26112
  v_mfma_f32_16x16x32_bf16 v[20:23], v[116:119], a[88:91], v[20:23]
  v_mfma_f32_16x16x32_bf16 v[8:11], v[120:123], a[84:87], v[8:11]
  v_mfma_f32_16x16x32_bf16 v[12:15], v[124:127], a[84:87], v[12:15]
  v_mfma_f32_16x16x32_bf16 v[16:19], v[120:123], a[92:95], v[16:19]
  v_mfma_f32_16x16x32_bf16 v[20:23], v[124:127], a[92:95], v[20:23]
  s_waitcnt lgkmcnt(0)
  s_barrier
  v_mfma_f32_16x16x32_bf16 v[8:11], a[28:31], a[0:3], v[8:11]
  ds_read_b64_tr_b16 v[88:89], v44 offset:20480
  ds_read_b64_tr_b16 v[90:91], v44 offset:20992
  v_mfma_f32_16x16x32_bf16 v[12:15], a[32:35], a[0:3], v[12:15]
  ds_read_b64_tr_b16 v[92:93], v45 offset:20480
  ds_read_b64_tr_b16 v[94:95], v45 offset:20992
  v_mfma_f32_16x16x32_bf16 v[16:19], a[28:31], a[8:11], v[16:19]
  ds_read_b128 a[68:71], v41 offset:17408
  ds_read_b128 a[76:79], v41 offset:26112
  v_mfma_f32_16x16x32_bf16 v[20:23], a[32:35], a[8:11], v[20:23]
  ds_read_b64_tr_b16 v[96:97], v44 offset:21504
  ds_read_b64_tr_b16 v[98:99], v44 offset:22016
  v_mfma_f32_16x16x32_bf16 v[8:11], a[36:39], a[4:7], v[8:11]
  ds_read_b64_tr_b16 v[100:101], v45 offset:21504
  v_mfma_f32_16x16x32_bf16 v[12:15], a[40:43], a[4:7], v[12:15]
  ds_read_b64_tr_b16 v[102:103], v45 offset:22016
  ds_read_b128 a[72:75], v41 offset:21760
  v_mfma_f32_16x16x32_bf16 v[16:19], a[36:39], a[12:15], v[16:19]
  ds_read_b128 a[80:83], v41 offset:30464
  ds_read_b64_tr_b16 v[104:105], v44 offset:22528
  v_mfma_f32_16x16x32_bf16 v[20:23], a[40:43], a[12:15], v[20:23]
  ds_read_b64_tr_b16 v[106:107], v44 offset:23040
  ds_read_b64_tr_b16 v[108:109], v45 offset:22528
  v_mfma_f32_16x16x32_bf16 v[8:11], a[44:47], a[8:11], v[8:11]
  ds_read_b64_tr_b16 v[110:111], v45 offset:23040
  ds_read_b128 a[84:87], v43 offset:17408
  v_mfma_f32_16x16x32_bf16 v[12:15], a[48:51], a[8:11], v[12:15]
  ds_read_b64_tr_b16 v[112:113], v44 offset:23552
  v_mfma_f32_16x16x32_bf16 v[16:19], a[44:47], a[16:19], v[16:19]
  ds_read_b64_tr_b16 v[114:115], v44 offset:24064
  ds_read_b64_tr_b16 v[116:117], v45 offset:23552
  v_mfma_f32_16x16x32_bf16 v[20:23], a[48:51], a[16:19], v[20:23]
  ds_read_b64_tr_b16 v[118:119], v45 offset:24064
  ds_read_b128 a[88:91], v43 offset:21760
  v_mfma_f32_16x16x32_bf16 v[8:11], a[52:55], a[12:15], v[8:11]
  ds_read_b64_tr_b16 v[120:121], v44 offset:24576
  ds_read_b64_tr_b16 v[122:123], v44 offset:25088
  v_mfma_f32_16x16x32_bf16 v[12:15], a[56:59], a[12:15], v[12:15]
  ds_read_b64_tr_b16 v[124:125], v45 offset:24576
  ds_read_b64_tr_b16 v[126:127], v45 offset:25088
  v_mfma_f32_16x16x32_bf16 v[16:19], a[52:55], a[20:23], v[16:19]
  ds_read_b128 a[92:95], v43 offset:26112
  v_mfma_f32_16x16x32_bf16 v[20:23], a[56:59], a[20:23], v[20:23]
  v_mfma_f32_16x16x32_bf16 v[8:11], a[60:63], a[16:19], v[8:11]
  v_mfma_f32_16x16x32_bf16 v[12:15], a[64:67], a[16:19], v[12:15]
  v_mfma_f32_16x16x32_bf16 v[16:19], a[60:63], a[24:27], v[16:19]
  v_mfma_f32_16x16x32_bf16 v[20:23], a[64:67], a[24:27], v[20:23]
  s_waitcnt lgkmcnt(0)
  s_barrier
  v_mfma_f32_16x16x32_bf16 v[8:11], v[88:91], a[68:71], v[8:11]
  s_mov_b32 s52, 0xbdd2d3e8
  s_mov_b32 s53, 0xbdd2d3e8
  v_mfma_f32_16x16x32_bf16 v[12:15], v[92:95], a[68:71], v[12:15]
  v_mov_b32 v2, 0xc0135761
  v_mfma_f32_16x16x32_bf16 v[16:19], v[88:91], a[76:79], v[16:19]
  v_mov_b32 v3, 0xc0135761
  s_lshr_b32 s63, s3, 1
  v_mfma_f32_16x16x32_bf16 v[20:23], v[92:95], a[76:79], v[20:23]
  s_and_b32 s80, s3, 1
  v_mfma_f32_16x16x32_bf16 v[8:11], v[96:99], a[72:75], v[8:11]
  v_and_b32 v4, 15, v0
  v_lshrrev_b32 v5, 4, v0
  v_mfma_f32_16x16x32_bf16 v[12:15], v[100:103], a[72:75], v[12:15]
  v_and_b32 v6, 1, v5
  v_mfma_f32_16x16x32_bf16 v[16:19], v[96:99], a[80:83], v[16:19]
  v_lshlrev_b32 v6, 5, v6
  v_and_b32 v5, 2, v5
  v_mfma_f32_16x16x32_bf16 v[20:23], v[100:103], a[80:83], v[20:23]
  v_lshlrev_b32 v5, 3, v5
  v_mfma_f32_16x16x32_bf16 v[8:11], v[104:107], a[76:79], v[8:11]
  v_add_u32 v5, v5, v6
  s_lshl_b32 s24, s62, 7
  v_mfma_f32_16x16x32_bf16 v[12:15], v[108:111], a[76:79], v[12:15]
  s_lshl_b32 s25, s80, 6
  v_mfma_f32_16x16x32_bf16 v[16:19], v[104:107], a[84:87], v[16:19]
  s_add_u32 s24, s24, s25
  v_add_u32 v5, s24, v5
  v_mfma_f32_16x16x32_bf16 v[20:23], v[108:111], a[84:87], v[20:23]
  s_mul_i32 s24, s61, 64
  v_mfma_f32_16x16x32_bf16 v[8:11], v[112:115], a[80:83], v[8:11]
  s_mul_i32 s25, s63, 32
  s_add_u32 s24, s24, s25
  v_mfma_f32_16x16x32_bf16 v[12:15], v[116:119], a[80:83], v[12:15]
  v_mul_u32_u24 v4, 2, v4
  v_mfma_f32_16x16x32_bf16 v[16:19], v[112:115], a[88:91], v[16:19]
  v_add_u32 v4, s24, v4
  v_lshlrev_b32 v6, 10, v4
  v_mfma_f32_16x16x32_bf16 v[20:23], v[116:119], a[88:91], v[20:23]
  v_add_u32 v6, v6, v5
  v_mfma_f32_16x16x32_bf16 v[8:11], v[120:123], a[84:87], v[8:11]
  v_mfma_f32_16x16x32_bf16 v[12:15], v[124:127], a[84:87], v[12:15]
  v_mfma_f32_16x16x32_bf16 v[16:19], v[120:123], a[92:95], v[16:19]
  v_mfma_f32_16x16x32_bf16 v[20:23], v[124:127], a[92:95], v[20:23]
  s_nop 7
  v_pk_mul_f32 v[48:49], v[8:9], v[8:9]
  v_pk_mul_f32 v[50:51], v[10:11], v[10:11]
  v_pk_mul_f32 v[52:53], v[12:13], v[12:13]
  v_pk_mul_f32 v[54:55], v[14:15], v[14:15]
  v_pk_fma_f32 v[48:49], v[48:49], s[52:53], v[2:3]
  v_pk_fma_f32 v[50:51], v[50:51], s[52:53], v[2:3]
  v_pk_fma_f32 v[52:53], v[52:53], s[52:53], v[2:3]
  v_pk_fma_f32 v[54:55], v[54:55], s[52:53], v[2:3]
  v_pk_mul_f32 v[48:49], v[48:49], v[8:9]
  v_pk_mul_f32 v[50:51], v[50:51], v[10:11]
  v_pk_mul_f32 v[52:53], v[52:53], v[12:13]
  v_pk_mul_f32 v[54:55], v[54:55], v[14:15]
  v_exp_f32 v48, v48
  v_exp_f32 v49, v49
  v_exp_f32 v50, v50
  v_exp_f32 v51, v51
  v_exp_f32 v52, v52
  v_exp_f32 v53, v53
  v_exp_f32 v54, v54
  v_exp_f32 v55, v55
  v_pk_add_f32 v[48:49], v[48:49], 1.0 op_sel_hi:[1,0]
  v_pk_add_f32 v[50:51], v[50:51], 1.0 op_sel_hi:[1,0]
  v_pk_add_f32 v[52:53], v[52:53], 1.0 op_sel_hi:[1,0]
  v_pk_add_f32 v[54:55], v[54:55], 1.0 op_sel_hi:[1,0]
  v_rcp_f32 v48, v48
  v_rcp_f32 v49, v49
  v_rcp_f32 v50, v50
  v_rcp_f32 v51, v51
  v_rcp_f32 v52, v52
  v_rcp_f32 v53, v53
  v_rcp_f32 v54, v54
  v_rcp_f32 v55, v55
  v_pk_mul_f32 v[8:9], v[8:9], v[48:49]
  v_pk_mul_f32 v[10:11], v[10:11], v[50:51]
  v_pk_mul_f32 v[12:13], v[12:13], v[52:53]
  v_pk_mul_f32 v[14:15], v[14:15], v[54:55]
  v_cvt_pk_bf16_f32 v56, v8, v9
  v_cvt_pk_bf16_f32 v57, v10, v11
  v_cvt_pk_bf16_f32 v58, v12, v13
  v_cvt_pk_bf16_f32 v59, v14, v15
  s_nop 1
  v_permlane16_swap_b32 v56, v58
  v_permlane16_swap_b32 v57, v59
  buffer_store_dwordx4 v[56:59], v6, s[16:19], 0 offen offset:0
  v_pk_mul_f32 v[48:49], v[16:17], v[16:17]
  v_pk_mul_f32 v[50:51], v[18:19], v[18:19]
  v_pk_mul_f32 v[52:53], v[20:21], v[20:21]
  v_pk_mul_f32 v[54:55], v[22:23], v[22:23]
  v_pk_fma_f32 v[48:49], v[48:49], s[52:53], v[2:3]
  v_pk_fma_f32 v[50:51], v[50:51], s[52:53], v[2:3]
  v_pk_fma_f32 v[52:53], v[52:53], s[52:53], v[2:3]
  v_pk_fma_f32 v[54:55], v[54:55], s[52:53], v[2:3]
  v_pk_mul_f32 v[48:49], v[48:49], v[16:17]
  v_pk_mul_f32 v[50:51], v[50:51], v[18:19]
  v_pk_mul_f32 v[52:53], v[52:53], v[20:21]
  v_pk_mul_f32 v[54:55], v[54:55], v[22:23]
  v_exp_f32 v48, v48
  v_exp_f32 v49, v49
  v_exp_f32 v50, v50
  v_exp_f32 v51, v51
  v_exp_f32 v52, v52
  v_exp_f32 v53, v53
  v_exp_f32 v54, v54
  v_exp_f32 v55, v55
  v_pk_add_f32 v[48:49], v[48:49], 1.0 op_sel_hi:[1,0]
  v_pk_add_f32 v[50:51], v[50:51], 1.0 op_sel_hi:[1,0]
  v_pk_add_f32 v[52:53], v[52:53], 1.0 op_sel_hi:[1,0]
  v_pk_add_f32 v[54:55], v[54:55], 1.0 op_sel_hi:[1,0]
  v_rcp_f32 v48, v48
  v_rcp_f32 v49, v49
  v_rcp_f32 v50, v50
  v_rcp_f32 v51, v51
  v_rcp_f32 v52, v52
  v_rcp_f32 v53, v53
  v_rcp_f32 v54, v54
  v_rcp_f32 v55, v55
  v_pk_mul_f32 v[16:17], v[16:17], v[48:49]
  v_pk_mul_f32 v[18:19], v[18:19], v[50:51]
  v_pk_mul_f32 v[20:21], v[20:21], v[52:53]
  v_pk_mul_f32 v[22:23], v[22:23], v[54:55]
  v_cvt_pk_bf16_f32 v60, v16, v17
  v_cvt_pk_bf16_f32 v61, v18, v19
  v_cvt_pk_bf16_f32 v62, v20, v21
  v_cvt_pk_bf16_f32 v63, v22, v23
  s_nop 1
  v_permlane16_swap_b32 v60, v62
  v_permlane16_swap_b32 v61, v63
  buffer_store_dwordx4 v[60:63], v6, s[16:19], 0 offen offset:1024
  s_lshl_b32 s24, s4, 18
  s_add_u32 s8, s50, s24
  s_addc_u32 s9, s51, 0
  s_add_u32 s8, s8, 4194304
  s_addc_u32 s9, s9, 0
  s_mov_b32 s10, 262144
  s_mov_b32 s11, 0x00020000
  s_lshr_b32 s63, s3, 1
  s_and_b32 s80, s3, 1
  v_and_b32 v1, 31, v0
  v_lshrrev_b32 v2, 5, v0
  s_lshl_b32 s26, s63, 5
  v_add_u32 v3, s26, v1
  v_bfe_u32 v4, v3, 1, 3
  v_xor_b32 v4, v4, v2
  v_lshlrev_b32 v4, 4, v4
  v_lshlrev_b32 v3, 7, v3
  v_add_u32 v3, v3, v4
  v_xor_b32 v40, 0, v3
  v_xor_b32 v41, 32, v3
  v_xor_b32 v42, 64, v3
  v_xor_b32 v43, 96, v3
  v_lshrrev_b32 v8, 5, v0
  v_lshlrev_b32 v8, 10, v8
  v_bfe_u32 v9, v0, 2, 2
  v_lshlrev_b32 v10, 7, v9
  v_add_u32 v8, v8, v10
  v_bfe_u32 v10, v0, 4, 1
  v_lshlrev_b32 v10, 1, v10
  v_bfe_u32 v11, v0, 1, 1
  v_add_u32 v10, v10, v11
  s_lshl_b32 s26, s80, 2
  v_add_u32 v10, s26, v10
  v_lshrrev_b32 v9, 1, v9
  v_lshlrev_b32 v9, 2, v9
  v_xor_b32 v10, v10, v9
  v_lshlrev_b32 v10, 4, v10
  v_add_u32 v8, v8, v10
  v_and_b32 v10, 1, v0
  v_lshlrev_b32 v10, 3, v10
  v_add_u32 v8, v8, v10
  v_add_u32 v44, 90112, v8
  v_and_b32 v4, 31, v0
  v_lshrrev_b32 v5, 5, v0
  s_lshl_b32 s24, s61, 6
  s_lshl_b32 s25, s63, 5
  s_add_u32 s24, s24, s25
  v_add_u32 v4, s24, v4
  v_lshlrev_b32 v4, 11, v4
  s_lshl_b32 s24, s62, 8
  s_lshl_b32 s25, s80, 7
  s_add_u32 s24, s24, s25
  v_lshlrev_b32 v5, 4, v5
  v_add_u32 v4, v4, v5
  v_add_u32 v45, s24, v4
  v_lshrrev_b32 v1, 3, v0
  s_lshl_b32 s26, s3, 4
  s_lshl_b32 s27, s61, 6
  s_add_u32 s27, s27, s26
  v_add_u32 v1, s27, v1
  v_lshlrev_b32 v1, 10, v1
  v_and_b32 v2, 7, v0
  v_lshrrev_b32 v3, 4, v0
  v_xor_b32 v2, v2, v3
  v_lshlrev_b32 v2, 4, v2
  v_add_u32 v56, v1, v2
  v_xor_b32 v2, 64, v2
  v_add_u32 v1, 8192, v1
  v_add_u32 v57, v1, v2
  s_lshl_b32 s55, s3, 11
  s_lshl_b32 s24, s61, 7
  v_and_b32 v61, 31, v0
  v_lshlrev_b32 v61, 2, v61
  v_add_u32 v61, s24, v61
  v_add_u32 v61, 512, v61
  s_lshl_b32 s24, s5, 2
  s_add_u32 s24, s24, s3
  s_waitcnt vmcnt(0)
  s_add_u32 s25, s88, 2
  v_mov_b32 v1, s25
  s_lshl_b32 s24, s24, 2
  v_mov_b32 v2, s24
  s_cmp_eq_u32 s89, 0
  s_cbranch_scc1 L_sigs_10
  s_mov_b64 exec, 1
  buffer_store_dword v1, v2, s[84:87], 0 offen offset:512
  s_mov_b64 exec, -1
  s_branch L_sigd_11
L_sigs_10:
  buffer_wbl2 sc1
  s_waitcnt vmcnt(0)
  s_mov_b64 exec, 1
  buffer_store_dword v1, v2, s[84:87], 0 offen offset:512 sc1
  s_mov_b64 exec, -1
L_sigd_11:
  s_lshl_b32 s24, s4, 19
  s_add_u32 s16, s50, s24
  s_addc_u32 s17, s51, 0
  s_add_u32 s16, s16, 6291456
  s_addc_u32 s17, s17, 0
  s_mov_b32 s18, 524288
  s_mov_b32 s19, 0x00020000
  s_add_u32 s25, s88, 2
  s_mov_b32 s27, 0
L_poll_12:
  buffer_load_dword v1, v61, s[84:87], 0 offen sc1
  s_add_u32 s27, s27, 1
  s_cmp_gt_u32 s27, 400000
  s_cbranch_scc1 L_pollx_14
  s_waitcnt vmcnt(0)
  v_cmp_ne_u32 vcc, s25, v1
  s_nop 1
  s_cbranch_vccnz L_poll_12
L_pollx_14:
  s_cmp_eq_u32 s89, 0
  s_cbranch_scc0 L_polld_13
  buffer_inv sc1
  s_waitcnt vmcnt(0)
L_polld_13:
  s_add_u32 m0, s55, 0
  s_mov_b32 s26, 0
  buffer_load_dwordx4 v56, s[8:11], s26 offen lds
  s_add_u32 m0, s55, 1024
  s_mov_b32 s26, 0
  buffer_load_dwordx4 v57, s[8:11], s26 offen lds
  s_add_u32 m0, s55, 8192
  s_mov_b32 s26, 128
  buffer_load_dwordx4 v56, s[8:11], s26 offen lds
  s_add_u32 m0, s55, 9216
  s_mov_b32 s26, 128
  buffer_load_dwordx4 v57, s[8:11], s26 offen lds
  s_add_u32 m0, s55, 16384
  s_mov_b32 s26, 256
  buffer_load_dwordx4 v56, s[8:11], s26 offen lds
  s_add_u32 m0, s55, 17408
  s_mov_b32 s26, 256
  buffer_load_dwordx4 v57, s[8:11], s26 offen lds
  s_add_u32 m0, s55, 24576
  s_mov_b32 s26, 384
  buffer_load_dwordx4 v56, s[8:11], s26 offen lds
  s_add_u32 m0, s55, 25600
  s_mov_b32 s26, 384
  buffer_load_dwordx4 v57, s[8:11], s26 offen lds
  s_add_u32 m0, s55, 32768
  s_mov_b32 s26, 512
  buffer_load_dwordx4 v56, s[8:11], s26 offen lds
  s_add_u32 m0, s55, 33792
  s_mov_b32 s26, 512
  buffer_load_dwordx4 v57, s[8:11], s26 offen lds
  s_add_u32 m0, s55, 40960
  s_mov_b32 s26, 640
  buffer_load_dwordx4 v56, s[8:11], s26 offen lds
  s_add_u32 m0, s55, 41984
  s_mov_b32 s26, 640
  buffer_load_dwordx4 v57, s[8:11], s26 offen lds
  s_add_u32 m0, s55, 49152
  s_mov_b32 s26, 768
  buffer_load_dwordx4 v56, s[8:11], s26 offen lds
  s_add_u32 m0, s55, 50176
  s_mov_b32 s26, 768
  buffer_load_dwordx4 v57, s[8:11], s26 offen lds
  s_add_u32 m0, s55, 57344
  s_mov_b32 s26, 896
  buffer_load_dwordx4 v56, s[8:11], s26 offen lds
  s_add_u32 m0, s55, 58368
  s_mov_b32 s26, 896
  buffer_load_dwordx4 v57, s[8:11], s26 offen lds
  s_waitcnt vmcnt(8)
  s_barrier
  ds_read_b64_tr_b16 v[8:9], v44 offset:0
  ds_read_b64_tr_b16 v[10:11], v44 offset:512
  ds_read_b128 v[12:15], v40 offset:0
  ds_read_b64_tr_b16 v[16:17], v44 offset:2048
  ds_read_b64_tr_b16 v[18:19], v44 offset:2560
  ds_read_b128 v[20:23], v41 offset:0
  ds_read_b64_tr_b16 v[24:25], v44 offset:4096
  ds_read_b64_tr_b16 v[26:27], v44 offset:4608
  ds_read_b128 v[28:31], v42 offset:0
  ds_read_b64_tr_b16 v[32:33], v44 offset:6144
  ds_read_b64_tr_b16 v[34:35], v44 offset:6656
  ds_read_b128 v[36:39], v43 offset:0
  s_waitcnt lgkmcnt(9)
  v_mfma_f32_32x32x16_bf16 v[104:119], v[8:11], v[12:15], 0
  ds_read_b64_tr_b16 v[72:73], v44 offset:8192
  ds_read_b64_tr_b16 v[74:75], v44 offset:8704
  ds_read_b128 v[76:79], v40 offset:8192
  s_waitcnt lgkmcnt(9)
  v_mfma_f32_32x32x16_bf16 v[104:119], v[16:19], v[20:23], v[104:119]
  ds_read_b64_tr_b16 v[80:81], v44 offset:10240
  ds_read_b64_tr_b16 v[82:83], v44 offset:10752
  ds_read_b128 v[84:87], v41 offset:8192
  s_waitcnt lgkmcnt(9)
  v_mfma_f32_32x32x16_bf16 v[104:119], v[24:27], v[28:31], v[104:119]
  ds_read_b64_tr_b16 v[8:9], v44 offset:12288
  ds_read_b64_tr_b16 v[10:11], v44 offset:12800
  ds_read_b128 v[12:15], v42 offset:8192
  s_waitcnt lgkmcnt(9)
  v_mfma_f32_32x32x16_bf16 v[104:119], v[32:35], v[36:39], v[104:119]
  ds_read_b64_tr_b16 v[16:17], v44 offset:14336
  ds_read_b64_tr_b16 v[18:19], v44 offset:14848
  ds_read_b128 v[20:23], v43 offset:8192
  s_waitcnt lgkmcnt(9)
  v_mfma_f32_32x32x16_bf16 v[104:119], v[72:75], v[76:79], v[104:119]
  ds_read_b64_tr_b16 v[24:25], v44 offset:16384
  ds_read_b64_tr_b16 v[26:27], v44 offset:16896
  ds_read_b128 v[28:31], v40 offset:16384
  s_waitcnt lgkmcnt(9)
  v_mfma_f32_32x32x16_bf16 v[104:119], v[80:83], v[84:87], v[104:119]
  ds_read_b64_tr_b16 v[32:33], v44 offset:18432
  ds_read_b64_tr_b16 v[34:35], v44 offset:18944
  ds_read_b128 v[36:39], v41 offset:16384
  s_waitcnt lgkmcnt(9)
  v_mfma_f32_32x32x16_bf16 v[104:119], v[8:11], v[12:15], v[104:119]
  ds_read_b64_tr_b16 v[72:73], v44 offset:20480
  ds_read_b64_tr_b16 v[74:75], v44 offset:20992
  ds_read_b128 v[76:79], v42 offset:16384
  s_waitcnt lgkmcnt(9)
  v_mfma_f32_32x32x16_bf16 v[104:119], v[16:19], v[20:23], v[104:119]
  ds_read_b64_tr_b16 v[80:81], v44 offset:22528
  ds_read_b64_tr_b16 v[82:83], v44 offset:23040
  ds_read_b128 v[84:87], v43 offset:16384
  s_waitcnt lgkmcnt(9)
  v_mfma_f32_32x32x16_bf16 v[104:119], v[24:27], v[28:31], v[104:119]
  ds_read_b64_tr_b16 v[8:9], v44 offset:24576
  ds_read_b64_tr_b16 v[10:11], v44 offset:25088
  ds_read_b128 v[12:15], v40 offset:24576
  s_waitcnt lgkmcnt(9)
  v_mfma_f32_32x32x16_bf16 v[104:119], v[32:35], v[36:39], v[104:119]
  ds_read_b64_tr_b16 v[16:17], v44 offset:26624
  ds_read_b64_tr_b16 v[18:19], v44 offset:27136
  ds_read_b128 v[20:23], v41 offset:24576
  s_waitcnt lgkmcnt(9)
  v_mfma_f32_32x32x16_bf16 v[104:119], v[72:75], v[76:79], v[104:119]
  ds_read_b64_tr_b16 v[24:25], v44 offset:28672
  ds_read_b64_tr_b16 v[26:27], v44 offset:29184
  ds_read_b128 v[28:31], v42 offset:24576
  s_waitcnt lgkmcnt(9)
  v_mfma_f32_32x32x16_bf16 v[104:119], v[80:83], v[84:87], v[104:119]
  ds_read_b64_tr_b16 v[32:33], v44 offset:30720
  ds_read_b64_tr_b16 v[34:35], v44 offset:31232
  ds_read_b128 v[36:39], v43 offset:24576
  s_waitcnt lgkmcnt(9)
  v_mfma_f32_32x32x16_bf16 v[104:119], v[8:11], v[12:15], v[104:119]
  s_waitcnt lgkmcnt(6)
  v_mfma_f32_32x32x16_bf16 v[104:119], v[16:19], v[20:23], v[104:119]
  s_waitcnt lgkmcnt(3)
  v_mfma_f32_32x32x16_bf16 v[104:119], v[24:27], v[28:31], v[104:119]
  s_waitcnt lgkmcnt(0)
  v_mfma_f32_32x32x16_bf16 v[104:119], v[32:35], v[36:39], v[104:119]
  s_waitcnt vmcnt(0)
  s_barrier
  ds_read_b64_tr_b16 v[72:73], v44 offset:32768
  ds_read_b64_tr_b16 v[74:75], v44 offset:33280
  ds_read_b128 v[76:79], v40 offset:32768
  ds_read_b64_tr_b16 v[80:81], v44 offset:34816
  ds_read_b64_tr_b16 v[82:83], v44 offset:35328
  ds_read_b128 v[84:87], v41 offset:32768
  ds_read_b64_tr_b16 v[8:9], v44 offset:36864
  ds_read_b64_tr_b16 v[10:11], v44 offset:37376
  ds_read_b128 v[12:15], v42 offset:32768
  ds_read_b64_tr_b16 v[16:17], v44 offset:38912
  ds_read_b64_tr_b16 v[18:19], v44 offset:39424
  ds_read_b128 v[20:23], v43 offset:32768
  s_waitcnt lgkmcnt(9)
  v_mfma_f32_32x32x16_bf16 v[104:119], v[72:75], v[76:79], v[104:119]
  ds_read_b64_tr_b16 v[24:25], v44 offset:40960
  ds_read_b64_tr_b16 v[26:27], v44 offset:41472
  ds_read_b128 v[28:31], v40 offset:40960
  s_waitcnt lgkmcnt(9)
  v_mfma_f32_32x32x16_bf16 v[104:119], v[80:83], v[84:87], v[104:119]
  ds_read_b64_tr_b16 v[32:33], v44 offset:43008
  ds_read_b64_tr_b16 v[34:35], v44 offset:43520
  ds_read_b128 v[36:39], v41 offset:40960
  s_waitcnt lgkmcnt(9)
  v_mfma_f32_32x32x16_bf16 v[104:119], v[8:11], v[12:15], v[104:119]
  ds_read_b64_tr_b16 v[72:73], v44 offset:45056
  ds_read_b64_tr_b16 v[74:75], v44 offset:45568
  ds_read_b128 v[76:79], v42 offset:40960
  s_waitcnt lgkmcnt(9)
  v_mfma_f32_32x32x16_bf16 v[104:119], v[16:19], v[20:23], v[104:119]
  ds_read_b64_tr_b16 v[80:81], v44 offset:47104
  ds_read_b64_tr_b16 v[82:83], v44 offset:47616
  ds_read_b128 v[84:87], v43 offset:40960
  s_waitcnt lgkmcnt(9)
  v_mfma_f32_32x32x16_bf16 v[104:119], v[24:27], v[28:31], v[104:119]
  ds_read_b64_tr_b16 v[8:9], v44 offset:49152
  ds_read_b64_tr_b16 v[10:11], v44 offset:49664
  ds_read_b128 v[12:15], v40 offset:49152
  s_waitcnt lgkmcnt(9)
  v_mfma_f32_32x32x16_bf16 v[104:119], v[32:35], v[36:39], v[104:119]
  ds_read_b64_tr_b16 v[16:17], v44 offset:51200
  ds_read_b64_tr_b16 v[18:19], v44 offset:51712
  ds_read_b128 v[20:23], v41 offset:49152
  s_waitcnt lgkmcnt(9)
  v_mfma_f32_32x32x16_bf16 v[104:119], v[72:75], v[76:79], v[104:119]
  ds_read_b64_tr_b16 v[24:25], v44 offset:53248
  ds_read_b64_tr_b16 v[26:27], v44 offset:53760
  ds_read_b128 v[28:31], v42 offset:49152
  s_waitcnt lgkmcnt(9)
  v_mfma_f32_32x32x16_bf16 v[104:119], v[80:83], v[84:87], v[104:119]
  ds_read_b64_tr_b16 v[32:33], v44 offset:55296
  ds_read_b64_tr_b16 v[34:35], v44 offset:55808
  ds_read_b128 v[36:39], v43 offset:49152
  s_waitcnt lgkmcnt(9)
  v_mfma_f32_32x32x16_bf16 v[104:119], v[8:11], v[12:15], v[104:119]
  ds_read_b64_tr_b16 v[72:73], v44 offset:57344
  ds_read_b64_tr_b16 v[74:75], v44 offset:57856
  ds_read_b128 v[76:79], v40 offset:57344
  s_waitcnt lgkmcnt(9)
  v_mfma_f32_32x32x16_bf16 v[104:119], v[16:19], v[20:23], v[104:119]
  ds_read_b64_tr_b16 v[80:81], v44 offset:59392
  ds_read_b64_tr_b16 v[82:83], v44 offset:59904
  ds_read_b128 v[84:87], v41 offset:57344
  s_waitcnt lgkmcnt(9)
  v_mfma_f32_32x32x16_bf16 v[104:119], v[24:27], v[28:31], v[104:119]
  ds_read_b64_tr_b16 v[8:9], v44 offset:61440
  ds_read_b64_tr_b16 v[10:11], v44 offset:61952
  ds_read_b128 v[12:15], v42 offset:57344
  s_waitcnt lgkmcnt(9)
  v_mfma_f32_32x32x16_bf16 v[104:119], v[32:35], v[36:39], v[104:119]
  ds_read_b64_tr_b16 v[16:17], v44 offset:63488
  ds_read_b64_tr_b16 v[18:19], v44 offset:64000
  ds_read_b128 v[20:23], v43 offset:57344
  s_waitcnt lgkmcnt(9)
  v_mfma_f32_32x32x16_bf16 v[104:119], v[72:75], v[76:79], v[104:119]
  s_waitcnt lgkmcnt(6)
  v_mfma_f32_32x32x16_bf16 v[104:119], v[80:83], v[84:87], v[104:119]
  s_waitcnt lgkmcnt(3)
  v_mfma_f32_32x32x16_bf16 v[104:119], v[8:11], v[12:15], v[104:119]
  s_waitcnt lgkmcnt(0)
  v_mfma_f32_32x32x16_bf16 v[104:119], v[16:19], v[20:23], v[104:119]
  s_mov_b32 s52, 0x4038aa3b
  s_nop 7
  s_nop 3
  v_mul_f32 v8, s52, v104
  v_mul_f32 v9, s52, v105
  v_mul_f32 v10, s52, v106
  v_mul_f32 v11, s52, v107
  v_mul_f32 v12, s52, v108
  v_mul_f32 v13, s52, v109
  v_mul_f32 v14, s52, v110
  v_mul_f32 v15, s52, v111
  v_mul_f32 v16, s52, v112
  v_mul_f32 v17, s52, v113
  v_mul_f32 v18, s52, v114
  v_mul_f32 v19, s52, v115
  v_mul_f32 v20, s52, v116
  v_mul_f32 v21, s52, v117
  v_mul_f32 v22, s52, v118
  v_mul_f32 v23, s52, v119
  v_exp_f32 v8, v8
  v_exp_f32 v9, v9
  v_exp_f32 v10, v10
  v_exp_f32 v11, v11
  v_exp_f32 v12, v12
  v_exp_f32 v13, v13
  v_exp_f32 v14, v14
  v_exp_f32 v15, v15
  v_exp_f32 v16, v16
  v_exp_f32 v17, v17
  v_exp_f32 v18, v18
  v_exp_f32 v19, v19
  v_exp_f32 v20, v20
  v_exp_f32 v21, v21
  v_exp_f32 v22, v22
  v_exp_f32 v23, v23
  s_nop 1
  buffer_store_dwordx4 v[8:11], v45, s[16:19], 0 offen offset:0
  buffer_store_dwordx4 v[12:15], v45, s[16:19], 0 offen offset:32
  buffer_store_dwordx4 v[16:19], v45, s[16:19], 0 offen offset:64
  buffer_store_dwordx4 v[20:23], v45, s[16:19], 0 offen offset:96
  s_lshr_b32 s90, s5, 1
  s_lshr_b32 s24, s90, 2
  s_lshl_b32 s24, s24, 7
  s_add_u32 s24, s24, 1024
  v_and_b32 v61, 31, v0
  v_lshlrev_b32 v61, 2, v61
  v_mov_b32 v62, s24
  v_mov_b32 v63, 1536
  v_cmp_gt_u32 vcc, 32, v0
  s_nop 1
  v_cndmask_b32 v62, v63, v62, vcc
  v_add_u32 v61, v61, v62
  s_lshl_b32 s24, s5, 2
  s_add_u32 s24, s24, s3
  s_waitcnt vmcnt(0)
  s_add_u32 s25, s88, 3
  v_mov_b32 v1, s25
  s_lshl_b32 s24, s24, 2
  v_mov_b32 v2, s24
  s_cmp_eq_u32 s89, 0
  s_cbranch_scc1 L_sigs_15
  s_mov_b64 exec, 1
  buffer_store_dword v1, v2, s[84:87], 0 offen offset:1024
  s_mov_b64 exec, -1
  s_branch L_sigd_16
L_sigs_15:
  buffer_wbl2 sc1
  s_waitcnt vmcnt(0)
  s_mov_b64 exec, 1
  buffer_store_dword v1, v2, s[84:87], 0 offen offset:1024 sc1
  s_mov_b64 exec, -1
L_sigd_16:
  s_lshr_b32 s90, s5, 1
  s_and_b32 s91, s5, 1
  s_lshl_b32 s24, s4, 19
  s_add_u32 s8, s50, s24
  s_addc_u32 s9, s51, 0
  s_add_u32 s8, s8, 6291456
  s_addc_u32 s9, s9, 0
  s_mov_b32 s10, 524288
  s_mov_b32 s11, 0x00020000
  s_add_u32 s12, s50, 12582912
  s_addc_u32 s13, s51, 0
  s_mov_b32 s14, 524288
  s_mov_b32 s15, 0x00020000
  s_lshl_b32 s24, s4, 14
  s_add_u32 s20, s50, s24
  s_addc_u32 s21, s51, 0
  s_add_u32 s20, s20, 10485760
  s_addc_u32 s21, s21, 0
  s_mov_b32 s22, 16384
  s_mov_b32 s23, 0x00020000
  s_mul_i32 s24, s6, 1000
  s_mul_i32 s25, s7, 250
  s_add_u32 s24, s24, s25
  s_lshl_b32 s25, s90, 4
  s_add_u32 s24, s24, s25
  s_lshl_b32 s24, s24, 13
  s_add_u32 s16, s46, s24
  s_addc_u32 s17, s47, 0
  s_mov_b32 s18, 0
  s_mov_b32 s19, 0x00020000
  s_sub_u32 s25, 250, s25
  s_min_u32 s25, s25, 16
  s_lshl_b32 s18, s25, 13
  v_and_b32 v2, 7, v0
  v_lshlrev_b32 v2, 5, v2
  s_lshl_b32 s26, s3, 8
  v_add_u32 v2, s26, v2
  v_bfe_u32 v3, v0, 3, 2
  s_lshl_b32 s26, s90, 4
  v_add_u32 v3, s26, v3
  v_lshlrev_b32 v3, 11, v3
  v_add_u32 v5, v3, v2
  v_lshrrev_b32 v1, 5, v0
  v_lshlrev_b32 v1, 13, v1
  v_add_u32 v2, v1, v2
  v_bfe_u32 v1, v0, 3, 2
  v_lshrrev_b32 v7, 5, v0
  v_lshlrev_b32 v3, 3, v1
  v_lshlrev_b32 v6, 2, v7
  v_add_u32 v3, v3, v6
  v_and_b32 v6, 15, v3
  v_and_b32 v7, 7, v0
  s_and_b32 s26, s3, 1
  s_lshl_b32 s26, s26, 3
  v_add_u32 v7, s26, v7
  v_xor_b32 v7, v7, v6
  v_lshlrev_b32 v7, 4, v7
  v_lshlrev_b32 v3, 10, v3
  v_add_u32 v3, v3, v7
  s_lshr_b32 s26, s3, 1
  s_lshl_b32 s26, s26, 8
  v_add_u32 v4, s26, v3
  v_and_b32 v1, 31, v0
  v_lshrrev_b32 v7, 5, v0
  v_and_b32 v3, 15, v1
  v_xor_b32 v3, v3, v7
  v_lshlrev_b32 v3, 4, v3
  v_lshlrev_b32 v1, 10, v1
  v_add_u32 v3, v3, v1
  v_xor_b32 v120, 0, v3
  v_xor_b32 v121, 32, v3
  v_xor_b32 v122, 64, v3
  v_xor_b32 v123, 96, v3
  v_xor_b32 v124, 128, v3
  v_xor_b32 v125, 160, v3
  v_xor_b32 v126, 192, v3
  v_xor_b32 v127, 224, v3
  v_and_b32 v1, 31, v0
  v_lshlrev_b32 v1, 10, v1
  v_lshrrev_b32 v7, 5, v0
  v_lshlrev_b32 v7, 4, v7
  v_add_u32 v1, v1, v7
  s_lshl_b32 s26, s91, 9
  s_lshl_b32 s27, s3, 6
  s_add_u32 s26, s26, s27
  v_add_u32 v6, s26, v1
  v_lshrrev_b32 v1, 4, v0
  v_lshlrev_b32 v1, 11, v1
  v_and_b32 v3, 15, v0
  v_lshlrev_b32 v3, 4, v3
  v_add_u32 v1, v1, v3
  s_lshl_b32 s26, s3, 8
  v_add_u32 v69, s26, v1
  s_lshl_b32 s27, s90, 15
  v_add_u32 v68, s27, v69
  s_mul_i32 s55, s3, 6144
  s_add_u32 s55, s55, 98304
  v_and_b32 v1, 7, v0
  v_lshlrev_b32 v1, 5, v1
  v_add_u32 v1, s55, v1
  v_lshrrev_b32 v3, 5, v0
  v_lshlrev_b32 v3, 10, v3
  v_add_u32 v2, v1, v3
  v_bfe_u32 v3, v0, 3, 2
  v_lshlrev_b32 v3, 8, v3
  v_add_u32 v5, v1, v3
  s_add_u32 s25, s88, 3
  s_mov_b32 s27, 0
L_poll_17:
  buffer_load_dword v1, v61, s[84:87], 0 offen sc1
  s_add_u32 s27, s27, 1
  s_cmp_gt_u32 s27, 400000
  s_cbranch_scc1 L_pollx_19
  s_waitcnt vmcnt(0)
  v_cmp_ne_u32 vcc, s25, v1
  s_nop 1
  s_cbranch_vccnz L_poll_17
L_pollx_19:
  s_cmp_eq_u32 s89, 0
  s_cbranch_scc0 L_polld_18
  buffer_inv sc1
  s_waitcnt vmcnt(0)
L_polld_18:
  s_barrier
  s_branch L_joint
L_loader:
  s_sub_u32 s57, s3, 4
  s_mul_i32 s24, s7, 1000
  s_lshl_b32 s25, s61, 8
  s_add_u32 s24, s24, s25
  s_sub_u32 s24, s24, 6
  v_mov_b32 v4, 0x80000000
  v_lshrrev_b32 v1, 3, v0
  v_mul_u32_u24 v1, 8, v1
  s_add_u32 s26, s24, s57
  v_add_u32 v1, s26, v1
  v_and_b32 v2, 7, v0
  v_lshrrev_b32 v3, 4, v0
  v_xor_b32 v5, v2, v3
  v_lshlrev_b32 v5, 4, v5
  v_xor_b32 v6, 64, v5
  v_add_u32 v8, 0, v1
  v_cmp_gt_i32 vcc, 0, v8
  v_lshlrev_b32 v8, 10, v8
  v_add_u32 v8, v8, v5
  v_cndmask_b32 v8, v8, v4, vcc
  v_add_u32 v9, 64, v1
  v_cmp_gt_i32 vcc, 0, v9
  v_lshlrev_b32 v9, 10, v9
  v_add_u32 v9, v9, v6
  v_cndmask_b32 v9, v9, v4, vcc
  v_add_u32 v10, 128, v1
  v_cmp_gt_i32 vcc, 0, v10
  v_lshlrev_b32 v10, 10, v10
  v_add_u32 v10, v10, v5
  v_cndmask_b32 v10, v10, v4, vcc
  v_add_u32 v11, 192, v1
  v_cmp_gt_i32 vcc, 0, v11
  v_lshlrev_b32 v11, 10, v11
  v_add_u32 v11, v11, v6
  v_cndmask_b32 v11, v11, v4, vcc
  v_add_u32 v12, 256, v1
  v_cmp_gt_i32 vcc, 0, v12
  v_lshlrev_b32 v12, 10, v12
  v_add_u32 v12, v12, v5
  v_cndmask_b32 v12, v12, v4, vcc
  v_add_u32 v13, 4, v1
  v_cmp_gt_i32 vcc, 0, v13
  v_lshlrev_b32 v13, 10, v13
  v_add_u32 v13, v13, v5
  v_cndmask_b32 v13, v13, v4, vcc
  v_add_u32 v14, 68, v1
  v_cmp_gt_i32 vcc, 0, v14
  v_lshlrev_b32 v14, 10, v14
  v_add_u32 v14, v14, v6
  v_cndmask_b32 v14, v14, v4, vcc
  v_add_u32 v15, 132, v1
  v_cmp_gt_i32 vcc, 0, v15
  v_lshlrev_b32 v15, 10, v15
  v_add_u32 v15, v15, v5
  v_cndmask_b32 v15, v15, v4, vcc
  v_add_u32 v16, 196, v1
  v_cmp_gt_i32 vcc, 0, v16
  v_lshlrev_b32 v16, 10, v16
  v_add_u32 v16, v16, v6
  v_cndmask_b32 v16, v16, v4, vcc
  s_mul_i32 s58, s57, 4352
  v_lshrrev_b32 v1, 3, v0
  s_lshl_b32 s26, s57, 3
  v_add_u32 v1, s26, v1
  v_lshlrev_b32 v1, 10, v1
  v_and_b32 v2, 7, v0
  v_bfe_u32 v3, v0, 4, 1
  s_and_b32 s26, s57, 1
  s_lshl_b32 s26, s26, 1
  v_add_u32 v3, s26, v3
  v_lshlrev_b32 v3, 1, v3
  v_xor_b32 v2, v2, v3
  v_lshlrev_b32 v2, 4, v2
  v_add_u32 v1, v1, v2
  s_lshl_b32 s26, s62, 7
  v_add_u32 v1, s26, v1
  v_add_u32 v17, 0, v1
  v_add_u32 v18, 524288, v1
  v_add_u32 v19, 1048576, v1
  v_add_u32 v20, 1572864, v1
  v_add_u32 v21, 2097152, v1
  s_mul_i32 s59, s57, 5120
  s_waitcnt lgkmcnt(0)
  s_mul_i32 s24, s6, 4096000
  s_add_u32 s8, s32, s24
  s_addc_u32 s9, s33, 0
  s_mov_b32 s10, 4096000
  s_mov_b32 s11, 0x00020000
  s_mov_b32 s12, s34
  s_mov_b32 s13, s35
  s_mov_b32 s14, 2621440
  s_mov_b32 s15, 0x00020000
  s_lshr_b32 s30, s60, 1
  s_add_u32 s30, s30, 0
  s_and_b32 s30, s30, 7
  s_lshl_b32 s30, s30, 7
  s_add_u32 m0, s58, 0
  s_nop 0
  buffer_load_dwordx4 v8, s[8:11], s30 offen  lds
  s_add_u32 m0, s58, 1024
  s_nop 0
  buffer_load_dwordx4 v9, s[8:11], s30 offen  lds
  s_add_u32 m0, s58, 2048
  s_nop 0
  buffer_load_dwordx4 v10, s[8:11], s30 offen  lds
  s_add_u32 m0, s58, 3072
  s_nop 0
  buffer_load_dwordx4 v11, s[8:11], s30 offen  lds
  s_add_u32 m0, s58, 4096
  s_mov_b64 exec, 0xff
  buffer_load_dwordx4 v12, s[8:11], s30 offen  lds
  s_mov_b64 exec, -1
  s_add_u32 m0, s58, 17408
  s_nop 0
  buffer_load_dwordx4 v13, s[8:11], s30 offen  lds
  s_add_u32 m0, s58, 18432
  s_nop 0
  buffer_load_dwordx4 v14, s[8:11], s30 offen  lds
  s_add_u32 m0, s58, 19456
  s_nop 0
  buffer_load_dwordx4 v15, s[8:11], s30 offen  lds
  s_add_u32 m0, s58, 20480
  s_nop 0
  buffer_load_dwordx4 v16, s[8:11], s30 offen  lds
  s_add_u32 s31, s60, 0
  s_and_b32 s31, s31, 15
  s_lshl_b32 s31, s31, 15
  s_add_u32 m0, s59, 69632
  s_nop 0
  buffer_load_dwordx4 v17, s[12:15], s31 offen  lds
  s_add_u32 m0, s59, 70656
  s_nop 0
  buffer_load_dwordx4 v18, s[12:15], s31 offen  lds
  s_add_u32 m0, s59, 71680
  s_nop 0
  buffer_load_dwordx4 v19, s[12:15], s31 offen  lds
  s_add_u32 m0, s59, 72704
  s_nop 0
  buffer_load_dwordx4 v20, s[12:15], s31 offen  lds
  s_add_u32 m0, s59, 73728
  s_nop 0
  buffer_load_dwordx4 v21, s[12:15], s31 offen  lds
  s_add_u32 s31, s60, 1
  s_and_b32 s31, s31, 15
  s_lshl_b32 s31, s31, 15
  s_add_u32 m0, s59, 90112
  s_nop 0
  buffer_load_dwordx4 v17, s[12:15], s31 offen  lds
  s_add_u32 m0, s59, 91136
  s_nop 0
  buffer_load_dwordx4 v18, s[12:15], s31 offen  lds
  s_add_u32 m0, s59, 92160
  s_nop 0
  buffer_load_dwordx4 v19, s[12:15], s31 offen  lds
  s_add_u32 m0, s59, 93184
  s_nop 0
  buffer_load_dwordx4 v20, s[12:15], s31 offen  lds
  s_add_u32 m0, s59, 94208
  s_nop 0
  buffer_load_dwordx4 v21, s[12:15], s31 offen  lds
  s_lshl_b32 s24, s61, 7
  s_lshl_b32 s25, s57, 5
  s_add_u32 s24, s24, s25
  s_lshl_b32 s24, s24, 10
  s_lshl_b32 s25, s62, 7
  s_add_u32 s24, s24, s25
  s_lshl_b32 s25, s4, 19
  s_add_u32 s24, s24, s25
  s_add_u32 s66, s50, s24
  s_addc_u32 s67, s51, 0
  s_lshl_b32 s24, s61, 6
  s_lshl_b32 s25, s57, 4
  s_add_u32 s26, s24, s25
  s_lshl_b32 s24, s26, 10
  s_lshl_b32 s25, s62, 7
  s_add_u32 s24, s24, s25
  s_lshl_b32 s25, s4, 18
  s_add_u32 s24, s24, s25
  s_add_u32 s24, s24, 4194304
  s_add_u32 s68, s50, s24
  s_addc_u32 s69, s51, 0
  s_lshl_b32 s24, s26, 11
  s_lshl_b32 s25, s62, 8
  s_add_u32 s24, s24, s25
  s_lshl_b32 s25, s4, 19
  s_add_u32 s24, s24, s25
  s_add_u32 s24, s24, 6291456
  s_add_u32 s78, s50, s24
  s_addc_u32 s79, s51, 0
  s_lshl_b32 s24, s4, 14
  s_add_u32 s24, s24, 10485760
  s_lshl_b32 s25, s5, 6
  s_add_u32 s24, s24, s25
  s_lshl_b32 s25, s57, 12
  s_add_u32 s24, s24, s25
  s_add_u32 s86, s50, s24
  s_addc_u32 s87, s51, 0
  s_waitcnt vmcnt(5)
  s_barrier
  s_lshr_b32 s30, s60, 1
  s_add_u32 s30, s30, 1
  s_and_b32 s30, s30, 7
  s_lshl_b32 s30, s30, 7
  s_add_u32 m0, s58, 34816
  s_nop 0
  buffer_load_dwordx4 v8, s[8:11], s30 offen  lds
  s_add_u32 m0, s58, 35840
  s_nop 0
  buffer_load_dwordx4 v9, s[8:11], s30 offen  lds
  s_add_u32 m0, s58, 36864
  s_nop 0
  buffer_load_dwordx4 v10, s[8:11], s30 offen  lds
  s_add_u32 m0, s58, 37888
  s_nop 0
  buffer_load_dwordx4 v11, s[8:11], s30 offen  lds
  s_add_u32 m0, s58, 38912
  s_mov_b64 exec, 0xff
  buffer_load_dwordx4 v12, s[8:11], s30 offen  lds
  s_mov_b64 exec, -1
  s_add_u32 m0, s58, 52224
  s_nop 0
  buffer_load_dwordx4 v13, s[8:11], s30 offen  lds
  s_add_u32 m0, s58, 53248
  s_nop 0
  buffer_load_dwordx4 v14, s[8:11], s30 offen  lds
  s_add_u32 m0, s58, 54272
  s_nop 0
  buffer_load_dwordx4 v15, s[8:11], s30 offen  lds
  s_add_u32 m0, s58, 55296
  s_nop 0
  buffer_load_dwordx4 v16, s[8:11], s30 offen  lds
  s_waitcnt vmcnt(9)
  s_barrier
  s_add_u32 s31, s60, 2
  s_and_b32 s31, s31, 15
  s_lshl_b32 s31, s31, 15
  s_add_u32 m0, s59, 110592
  s_nop 0
  buffer_load_dwordx4 v17, s[12:15], s31 offen  lds
  s_add_u32 m0, s59, 111616
  s_nop 0
  buffer_load_dwordx4 v18, s[12:15], s31 offen  lds
  s_add_u32 m0, s59, 112640
  s_nop 0
  buffer_load_dwordx4 v19, s[12:15], s31 offen  lds
  s_add_u32 m0, s59, 113664
  s_nop 0
  buffer_load_dwordx4 v20, s[12:15], s31 offen  lds
  s_add_u32 m0, s59, 114688
  s_nop 0
  buffer_load_dwordx4 v21, s[12:15], s31 offen  lds
  s_add_u32 s31, s60, 3
  s_and_b32 s31, s31, 15
  s_lshl_b32 s31, s31, 15
  s_add_u32 m0, s59, 131072
  s_nop 0
  buffer_load_dwordx4 v17, s[12:15], s31 offen  lds
  s_add_u32 m0, s59, 132096
  s_nop 0
  buffer_load_dwordx4 v18, s[12:15], s31 offen  lds
  s_add_u32 m0, s59, 133120
  s_nop 0
  buffer_load_dwordx4 v19, s[12:15], s31 offen  lds
  s_add_u32 m0, s59, 134144
  s_nop 0
  buffer_load_dwordx4 v20, s[12:15], s31 offen  lds
  s_add_u32 m0, s59, 135168
  s_nop 0
  buffer_load_dwordx4 v21, s[12:15], s31 offen  lds
  s_add_u32 s31, s60, 4
  s_and_b32 s31, s31, 15
  s_lshl_b32 s31, s31, 15
  s_add_u32 m0, s59, 69632
  s_nop 0
  buffer_load_dwordx4 v17, s[12:15], s31 offen  lds
  s_add_u32 m0, s59, 70656
  s_nop 0
  buffer_load_dwordx4 v18, s[12:15], s31 offen  lds
  s_add_u32 m0, s59, 71680
  s_nop 0
  buffer_load_dwordx4 v19, s[12:15], s31 offen  lds
  s_add_u32 m0, s59, 72704
  s_nop 0
  buffer_load_dwordx4 v20, s[12:15], s31 offen  lds
  s_add_u32 m0, s59, 73728
  s_nop 0
  buffer_load_dwordx4 v21, s[12:15], s31 offen  lds
  s_load_dword s70, s[66:67], 0
  s_load_dword s71, s[66:67], 64
  s_load_dword s72, s[66:67], 1024
  s_load_dword s73, s[66:67], 1088
  s_load_dword s74, s[66:67], 2048
  s_waitcnt vmcnt(10)
  s_barrier
  s_lshr_b32 s30, s60, 1
  s_add_u32 s30, s30, 2
  s_and_b32 s30, s30, 7
  s_lshl_b32 s30, s30, 7
  s_add_u32 m0, s58, 0
  s_nop 0
  buffer_load_dwordx4 v8, s[8:11], s30 offen  lds
  s_add_u32 m0, s58, 1024
  s_nop 0
  buffer_load_dwordx4 v9, s[8:11], s30 offen  lds
  s_add_u32 m0, s58, 2048
  s_nop 0
  buffer_load_dwordx4 v10, s[8:11], s30 offen  lds
  s_add_u32 m0, s58, 3072
  s_nop 0
  buffer_load_dwordx4 v11, s[8:11], s30 offen  lds
  s_add_u32 m0, s58, 4096
  s_mov_b64 exec, 0xff
  buffer_load_dwordx4 v12, s[8:11], s30 offen  lds
  s_mov_b64 exec, -1
  s_add_u32 m0, s58, 17408
  s_nop 0
  buffer_load_dwordx4 v13, s[8:11], s30 offen  lds
  s_add_u32 m0, s58, 18432
  s_nop 0
  buffer_load_dwordx4 v14, s[8:11], s30 offen  lds
  s_add_u32 m0, s58, 19456
  s_nop 0
  buffer_load_dwordx4 v15, s[8:11], s30 offen  lds
  s_add_u32 m0, s58, 20480
  s_nop 0
  buffer_load_dwordx4 v16, s[8:11], s30 offen  lds
  s_load_dword s75, s[66:67], 2112
  s_load_dword s76, s[66:67], 3072
  s_load_dword s77, s[66:67], 3136
  s_load_dword s70, s[66:67], 4096
  s_load_dword s71, s[66:67], 4160
  s_waitcnt vmcnt(14)
  s_barrier
  s_add_u32 s31, s60, 5
  s_and_b32 s31, s31, 15
  s_lshl_b32 s31, s31, 15
  s_add_u32 m0, s59, 90112
  s_nop 0
  buffer_load_dwordx4 v17, s[12:15], s31 offen  lds
  s_add_u32 m0, s59, 91136
  s_nop 0
  buffer_load_dwordx4 v18, s[12:15], s31 offen  lds
  s_add_u32 m0, s59, 92160
  s_nop 0
  buffer_load_dwordx4 v19, s[12:15], s31 offen  lds
  s_add_u32 m0, s59, 93184
  s_nop 0
  buffer_load_dwordx4 v20, s[12:15], s31 offen  lds
  s_add_u32 m0, s59, 94208
  s_nop 0
  buffer_load_dwordx4 v21, s[12:15], s31 offen  lds
  s_add_u32 s31, s60, 6
  s_and_b32 s31, s31, 15
  s_lshl_b32 s31, s31, 15
  s_add_u32 m0, s59, 110592
  s_nop 0
  buffer_load_dwordx4 v17, s[12:15], s31 offen  lds
  s_add_u32 m0, s59, 111616
  s_nop 0
  buffer_load_dwordx4 v18, s[12:15], s31 offen  lds
  s_add_u32 m0, s59, 112640
  s_nop 0
  buffer_load_dwordx4 v19, s[12:15], s31 offen  lds
  s_add_u32 m0, s59, 113664
  s_nop 0
  buffer_load_dwordx4 v20, s[12:15], s31 offen  lds
  s_add_u32 m0, s59, 114688
  s_nop 0
  buffer_load_dwordx4 v21, s[12:15], s31 offen  lds
  s_load_dword s72, s[66:67], 5120
  s_load_dword s73, s[66:67], 5184
  s_load_dword s74, s[66:67], 6144
  s_load_dword s75, s[66:67], 6208
  s_load_dword s76, s[66:67], 7168
  s_waitcnt vmcnt(10)
  s_barrier
  s_lshr_b32 s30, s60, 1
  s_add_u32 s30, s30, 3
  s_and_b32 s30, s30, 7
  s_lshl_b32 s30, s30, 7
  s_add_u32 m0, s58, 34816
  s_nop 0
  buffer_load_dwordx4 v8, s[8:11], s30 offen  lds
  s_add_u32 m0, s58, 35840
  s_nop 0
  buffer_load_dwordx4 v9, s[8:11], s30 offen  lds
  s_add_u32 m0, s58, 36864
  s_nop 0
  buffer_load_dwordx4 v10, s[8:11], s30 offen  lds
  s_add_u32 m0, s58, 37888
  s_nop 0
  buffer_load_dwordx4 v11, s[8:11], s30 offen  lds
  s_add_u32 m0, s58, 38912
  s_mov_b64 exec, 0xff
  buffer_load_dwordx4 v12, s[8:11], s30 offen  lds
  s_mov_b64 exec, -1
  s_add_u32 m0, s58, 52224
  s_nop 0
  buffer_load_dwordx4 v13, s[8:11], s30 offen  lds
  s_add_u32 m0, s58, 53248
  s_nop 0
  buffer_load_dwordx4 v14, s[8:11], s30 offen  lds
  s_add_u32 m0, s58, 54272
  s_nop 0
  buffer_load_dwordx4 v15, s[8:11], s30 offen  lds
  s_add_u32 m0, s58, 55296
  s_nop 0
  buffer_load_dwordx4 v16, s[8:11], s30 offen  lds
  s_load_dword s77, s[66:67], 7232
  s_load_dword s70, s[66:67], 8192
  s_load_dword s71, s[66:67], 8256
  s_load_dword s72, s[66:67], 9216
  s_load_dword s73, s[66:67], 9280
  s_waitcnt vmcnt(14)
  s_barrier
  s_add_u32 s31, s60, 7
  s_and_b32 s31, s31, 15
  s_lshl_b32 s31, s31, 15
  s_add_u32 m0, s59, 131072
  s_nop 0
  buffer_load_dwordx4 v17, s[12:15], s31 offen  lds
  s_add_u32 m0, s59, 132096
  s_nop 0
  buffer_load_dwordx4 v18, s[12:15], s31 offen  lds
  s_add_u32 m0, s59, 133120
  s_nop 0
  buffer_load_dwordx4 v19, s[12:15], s31 offen  lds
  s_add_u32 m0, s59, 134144
  s_nop 0
  buffer_load_dwordx4 v20, s[12:15], s31 offen  lds
  s_add_u32 m0, s59, 135168
  s_nop 0
  buffer_load_dwordx4 v21, s[12:15], s31 offen  lds
  s_add_u32 s31, s60, 8
  s_and_b32 s31, s31, 15
  s_lshl_b32 s31, s31, 15
  s_add_u32 m0, s59, 69632
  s_nop 0
  buffer_load_dwordx4 v17, s[12:15], s31 offen  lds
  s_add_u32 m0, s59, 70656
  s_nop 0
  buffer_load_dwordx4 v18, s[12:15], s31 offen  lds
  s_add_u32 m0, s59, 71680
  s_nop 0
  buffer_load_dwordx4 v19, s[12:15], s31 offen  lds
  s_add_u32 m0, s59, 72704
  s_nop 0
  buffer_load_dwordx4 v20, s[12:15], s31 offen  lds
  s_add_u32 m0, s59, 73728
  s_nop 0
  buffer_load_dwordx4 v21, s[12:15], s31 offen  lds
  s_load_dword s74, s[66:67], 10240
  s_load_dword s75, s[66:67], 10304
  s_load_dword s76, s[66:67], 11264
  s_load_dword s77, s[66:67], 11328
  s_load_dword s70, s[66:67], 12288
  s_waitcnt vmcnt(10)
  s_barrier
  s_lshr_b32 s30, s60, 1
  s_add_u32 s30, s30, 4
  s_and_b32 s30, s30, 7
  s_lshl_b32 s30, s30, 7
  s_add_u32 m0, s58, 0
  s_nop 0
  buffer_load_dwordx4 v8, s[8:11], s30 offen  lds
  s_add_u32 m0, s58, 1024
  s_nop 0
  buffer_load_dwordx4 v9, s[8:11], s30 offen  lds
  s_add_u32 m0, s58, 2048
  s_nop 0
  buffer_load_dwordx4 v10, s[8:11], s30 offen  lds
  s_add_u32 m0, s58, 3072
  s_nop 0
  buffer_load_dwordx4 v11, s[8:11], s30 offen  lds
  s_add_u32 m0, s58, 4096
  s_mov_b64 exec, 0xff
  buffer_load_dwordx4 v12, s[8:11], s30 offen  lds
  s_mov_b64 exec, -1
  s_add_u32 m0, s58, 17408
  s_nop 0
  buffer_load_dwordx4 v13, s[8:11], s30 offen  lds
  s_add_u32 m0, s58, 18432
  s_nop 0
  buffer_load_dwordx4 v14, s[8:11], s30 offen  lds
  s_add_u32 m0, s58, 19456
  s_nop 0
  buffer_load_dwordx4 v15, s[8:11], s30 offen  lds
  s_add_u32 m0, s58, 20480
  s_nop 0
  buffer_load_dwordx4 v16, s[8:11], s30 offen  lds
  s_load_dword s71, s[66:67], 12352
  s_load_dword s72, s[66:67], 13312
  s_load_dword s73, s[66:67], 13376
  s_load_dword s74, s[66:67], 14336
  s_load_dword s75, s[66:67], 14400
  s_waitcnt vmcnt(14)
  s_barrier
  s_add_u32 s31, s60, 9
  s_and_b32 s31, s31, 15
  s_lshl_b32 s31, s31, 15
  s_add_u32 m0, s59, 90112
  s_nop 0
  buffer_load_dwordx4 v17, s[12:15], s31 offen  lds
  s_add_u32 m0, s59, 91136
  s_nop 0
  buffer_load_dwordx4 v18, s[12:15], s31 offen  lds
  s_add_u32 m0, s59, 92160
  s_nop 0
  buffer_load_dwordx4 v19, s[12:15], s31 offen  lds
  s_add_u32 m0, s59, 93184
  s_nop 0
  buffer_load_dwordx4 v20, s[12:15], s31 offen  lds
  s_add_u32 m0, s59, 94208
  s_nop 0
  buffer_load_dwordx4 v21, s[12:15], s31 offen  lds
  s_add_u32 s31, s60, 10
  s_and_b32 s31, s31, 15
  s_lshl_b32 s31, s31, 15
  s_add_u32 m0, s59, 110592
  s_nop 0
  buffer_load_dwordx4 v17, s[12:15], s31 offen  lds
  s_add_u32 m0, s59, 111616
  s_nop 0
  buffer_load_dwordx4 v18, s[12:15], s31 offen  lds
  s_add_u32 m0, s59, 112640
  s_nop 0
  buffer_load_dwordx4 v19, s[12:15], s31 offen  lds
  s_add_u32 m0, s59, 113664
  s_nop 0
  buffer_load_dwordx4 v20, s[12:15], s31 offen  lds
  s_add_u32 m0, s59, 114688
  s_nop 0
  buffer_load_dwordx4 v21, s[12:15], s31 offen  lds
  s_load_dword s76, s[66:67], 15360
  s_load_dword s77, s[66:67], 15424
  s_load_dword s70, s[66:67], 16384
  s_load_dword s71, s[66:67], 16448
  s_load_dword s72, s[66:67], 17408
  s_waitcnt vmcnt(10)
  s_barrier
  s_lshr_b32 s30, s60, 1
  s_add_u32 s30, s30, 5
  s_and_b32 s30, s30, 7
  s_lshl_b32 s30, s30, 7
  s_add_u32 m0, s58, 34816
  s_nop 0
  buffer_load_dwordx4 v8, s[8:11], s30 offen  lds
  s_add_u32 m0, s58, 35840
  s_nop 0
  buffer_load_dwordx4 v9, s[8:11], s30 offen  lds
  s_add_u32 m0, s58, 36864
  s_nop 0
  buffer_load_dwordx4 v10, s[8:11], s30 offen  lds
  s_add_u32 m0, s58, 37888
  s_nop 0
  buffer_load_dwordx4 v11, s[8:11], s30 offen  lds
  s_add_u32 m0, s58, 38912
  s_mov_b64 exec, 0xff
  buffer_load_dwordx4 v12, s[8:11], s30 offen  lds
  s_mov_b64 exec, -1
  s_add_u32 m0, s58, 52224
  s_nop 0
  buffer_load_dwordx4 v13, s[8:11], s30 offen  lds
  s_add_u32 m0, s58, 53248
  s_nop 0
  buffer_load_dwordx4 v14, s[8:11], s30 offen  lds
  s_add_u32 m0, s58, 54272
  s_nop 0
  buffer_load_dwordx4 v15, s[8:11], s30 offen  lds
  s_add_u32 m0, s58, 55296
  s_nop 0
  buffer_load_dwordx4 v16, s[8:11], s30 offen  lds
  s_load_dword s73, s[66:67], 17472
  s_load_dword s74, s[66:67], 18432
  s_load_dword s75, s[66:67], 18496
  s_load_dword s76, s[66:67], 19456
  s_load_dword s77, s[66:67], 19520
  s_waitcnt vmcnt(14)
  s_barrier
  s_add_u32 s31, s60, 11
  s_and_b32 s31, s31, 15
  s_lshl_b32 s31, s31, 15
  s_add_u32 m0, s59, 131072
  s_nop 0
  buffer_load_dwordx4 v17, s[12:15], s31 offen  lds
  s_add_u32 m0, s59, 132096
  s_nop 0
  buffer_load_dwordx4 v18, s[12:15], s31 offen  lds
  s_add_u32 m0, s59, 133120
  s_nop 0
  buffer_load_dwordx4 v19, s[12:15], s31 offen  lds
  s_add_u32 m0, s59, 134144
  s_nop 0
  buffer_load_dwordx4 v20, s[12:15], s31 offen  lds
  s_add_u32 m0, s59, 135168
  s_nop 0
  buffer_load_dwordx4 v21, s[12:15], s31 offen  lds
  s_add_u32 s31, s60, 12
  s_and_b32 s31, s31, 15
  s_lshl_b32 s31, s31, 15
  s_add_u32 m0, s59, 69632
  s_nop 0
  buffer_load_dwordx4 v17, s[12:15], s31 offen  lds
  s_add_u32 m0, s59, 70656
  s_nop 0
  buffer_load_dwordx4 v18, s[12:15], s31 offen  lds
  s_add_u32 m0, s59, 71680
  s_nop 0
  buffer_load_dwordx4 v19, s[12:15], s31 offen  lds
  s_add_u32 m0, s59, 72704
  s_nop 0
  buffer_load_dwordx4 v20, s[12:15], s31 offen  lds
  s_add_u32 m0, s59, 73728
  s_nop 0
  buffer_load_dwordx4 v21, s[12:15], s31 offen  lds
  s_load_dword s70, s[66:67], 20480
  s_load_dword s71, s[66:67], 20544
  s_load_dword s72, s[66:67], 21504
  s_load_dword s73, s[66:67], 21568
  s_load_dword s74, s[66:67], 22528
  s_cmp_lg_u32 s3, 7
  s_cbranch_scc1 L_ow_20
  s_mov_b32 s20, s44
  s_mov_b32 s21, s45
  s_mov_b32 s22, 524288
  s_mov_b32 s23, 0x00020000
  v_lshrrev_b32 v72, 3, v0
  s_lshr_b32 s24, s2, 3
  s_lshl_b32 s24, s24, 4
  v_add_u32 v72, s24, v72
  v_lshlrev_b32 v72, 10, v72
  v_and_b32 v73, 7, v0
  v_bfe_u32 v74, v0, 4, 1
  v_lshlrev_b32 v74, 2, v74
  v_xor_b32 v73, v73, v74
  v_lshlrev_b32 v73, 4, v73
  v_add_u32 v72, v72, v73
  s_and_b32 s24, s2, 7
  s_lshl_b32 s24, s24, 7
  v_add_u32 v72, s24, v72
  s_mov_b32 m0, 151552
  s_mov_b32 s24, 0
  buffer_load_dwordx4 v72, s[20:23], s24 offen lds
  s_mov_b32 m0, 152576
  s_mov_b32 s24, 8192
  buffer_load_dwordx4 v72, s[20:23], s24 offen lds
L_ow_20:
  s_waitcnt vmcnt(10)
  s_barrier
  s_lshr_b32 s30, s60, 1
  s_add_u32 s30, s30, 6
  s_and_b32 s30, s30, 7
  s_lshl_b32 s30, s30, 7
  s_add_u32 m0, s58, 0
  s_nop 0
  buffer_load_dwordx4 v8, s[8:11], s30 offen  lds
  s_add_u32 m0, s58, 1024
  s_nop 0
  buffer_load_dwordx4 v9, s[8:11], s30 offen  lds
  s_add_u32 m0, s58, 2048
  s_nop 0
  buffer_load_dwordx4 v10, s[8:11], s30 offen  lds
  s_add_u32 m0, s58, 3072
  s_nop 0
  buffer_load_dwordx4 v11, s[8:11], s30 offen  lds
  s_add_u32 m0, s58, 4096
  s_mov_b64 exec, 0xff
  buffer_load_dwordx4 v12, s[8:11], s30 offen  lds
  s_mov_b64 exec, -1
  s_add_u32 m0, s58, 17408
  s_nop 0
  buffer_load_dwordx4 v13, s[8:11], s30 offen  lds
  s_add_u32 m0, s58, 18432
  s_nop 0
  buffer_load_dwordx4 v14, s[8:11], s30 offen  lds
  s_add_u32 m0, s58, 19456
  s_nop 0
  buffer_load_dwordx4 v15, s[8:11], s30 offen  lds
  s_add_u32 m0, s58, 20480
  s_nop 0
  buffer_load_dwordx4 v16, s[8:11], s30 offen  lds
  s_load_dword s75, s[66:67], 22592
  s_load_dword s76, s[66:67], 23552
  s_load_dword s77, s[66:67], 23616
  s_load_dword s70, s[66:67], 24576
  s_load_dword s71, s[66:67], 24640
  s_waitcnt vmcnt(14)
  s_barrier
  s_add_u32 s31, s60, 13
  s_and_b32 s31, s31, 15
  s_lshl_b32 s31, s31, 15
  s_add_u32 m0, s59, 90112
  s_nop 0
  buffer_load_dwordx4 v17, s[12:15], s31 offen  lds
  s_add_u32 m0, s59, 91136
  s_nop 0
  buffer_load_dwordx4 v18, s[12:15], s31 offen  lds
  s_add_u32 m0, s59, 92160
  s_nop 0
  buffer_load_dwordx4 v19, s[12:15], s31 offen  lds
  s_add_u32 m0, s59, 93184
  s_nop 0
  buffer_load_dwordx4 v20, s[12:15], s31 offen  lds
  s_add_u32 m0, s59, 94208
  s_nop 0
  buffer_load_dwordx4 v21, s[12:15], s31 offen  lds
  s_add_u32 s31, s60, 14
  s_and_b32 s31, s31, 15
  s_lshl_b32 s31, s31, 15
  s_add_u32 m0, s59, 110592
  s_nop 0
  buffer_load_dwordx4 v17, s[12:15], s31 offen  lds
  s_add_u32 m0, s59, 111616
  s_nop 0
  buffer_load_dwordx4 v18, s[12:15], s31 offen  lds
  s_add_u32 m0, s59, 112640
  s_nop 0
  buffer_load_dwordx4 v19, s[12:15], s31 offen  lds
  s_add_u32 m0, s59, 113664
  s_nop 0
  buffer_load_dwordx4 v20, s[12:15], s31 offen  lds
  s_add_u32 m0, s59, 114688
  s_nop 0
  buffer_load_dwordx4 v21, s[12:15], s31 offen  lds
  s_load_dword s72, s[66:67], 25600
  s_load_dword s73, s[66:67], 25664
  s_load_dword s74, s[66:67], 26624
  s_load_dword s75, s[66:67], 26688
  s_load_dword s76, s[66:67], 27648
  s_waitcnt vmcnt(10)
  s_barrier
  s_lshr_b32 s30, s60, 1
  s_add_u32 s30, s30, 7
  s_and_b32 s30, s30, 7
  s_lshl_b32 s30, s30, 7
  s_add_u32 m0, s58, 34816
  s_nop 0
  buffer_load_dwordx4 v8, s[8:11], s30 offen  lds
  s_add_u32 m0, s58, 35840
  s_nop 0
  buffer_load_dwordx4 v9, s[8:11], s30 offen  lds
  s_add_u32 m0, s58, 36864
  s_nop 0
  buffer_load_dwordx4 v10, s[8:11], s30 offen  lds
  s_add_u32 m0, s58, 37888
  s_nop 0
  buffer_load_dwordx4 v11, s[8:11], s30 offen  lds
  s_add_u32 m0, s58, 38912
  s_mov_b64 exec, 0xff
  buffer_load_dwordx4 v12, s[8:11], s30 offen  lds
  s_mov_b64 exec, -1
  s_add_u32 m0, s58, 52224
  s_nop 0
  buffer_load_dwordx4 v13, s[8:11], s30 offen  lds
  s_add_u32 m0, s58, 53248
  s_nop 0
  buffer_load_dwordx4 v14, s[8:11], s30 offen  lds
  s_add_u32 m0, s58, 54272
  s_nop 0
  buffer_load_dwordx4 v15, s[8:11], s30 offen  lds
  s_add_u32 m0, s58, 55296
  s_nop 0
  buffer_load_dwordx4 v16, s[8:11], s30 offen  lds
  s_load_dword s77, s[66:67], 27712
  s_load_dword s70, s[66:67], 28672
  s_load_dword s71, s[66:67], 28736
  s_load_dword s72, s[66:67], 29696
  s_load_dword s73, s[66:67], 29760
  s_waitcnt vmcnt(14)
  s_barrier
  s_add_u32 s31, s60, 15
  s_and_b32 s31, s31, 15
  s_lshl_b32 s31, s31, 15
  s_add_u32 m0, s59, 131072
  s_nop 0
  buffer_load_dwordx4 v17, s[12:15], s31 offen  lds
  s_add_u32 m0, s59, 132096
  s_nop 0
  buffer_load_dwordx4 v18, s[12:15], s31 offen  lds
  s_add_u32 m0, s59, 133120
  s_nop 0
  buffer_load_dwordx4 v19, s[12:15], s31 offen  lds
  s_add_u32 m0, s59, 134144
  s_nop 0
  buffer_load_dwordx4 v20, s[12:15], s31 offen  lds
  s_add_u32 m0, s59, 135168
  s_nop 0
  buffer_load_dwordx4 v21, s[12:15], s31 offen  lds
  s_load_dword s74, s[66:67], 30720
  s_load_dword s75, s[66:67], 30784
  s_load_dword s76, s[66:67], 31744
  s_load_dword s77, s[66:67], 31808
  s_load_dword s70, s[68:69], 0
  s_waitcnt vmcnt(5)
  s_barrier
  s_load_dword s71, s[68:69], 64
  s_load_dword s72, s[68:69], 1024
  s_load_dword s73, s[68:69], 1088
  s_load_dword s74, s[68:69], 2048
  s_load_dword s75, s[68:69], 2112
  s_waitcnt vmcnt(0)
  s_barrier
  s_mov_b32 s12, s36
  s_mov_b32 s13, s37
  s_mov_b32 s14, 2621440
  s_mov_b32 s15, 0x00020000
  s_add_u32 s31, s60, 0
  s_and_b32 s31, s31, 15
  s_lshl_b32 s31, s31, 15
  s_add_u32 m0, s59, 69632
  s_nop 0
  buffer_load_dwordx4 v17, s[12:15], s31 offen  lds
  s_add_u32 m0, s59, 70656
  s_nop 0
  buffer_load_dwordx4 v18, s[12:15], s31 offen  lds
  s_add_u32 m0, s59, 71680
  s_nop 0
  buffer_load_dwordx4 v19, s[12:15], s31 offen  lds
  s_add_u32 m0, s59, 72704
  s_nop 0
  buffer_load_dwordx4 v20, s[12:15], s31 offen  lds
  s_add_u32 m0, s59, 73728
  s_nop 0
  buffer_load_dwordx4 v21, s[12:15], s31 offen  lds
  s_add_u32 s31, s60, 1
  s_and_b32 s31, s31, 15
  s_lshl_b32 s31, s31, 15
  s_add_u32 m0, s59, 90112
  s_nop 0
  buffer_load_dwordx4 v17, s[12:15], s31 offen  lds
  s_add_u32 m0, s59, 91136
  s_nop 0
  buffer_load_dwordx4 v18, s[12:15], s31 offen  lds
  s_add_u32 m0, s59, 92160
  s_nop 0
  buffer_load_dwordx4 v19, s[12:15], s31 offen  lds
  s_add_u32 m0, s59, 93184
  s_nop 0
  buffer_load_dwordx4 v20, s[12:15], s31 offen  lds
  s_add_u32 m0, s59, 94208
  s_nop 0
  buffer_load_dwordx4 v21, s[12:15], s31 offen  lds
  s_add_u32 s31, s60, 2
  s_and_b32 s31, s31, 15
  s_lshl_b32 s31, s31, 15
  s_add_u32 m0, s59, 110592
  s_nop 0
  buffer_load_dwordx4 v17, s[12:15], s31 offen  lds
  s_add_u32 m0, s59, 111616
  s_nop 0
  buffer_load_dwordx4 v18, s[12:15], s31 offen  lds
  s_add_u32 m0, s59, 112640
  s_nop 0
  buffer_load_dwordx4 v19, s[12:15], s31 offen  lds
  s_add_u32 m0, s59, 113664
  s_nop 0
  buffer_load_dwordx4 v20, s[12:15], s31 offen  lds
  s_add_u32 m0, s59, 114688
  s_nop 0
  buffer_load_dwordx4 v21, s[12:15], s31 offen  lds
  s_barrier
  s_cmp_lg_u32 s3, 7
  s_cbranch_scc1 L_ow_21
  s_lshr_b32 s52, s4, 2
  s_lshl_b32 s52, s52, 7
  s_and_b32 s55, s4, 3
  s_lshl_b32 s55, s55, 3
  s_add_u32 s52, s52, s55
  v_mov_b32 v34, s52
  global_load_dwordx2 v[32:33], v34, s[48:49] sc1
  s_waitcnt lgkmcnt(0)
  v_lshrrev_b32 v72, 5, v0
  v_lshlrev_b32 v72, 10, v72
  v_bfe_u32 v73, v0, 2, 2
  v_lshlrev_b32 v74, 7, v73
  v_add_u32 v72, v72, v74
  v_bfe_u32 v74, v0, 4, 1
  v_lshlrev_b32 v74, 1, v74
  v_bfe_u32 v75, v0, 1, 1
  v_add_u32 v74, v74, v75
  v_lshrrev_b32 v73, 1, v73
  v_lshlrev_b32 v73, 2, v73
  v_xor_b32 v74, v74, v73
  v_lshlrev_b32 v75, 4, v74
  v_add_u32 v75, v72, v75
  v_and_b32 v73, 1, v0
  v_lshlrev_b32 v73, 3, v73
  v_add_u32 v75, v75, v73
  v_add_u32 v75, 151552, v75
  v_xor_b32 v74, 64, v75
  ds_read_b64_tr_b16 v[76:77], v75
  ds_read_b64_tr_b16 v[78:79], v75 offset:512
  ds_read_b64_tr_b16 v[80:81], v74
  ds_read_b64_tr_b16 v[82:83], v74 offset:512
  s_waitcnt lgkmcnt(0)
  s_add_u32 s20, s50, 12582912
  s_addc_u32 s21, s51, 0
  s_mov_b32 s22, 524288
  s_mov_b32 s23, 0x00020000
  s_and_b32 s24, s2, 7
  s_lshl_b32 s24, s24, 16
  s_lshr_b32 s25, s2, 3
  s_lshl_b32 s25, s25, 10
  s_add_u32 s24, s24, s25
  v_lshlrev_b32 v73, 4, v0
  buffer_store_dwordx4 v[76:79], v73, s[20:23], s24 offen sc1
  s_add_u32 s24, s24, 32768
  buffer_store_dwordx4 v[80:83], v73, s[20:23], s24 offen sc1
  s_waitcnt vmcnt(0)
  s_mov_b32 s27, 0
L_cenp_22:
  v_readfirstlane_b32 s24, v32
  v_readfirstlane_b32 s88, v33
  s_nop 0
  s_and_b32 s25, s24, 63
  s_cmp_eq_u32 s25, 32
  s_cbranch_scc1 L_cenok_23
  s_add_u32 s27, s27, 1
  s_cmp_gt_u32 s27, 400000
  s_cbranch_scc1 L_cenok_23
  s_sleep 4
  global_load_dwordx2 v[32:33], v34, s[48:49] sc1
  s_waitcnt vmcnt(0)
  s_branch L_cenp_22
L_cenok_23:
  s_getreg_b32 s25, hwreg(HW_REG_XCC_ID)
  s_and_b32 s25, s25, 15
  s_mul_i32 s26, s25, s25
  s_lshl_b32 s26, s26, 25
  s_lshl_b32 s25, s25, 13
  s_add_u32 s25, s25, s26
  s_add_u32 s25, s25, 32
  s_cmp_eq_u32 s24, s25
  s_cselect_b32 s89, 1, 0
  s_and_b32 s24, s2, 63
  s_lshl_b32 s24, s24, 2
  s_lshr_b32 s25, s2, 6
  s_add_u32 s24, s24, s25
  s_lshl_b32 s24, s24, 2
  s_add_u32 s24, s24, 11599872
  s_add_u32 s25, s88, 5
  v_mov_b32 v72, s24
  v_mov_b32 v73, s25
  s_mov_b64 exec, 1
  global_store_dword v72, v73, s[50:51] sc1
  s_mov_b64 exec, -1
L_ow_21:
  s_cmp_lg_u32 s3, 6
  s_cbranch_scc1 L_ow_24
  s_lshl_b32 s24, s2, 11
  v_and_b32 v1, 15, v0
  v_lshlrev_b32 v1, 7, v1
  v_add_u32 v1, s24, v1
  s_mov_b64 exec, 0xffff
  global_load_dword v30, v1, s[40:41]
  global_load_dword v30, v1, s[42:43]
  s_mov_b64 exec, -1
L_ow_24:
  s_lshl_b32 s24, s4, 19
  s_add_u32 s8, s50, s24
  s_addc_u32 s9, s51, 0
  s_mov_b32 s10, 524288
  s_mov_b32 s11, 0x00020000
  v_mov_b32 v4, 0x80000000
  s_lshl_b32 s24, s61, 7
  v_lshrrev_b32 v1, 3, v0
  v_mul_u32_u24 v1, 4, v1
  s_add_u32 s26, s24, s57
  v_add_u32 v1, s26, v1
  v_and_b32 v2, 7, v0
  v_lshrrev_b32 v3, 4, v0
  v_xor_b32 v5, v2, v3
  v_lshlrev_b32 v5, 4, v5
  v_xor_b32 v6, 64, v5
  v_add_u32 v8, 0, v1
  v_cmp_gt_i32 vcc, 0, v8
  v_lshlrev_b32 v8, 10, v8
  v_add_u32 v8, v8, v5
  v_cndmask_b32 v8, v8, v4, vcc
  v_add_u32 v9, 32, v1
  v_cmp_gt_i32 vcc, 0, v9
  v_lshlrev_b32 v9, 10, v9
  v_add_u32 v9, v9, v6
  v_cndmask_b32 v9, v9, v4, vcc
  v_add_u32 v10, 64, v1
  v_cmp_gt_i32 vcc, 0, v10
  v_lshlrev_b32 v10, 10, v10
  v_add_u32 v10, v10, v5
  v_cndmask_b32 v10, v10, v4, vcc
  v_add_u32 v11, 96, v1
  v_cmp_gt_i32 vcc, 0, v11
  v_lshlrev_b32 v11, 10, v11
  v_add_u32 v11, v11, v6
  v_cndmask_b32 v11, v11, v4, vcc
  v_add_u32 v12, 128, v1
  v_cmp_gt_i32 vcc, 0, v12
  v_lshlrev_b32 v12, 10, v12
  v_add_u32 v12, v12, v5
  v_cndmask_b32 v12, v12, v4, vcc
  s_mul_i32 s58, s57, 4352
  v_lshrrev_b32 v1, 3, v0
  s_lshl_b32 s26, s57, 3
  v_add_u32 v1, s26, v1
  v_lshlrev_b32 v1, 10, v1
  v_and_b32 v2, 7, v0
  v_bfe_u32 v3, v0, 4, 1
  v_lshlrev_b32 v3, 2, v3
  v_xor_b32 v2, v2, v3
  v_lshlrev_b32 v2, 4, v2
  v_add_u32 v1, v1, v2
  s_lshl_b32 s26, s62, 7
  v_add_u32 v22, s26, v1
  v_lshrrev_b32 v1, 1, v0
  s_lshl_b32 s26, s57, 5
  v_add_u32 v1, s26, v1
  v_lshlrev_b32 v1, 10, v1
  v_and_b32 v2, 1, v0
  v_lshlrev_b32 v2, 4, v2
  v_add_u32 v1, v1, v2
  s_lshl_b32 s26, s5, 5
  v_add_u32 v23, s26, v1
  v_lshlrev_b32 v26, 4, v0
  s_lshl_b32 s81, s57, 10
  s_mov_b32 s20, s40
  s_mov_b32 s21, s41
  s_mov_b32 s22, 524288
  s_mov_b32 s23, 0x00020000
  s_waitcnt vmcnt(10)
  s_barrier
  s_lshr_b32 s30, s60, 1
  s_add_u32 s30, s30, 1
  s_and_b32 s30, s30, 7
  s_lshl_b32 s30, s30, 7
  s_add_u32 m0, s58, 17408
  s_nop 0
  buffer_load_dwordx4 v8, s[8:11], s30 offen  lds
  s_add_u32 m0, s58, 18432
  s_nop 0
  buffer_load_dwordx4 v9, s[8:11], s30 offen  lds
  s_add_u32 m0, s58, 19456
  s_nop 0
  buffer_load_dwordx4 v10, s[8:11], s30 offen  lds
  s_add_u32 m0, s58, 20480
  s_nop 0
  buffer_load_dwordx4 v11, s[8:11], s30 offen  lds
  s_add_u32 m0, s58, 21504
  s_mov_b64 exec, 0xff
  buffer_load_dwordx4 v12, s[8:11], s30 offen  lds
  s_mov_b64 exec, -1
  s_add_u32 s31, s60, 3
  s_and_b32 s31, s31, 15
  s_lshl_b32 s31, s31, 15
  s_add_u32 m0, s59, 131072
  s_nop 0
  buffer_load_dwordx4 v17, s[12:15], s31 offen  lds
  s_add_u32 m0, s59, 132096
  s_nop 0
  buffer_load_dwordx4 v18, s[12:15], s31 offen  lds
  s_add_u32 m0, s59, 133120
  s_nop 0
  buffer_load_dwordx4 v19, s[12:15], s31 offen  lds
  s_add_u32 m0, s59, 134144
  s_nop 0
  buffer_load_dwordx4 v20, s[12:15], s31 offen  lds
  s_add_u32 m0, s59, 135168
  s_nop 0
  buffer_load_dwordx4 v21, s[12:15], s31 offen  lds
  s_waitcnt vmcnt(15)
  s_barrier
  s_add_u32 s31, s60, 4
  s_and_b32 s31, s31, 15
  s_lshl_b32 s31, s31, 15
  s_add_u32 m0, s59, 49152
  s_nop 0
  buffer_load_dwordx4 v17, s[12:15], s31 offen  lds
  s_add_u32 m0, s59, 50176
  s_nop 0
  buffer_load_dwordx4 v18, s[12:15], s31 offen  lds
  s_add_u32 m0, s59, 51200
  s_nop 0
  buffer_load_dwordx4 v19, s[12:15], s31 offen  lds
  s_add_u32 m0, s59, 52224
  s_nop 0
  buffer_load_dwordx4 v20, s[12:15], s31 offen  lds
  s_add_u32 m0, s59, 53248
  s_nop 0
  buffer_load_dwordx4 v21, s[12:15], s31 offen  lds
  s_add_u32 s31, s60, 5
  s_and_b32 s31, s31, 15
  s_lshl_b32 s31, s31, 15
  s_add_u32 m0, s59, 69632
  s_nop 0
  buffer_load_dwordx4 v17, s[12:15], s31 offen  lds
  s_add_u32 m0, s59, 70656
  s_nop 0
  buffer_load_dwordx4 v18, s[12:15], s31 offen  lds
  s_add_u32 m0, s59, 71680
  s_nop 0
  buffer_load_dwordx4 v19, s[12:15], s31 offen  lds
  s_add_u32 m0, s59, 72704
  s_nop 0
  buffer_load_dwordx4 v20, s[12:15], s31 offen  lds
  s_add_u32 m0, s59, 73728
  s_nop 0
  buffer_load_dwordx4 v21, s[12:15], s31 offen  lds
  s_load_dword s76, s[68:69], 3072
  s_load_dword s77, s[68:69], 3136
  s_load_dword s70, s[68:69], 4096
  s_load_dword s71, s[68:69], 4160
  s_waitcnt vmcnt(15)
  s_barrier
  s_lshr_b32 s30, s60, 1
  s_add_u32 s30, s30, 2
  s_and_b32 s30, s30, 7
  s_lshl_b32 s30, s30, 7
  s_add_u32 m0, s58, 0
  s_nop 0
  buffer_load_dwordx4 v8, s[8:11], s30 offen  lds
  s_add_u32 m0, s58, 1024
  s_nop 0
  buffer_load_dwordx4 v9, s[8:11], s30 offen  lds
  s_add_u32 m0, s58, 2048
  s_nop 0
  buffer_load_dwordx4 v10, s[8:11], s30 offen  lds
  s_add_u32 m0, s58, 3072
  s_nop 0
  buffer_load_dwordx4 v11, s[8:11], s30 offen  lds
  s_add_u32 m0, s58, 4096
  s_mov_b64 exec, 0xff
  buffer_load_dwordx4 v12, s[8:11], s30 offen  lds
  s_mov_b64 exec, -1
  s_add_u32 s31, s60, 6
  s_and_b32 s31, s31, 15
  s_lshl_b32 s31, s31, 15
  s_add_u32 m0, s59, 90112
  s_nop 0
  buffer_load_dwordx4 v17, s[12:15], s31 offen  lds
  s_add_u32 m0, s59, 91136
  s_nop 0
  buffer_load_dwordx4 v18, s[12:15], s31 offen  lds
  s_load_dword s72, s[68:69], 5120
  s_load_dword s73, s[68:69], 5184
  s_load_dword s74, s[68:69], 6144
  s_load_dword s75, s[68:69], 6208
  v_and_b32 v42, 7, v0
  v_lshrrev_b32 v43, 2, v42
  v_lshlrev_b32 v43, 7, v43
  v_and_b32 v42, 3, v42
  v_lshlrev_b32 v42, 3, v42
  v_add_u32 v42, v42, v43
  v_lshlrev_b32 v43, 4, v0
  v_add_u32 v43, 11599872, v43
  global_load_dwordx2 v[36:37], v42, s[48:49] sc1
  global_load_dwordx4 v[38:41], v43, s[50:51] sc1
  s_waitcnt vmcnt(17)
  s_barrier
  s_add_u32 s31, s60, 6
  s_and_b32 s31, s31, 15
  s_lshl_b32 s31, s31, 15
  s_add_u32 m0, s59, 92160
  s_nop 0
  buffer_load_dwordx4 v19, s[12:15], s31 offen  lds
  s_add_u32 m0, s59, 93184
  s_nop 0
  buffer_load_dwordx4 v20, s[12:15], s31 offen  lds
  s_add_u32 m0, s59, 94208
  s_nop 0
  buffer_load_dwordx4 v21, s[12:15], s31 offen  lds
  s_add_u32 s31, s60, 7
  s_and_b32 s31, s31, 15
  s_lshl_b32 s31, s31, 15
  s_add_u32 m0, s59, 110592
  s_nop 0
  buffer_load_dwordx4 v17, s[12:15], s31 offen  lds
  s_add_u32 m0, s59, 111616
  s_nop 0
  buffer_load_dwordx4 v18, s[12:15], s31 offen  lds
  s_add_u32 m0, s59, 112640
  s_nop 0
  buffer_load_dwordx4 v19, s[12:15], s31 offen  lds
  s_add_u32 m0, s59, 113664
  s_nop 0
  buffer_load_dwordx4 v20, s[12:15], s31 offen  lds
  s_add_u32 m0, s59, 114688
  s_nop 0
  buffer_load_dwordx4 v21, s[12:15], s31 offen  lds
  s_load_dword s76, s[68:69], 7168
  s_load_dword s77, s[68:69], 7232
  s_load_dword s70, s[68:69], 8192
  s_load_dword s71, s[68:69], 8256
  s_waitcnt vmcnt(10)
  s_barrier
  s_lshr_b32 s30, s60, 1
  s_add_u32 s30, s30, 3
  s_and_b32 s30, s30, 7
  s_lshl_b32 s30, s30, 7
  s_add_u32 m0, s58, 17408
  s_nop 0
  buffer_load_dwordx4 v8, s[8:11], s30 offen  lds
  s_add_u32 m0, s58, 18432
  s_nop 0
  buffer_load_dwordx4 v9, s[8:11], s30 offen  lds
  s_add_u32 m0, s58, 19456
  s_nop 0
  buffer_load_dwordx4 v10, s[8:11], s30 offen  lds
  s_add_u32 m0, s58, 20480
  s_nop 0
  buffer_load_dwordx4 v11, s[8:11], s30 offen  lds
  s_add_u32 m0, s58, 21504
  s_mov_b64 exec, 0xff
  buffer_load_dwordx4 v12, s[8:11], s30 offen  lds
  s_mov_b64 exec, -1
  s_add_u32 s31, s60, 8
  s_and_b32 s31, s31, 15
  s_lshl_b32 s31, s31, 15
  s_add_u32 m0, s59, 131072
  s_nop 0
  buffer_load_dwordx4 v17, s[12:15], s31 offen  lds
  s_add_u32 m0, s59, 132096
  s_nop 0
  buffer_load_dwordx4 v18, s[12:15], s31 offen  lds
  s_load_dword s72, s[68:69], 9216
  s_load_dword s73, s[68:69], 9280
  s_load_dword s74, s[68:69], 10240
  s_load_dword s75, s[68:69], 10304
  s_waitcnt vmcnt(17)
  s_barrier
  s_add_u32 s31, s60, 8
  s_and_b32 s31, s31, 15
  s_lshl_b32 s31, s31, 15
  s_add_u32 m0, s59, 133120
  s_nop 0
  buffer_load_dwordx4 v19, s[12:15], s31 offen  lds
  s_add_u32 m0, s59, 134144
  s_nop 0
  buffer_load_dwordx4 v20, s[12:15], s31 offen  lds
  s_add_u32 m0, s59, 135168
  s_nop 0
  buffer_load_dwordx4 v21, s[12:15], s31 offen  lds
  s_add_u32 s31, s60, 9
  s_and_b32 s31, s31, 15
  s_lshl_b32 s31, s31, 15
  s_add_u32 m0, s59, 49152
  s_nop 0
  buffer_load_dwordx4 v17, s[12:15], s31 offen  lds
  s_add_u32 m0, s59, 50176
  s_nop 0
  buffer_load_dwordx4 v18, s[12:15], s31 offen  lds
  s_add_u32 m0, s59, 51200
  s_nop 0
  buffer_load_dwordx4 v19, s[12:15], s31 offen  lds
  s_add_u32 m0, s59, 52224
  s_nop 0
  buffer_load_dwordx4 v20, s[12:15], s31 offen  lds
  s_add_u32 m0, s59, 53248
  s_nop 0
  buffer_load_dwordx4 v21, s[12:15], s31 offen  lds
  s_load_dword s76, s[68:69], 11264
  s_load_dword s77, s[68:69], 11328
  s_load_dword s70, s[68:69], 12288
  s_load_dword s71, s[68:69], 12352
  s_waitcnt vmcnt(10)
  s_barrier
  s_lshr_b32 s30, s60, 1
  s_add_u32 s30, s30, 4
  s_and_b32 s30, s30, 7
  s_lshl_b32 s30, s30, 7
  s_add_u32 m0, s58, 0
  s_nop 0
  buffer_load_dwordx4 v8, s[8:11], s30 offen  lds
  s_add_u32 m0, s58, 1024
  s_nop 0
  buffer_load_dwordx4 v9, s[8:11], s30 offen  lds
  s_add_u32 m0, s58, 2048
  s_nop 0
  buffer_load_dwordx4 v10, s[8:11], s30 offen  lds
  s_add_u32 m0, s58, 3072
  s_nop 0
  buffer_load_dwordx4 v11, s[8:11], s30 offen  lds
  s_add_u32 m0, s58, 4096
  s_mov_b64 exec, 0xff
  buffer_load_dwordx4 v12, s[8:11], s30 offen  lds
  s_mov_b64 exec, -1
  s_add_u32 s31, s60, 10
  s_and_b32 s31, s31, 15
  s_lshl_b32 s31, s31, 15
  s_add_u32 m0, s59, 69632
  s_nop 0
  buffer_load_dwordx4 v17, s[12:15], s31 offen  lds
  s_add_u32 m0, s59, 70656
  s_nop 0
  buffer_load_dwordx4 v18, s[12:15], s31 offen  lds
  s_load_dword s72, s[68:69], 13312
  s_load_dword s73, s[68:69], 13376
  s_load_dword s74, s[68:69], 14336
  s_load_dword s75, s[68:69], 14400
  s_waitcnt vmcnt(17)
  s_barrier
  s_add_u32 s31, s60, 10
  s_and_b32 s31, s31, 15
  s_lshl_b32 s31, s31, 15
  s_add_u32 m0, s59, 71680
  s_nop 0
  buffer_load_dwordx4 v19, s[12:15], s31 offen  lds
  s_add_u32 m0, s59, 72704
  s_nop 0
  buffer_load_dwordx4 v20, s[12:15], s31 offen  lds
  s_add_u32 m0, s59, 73728
  s_nop 0
  buffer_load_dwordx4 v21, s[12:15], s31 offen  lds
  s_add_u32 s31, s60, 11
  s_and_b32 s31, s31, 15
  s_lshl_b32 s31, s31, 15
  s_add_u32 m0, s59, 90112
  s_nop 0
  buffer_load_dwordx4 v17, s[12:15], s31 offen  lds
  s_add_u32 m0, s59, 91136
  s_nop 0
  buffer_load_dwordx4 v18, s[12:15], s31 offen  lds
  s_add_u32 m0, s59, 92160
  s_nop 0
  buffer_load_dwordx4 v19, s[12:15], s31 offen  lds
  s_add_u32 m0, s59, 93184
  s_nop 0
  buffer_load_dwordx4 v20, s[12:15], s31 offen  lds
  s_add_u32 m0, s59, 94208
  s_nop 0
  buffer_load_dwordx4 v21, s[12:15], s31 offen  lds
  s_load_dword s76, s[68:69], 15360
  s_load_dword s77, s[68:69], 15424
  s_load_dword s70, s[78:79], 0
  s_load_dword s71, s[78:79], 64
  s_mov_b32 s27, 0
L_wotp_25:
  v_and_b32 v1, 63, v36
  v_cmp_ne_u32 s[82:83], 32, v1
  v_add_u32 v1, 5, v37
  v_cmp_ne_u32 vcc, v1, v38
  s_nop 1
  s_or_b64 s[82:83], s[82:83], vcc
  v_cmp_ne_u32 vcc, v1, v39
  s_nop 1
  s_or_b64 s[82:83], s[82:83], vcc
  v_cmp_ne_u32 vcc, v1, v40
  s_nop 1
  s_or_b64 s[82:83], s[82:83], vcc
  v_cmp_ne_u32 vcc, v1, v41
  s_nop 1
  s_or_b64 s[82:83], s[82:83], vcc
  s_cmp_eq_u64 s[82:83], 0
  s_cbranch_scc1 L_wotok_26
  s_add_u32 s27, s27, 1
  s_cmp_gt_u32 s27, 400000
  s_cbranch_scc1 L_wotok_26
  s_sleep 4
  global_load_dwordx2 v[36:37], v42, s[48:49] sc1
  global_load_dwordx4 v[38:41], v43, s[50:51] sc1
  s_waitcnt vmcnt(0)
  s_branch L_wotp_25
L_wotok_26:
  s_waitcnt vmcnt(10)
  s_barrier
  s_lshr_b32 s30, s60, 1
  s_add_u32 s30, s30, 5
  s_and_b32 s30, s30, 7
  s_lshl_b32 s30, s30, 7
  s_add_u32 m0, s58, 17408
  s_nop 0
  buffer_load_dwordx4 v8, s[8:11], s30 offen  lds
  s_add_u32 m0, s58, 18432
  s_nop 0
  buffer_load_dwordx4 v9, s[8:11], s30 offen  lds
  s_add_u32 m0, s58, 19456
  s_nop 0
  buffer_load_dwordx4 v10, s[8:11], s30 offen  lds
  s_add_u32 m0, s58, 20480
  s_nop 0
  buffer_load_dwordx4 v11, s[8:11], s30 offen  lds
  s_add_u32 m0, s58, 21504
  s_mov_b64 exec, 0xff
  buffer_load_dwordx4 v12, s[8:11], s30 offen  lds
  s_mov_b64 exec, -1
  s_add_u32 s31, s60, 12
  s_and_b32 s31, s31, 15
  s_lshl_b32 s31, s31, 15
  s_add_u32 m0, s59, 110592
  s_nop 0
  buffer_load_dwordx4 v17, s[12:15], s31 offen  lds
  s_add_u32 m0, s59, 111616
  s_nop 0
  buffer_load_dwordx4 v18, s[12:15], s31 offen  lds
  s_load_dword s72, s[78:79], 128
  s_load_dword s73, s[78:79], 192
  s_load_dword s74, s[78:79], 2048
  s_load_dword s75, s[78:79], 2112
  s_lshr_b32 s24, s57, 1
  s_cmp_lg_u32 s24, 0
  s_cbranch_scc1 L_l2t_27
  s_lshl_b32 s24, s5, 2
  s_add_u32 s24, s24, s57
  s_lshl_b32 s24, s24, 12
  s_add_u32 s24, s24, 12582912
  v_lshlrev_b32 v1, 7, v0
  v_add_u32 v1, s24, v1
  s_mov_b64 exec, 0xffffffff
  global_load_dword v30, v1, s[50:51] sc1
  s_mov_b64 exec, -1
L_l2t_27:
  s_waitcnt vmcnt(17)
  s_barrier
  s_add_u32 s31, s60, 12
  s_and_b32 s31, s31, 15
  s_lshl_b32 s31, s31, 15
  s_add_u32 m0, s59, 112640
  s_nop 0
  buffer_load_dwordx4 v19, s[12:15], s31 offen  lds
  s_add_u32 m0, s59, 113664
  s_nop 0
  buffer_load_dwordx4 v20, s[12:15], s31 offen  lds
  s_add_u32 m0, s59, 114688
  s_nop 0
  buffer_load_dwordx4 v21, s[12:15], s31 offen  lds
  s_add_u32 s31, s60, 13
  s_and_b32 s31, s31, 15
  s_lshl_b32 s31, s31, 15
  s_add_u32 m0, s59, 131072
  s_nop 0
  buffer_load_dwordx4 v17, s[12:15], s31 offen  lds
  s_add_u32 m0, s59, 132096
  s_nop 0
  buffer_load_dwordx4 v18, s[12:15], s31 offen  lds
  s_add_u32 m0, s59, 133120
  s_nop 0
  buffer_load_dwordx4 v19, s[12:15], s31 offen  lds
  s_add_u32 m0, s59, 134144
  s_nop 0
  buffer_load_dwordx4 v20, s[12:15], s31 offen  lds
  s_add_u32 m0, s59, 135168
  s_nop 0
  buffer_load_dwordx4 v21, s[12:15], s31 offen  lds
  s_load_dword s76, s[78:79], 2176
  s_load_dword s77, s[78:79], 2240
  s_load_dword s70, s[78:79], 4096
  s_load_dword s71, s[78:79], 4160
  s_waitcnt vmcnt(10)
  s_barrier
  s_lshr_b32 s30, s60, 1
  s_add_u32 s30, s30, 6
  s_and_b32 s30, s30, 7
  s_lshl_b32 s30, s30, 7
  s_add_u32 m0, s58, 0
  s_nop 0
  buffer_load_dwordx4 v8, s[8:11], s30 offen  lds
  s_add_u32 m0, s58, 1024
  s_nop 0
  buffer_load_dwordx4 v9, s[8:11], s30 offen  lds
  s_add_u32 m0, s58, 2048
  s_nop 0
  buffer_load_dwordx4 v10, s[8:11], s30 offen  lds
  s_add_u32 m0, s58, 3072
  s_nop 0
  buffer_load_dwordx4 v11, s[8:11], s30 offen  lds
  s_add_u32 m0, s58, 4096
  s_mov_b64 exec, 0xff
  buffer_load_dwordx4 v12, s[8:11], s30 offen  lds
  s_mov_b64 exec, -1
  s_add_u32 s31, s60, 14
  s_and_b32 s31, s31, 15
  s_lshl_b32 s31, s31, 15
  s_add_u32 m0, s59, 49152
  s_nop 0
  buffer_load_dwordx4 v17, s[12:15], s31 offen  lds
  s_add_u32 m0, s59, 50176
  s_nop 0
  buffer_load_dwordx4 v18, s[12:15], s31 offen  lds
  s_load_dword s72, s[78:79], 4224
  s_load_dword s73, s[78:79], 4288
  s_load_dword s74, s[78:79], 6144
  s_load_dword s75, s[78:79], 6208
  s_lshr_b32 s24, s57, 1
  s_cmp_lg_u32 s24, 1
  s_cbranch_scc1 L_l2t_28
  s_lshl_b32 s24, s5, 2
  s_add_u32 s24, s24, s57
  s_lshl_b32 s24, s24, 12
  s_add_u32 s24, s24, 12582912
  v_lshlrev_b32 v1, 7, v0
  v_add_u32 v1, s24, v1
  s_mov_b64 exec, 0xffffffff
  global_load_dword v30, v1, s[50:51] sc1
  s_mov_b64 exec, -1
L_l2t_28:
  s_waitcnt vmcnt(17)
  s_barrier
  s_add_u32 s31, s60, 14
  s_and_b32 s31, s31, 15
  s_lshl_b32 s31, s31, 15
  s_add_u32 m0, s59, 51200
  s_nop 0
  buffer_load_dwordx4 v19, s[12:15], s31 offen  lds
  s_add_u32 m0, s59, 52224
  s_nop 0
  buffer_load_dwordx4 v20, s[12:15], s31 offen  lds
  s_add_u32 m0, s59, 53248
  s_nop 0
  buffer_load_dwordx4 v21, s[12:15], s31 offen  lds
  s_add_u32 s31, s60, 15
  s_and_b32 s31, s31, 15
  s_lshl_b32 s31, s31, 15
  s_add_u32 m0, s59, 69632
  s_nop 0
  buffer_load_dwordx4 v17, s[12:15], s31 offen  lds
  s_add_u32 m0, s59, 70656
  s_nop 0
  buffer_load_dwordx4 v18, s[12:15], s31 offen  lds
  s_add_u32 m0, s59, 71680
  s_nop 0
  buffer_load_dwordx4 v19, s[12:15], s31 offen  lds
  s_add_u32 m0, s59, 72704
  s_nop 0
  buffer_load_dwordx4 v20, s[12:15], s31 offen  lds
  s_add_u32 m0, s59, 73728
  s_nop 0
  buffer_load_dwordx4 v21, s[12:15], s31 offen  lds
  s_load_dword s76, s[78:79], 6272
  s_load_dword s77, s[78:79], 6336
  s_load_dword s70, s[86:87], 0
  s_load_dword s71, s[86:87], 2048
  s_waitcnt vmcnt(10)
  s_barrier
  s_lshr_b32 s30, s60, 1
  s_add_u32 s30, s30, 7
  s_and_b32 s30, s30, 7
  s_lshl_b32 s30, s30, 7
  s_add_u32 m0, s58, 17408
  s_nop 0
  buffer_load_dwordx4 v8, s[8:11], s30 offen  lds
  s_add_u32 m0, s58, 18432
  s_nop 0
  buffer_load_dwordx4 v9, s[8:11], s30 offen  lds
  s_add_u32 m0, s58, 19456
  s_nop 0
  buffer_load_dwordx4 v10, s[8:11], s30 offen  lds
  s_add_u32 m0, s58, 20480
  s_nop 0
  buffer_load_dwordx4 v11, s[8:11], s30 offen  lds
  s_add_u32 m0, s58, 21504
  s_mov_b64 exec, 0xff
  buffer_load_dwordx4 v12, s[8:11], s30 offen  lds
  s_mov_b64 exec, -1
  s_add_u32 m0, s81, 90112
  s_mov_b32 s26, 0
  buffer_load_dwordx4 v22, s[20:23], s26 offen lds
  s_add_u32 m0, s81, 94208
  s_mov_b32 s26, 32768
  buffer_load_dwordx4 v22, s[20:23], s26 offen lds
  s_add_u32 m0, s81, 98304
  s_mov_b32 s26, 65536
  buffer_load_dwordx4 v22, s[20:23], s26 offen lds
  s_add_u32 m0, s81, 102400
  s_mov_b32 s26, 98304
  buffer_load_dwordx4 v22, s[20:23], s26 offen lds
  s_add_u32 m0, s81, 106496
  s_mov_b32 s26, 131072
  buffer_load_dwordx4 v22, s[20:23], s26 offen lds
  s_waitcnt vmcnt(20)
  s_barrier
  s_add_u32 m0, s81, 110592
  s_mov_b32 s26, 163840
  buffer_load_dwordx4 v22, s[20:23], s26 offen lds
  s_add_u32 m0, s81, 114688
  s_mov_b32 s26, 196608
  buffer_load_dwordx4 v22, s[20:23], s26 offen lds
  s_add_u32 m0, s81, 118784
  s_mov_b32 s26, 229376
  buffer_load_dwordx4 v22, s[20:23], s26 offen lds
  s_add_u32 m0, s81, 122880
  s_mov_b32 s26, 262144
  buffer_load_dwordx4 v22, s[20:23], s26 offen lds
  s_add_u32 m0, s81, 126976
  s_mov_b32 s26, 294912
  buffer_load_dwordx4 v22, s[20:23], s26 offen lds
  s_waitcnt vmcnt(10)
  s_barrier
  s_add_u32 m0, s81, 131072
  s_mov_b32 s26, 327680
  buffer_load_dwordx4 v22, s[20:23], s26 offen lds
  s_add_u32 m0, s81, 135168
  s_mov_b32 s26, 360448
  buffer_load_dwordx4 v22, s[20:23], s26 offen lds
  s_add_u32 m0, s81, 139264
  s_mov_b32 s26, 393216
  buffer_load_dwordx4 v22, s[20:23], s26 offen lds
  s_add_u32 m0, s81, 143360
  s_mov_b32 s26, 425984
  buffer_load_dwordx4 v22, s[20:23], s26 offen lds
  s_add_u32 m0, s81, 147456
  s_mov_b32 s26, 458752
  buffer_load_dwordx4 v22, s[20:23], s26 offen lds
  s_add_u32 m0, s81, 151552
  s_mov_b32 s26, 491520
  buffer_load_dwordx4 v22, s[20:23], s26 offen lds
  s_waitcnt vmcnt(16)
  s_barrier
  s_barrier
  s_mov_b32 s12, s42
  s_mov_b32 s13, s43
  s_mov_b32 s14, 524288
  s_mov_b32 s15, 0x00020000
  s_lshl_b32 s24, s6, 13
  s_add_u32 s8, s38, s24
  s_addc_u32 s9, s39, 0
  s_mov_b32 s10, 8192
  s_mov_b32 s11, 0x00020000
  s_add_u32 m0, s81, 65536
  s_mov_b32 s26, 0
  buffer_load_dwordx4 v23, s[12:15], s26 offen lds
  s_add_u32 m0, s81, 69632
  s_mov_b32 s26, 131072
  buffer_load_dwordx4 v23, s[12:15], s26 offen lds
  s_add_u32 m0, s81, 73728
  s_mov_b32 s26, 262144
  buffer_load_dwordx4 v23, s[12:15], s26 offen lds
  s_add_u32 m0, s81, 77824
  s_mov_b32 s26, 393216
  buffer_load_dwordx4 v23, s[12:15], s26 offen lds
  s_add_u32 m0, s81, 81920
  s_add_u32 s26, s81, 0
  buffer_load_dwordx4 v26, s[8:11], s26 offen lds
  s_add_u32 m0, s81, 86016
  s_add_u32 s26, s81, 4096
  buffer_load_dwordx4 v26, s[8:11], s26 offen lds
  s_lshl_b32 s24, s4, 14
  s_add_u32 s92, s50, s24
  s_addc_u32 s93, s51, 0
  s_add_u32 s92, s92, 10485760
  s_addc_u32 s93, s93, 0
  s_mov_b32 s94, 16384
  s_mov_b32 s95, 0x00020000
  s_lshl_b32 s24, s4, 12
  s_add_u32 s84, s50, s24
  s_addc_u32 s85, s51, 0
  s_add_u32 s84, s84, 11534336
  s_addc_u32 s85, s85, 0
  s_mov_b32 s86, 4096
  s_mov_b32 s87, 0x00020000
  s_lshr_b32 s52, s4, 2
  s_lshl_b32 s52, s52, 7
  s_and_b32 s55, s4, 3
  s_lshl_b32 s55, s55, 3
  s_add_u32 s52, s52, s55
  v_mov_b32 v34, s52
  global_load_dwordx2 v[32:33], v34, s[48:49] sc1
  s_lshr_b32 s90, s5, 1
  s_and_b32 s91, s5, 1
  s_lshl_b32 s24, s4, 19
  s_add_u32 s8, s50, s24
  s_addc_u32 s9, s51, 0
  s_add_u32 s8, s8, 6291456
  s_addc_u32 s9, s9, 0
  s_mov_b32 s10, 524288
  s_mov_b32 s11, 0x00020000
  s_add_u32 s12, s50, 12582912
  s_addc_u32 s13, s51, 0
  s_mov_b32 s14, 524288
  s_mov_b32 s15, 0x00020000
  s_lshl_b32 s24, s4, 14
  s_add_u32 s20, s50, s24
  s_addc_u32 s21, s51, 0
  s_add_u32 s20, s20, 10485760
  s_addc_u32 s21, s21, 0
  s_mov_b32 s22, 16384
  s_mov_b32 s23, 0x00020000
  s_mul_i32 s24, s6, 1000
  s_mul_i32 s25, s7, 250
  s_add_u32 s24, s24, s25
  s_lshl_b32 s25, s90, 4
  s_add_u32 s24, s24, s25
  s_lshl_b32 s24, s24, 13
  s_add_u32 s16, s46, s24
  s_addc_u32 s17, s47, 0
  s_mov_b32 s18, 0
  s_mov_b32 s19, 0x00020000
  s_sub_u32 s25, 250, s25
  s_min_u32 s25, s25, 16
  s_lshl_b32 s18, s25, 13
  s_waitcnt lgkmcnt(0)
  s_lshl_b32 s70, s91, 3
  s_add_u32 s70, s70, s3
  s_lshl_b32 s70, s70, 15
  s_add_u32 s71, s70, 4096
  s_add_u32 s72, s70, 8192
  s_add_u32 s73, s70, 12288
  s_add_u32 s74, s70, 16384
  s_add_u32 s75, s70, 20480
  s_add_u32 s76, s70, 24576
  s_add_u32 s77, s70, 28672
  v_lshlrev_b32 v3, 4, v0
  buffer_load_dwordx4 a[0:3], v3, s[12:15], s70 offen offset:0 sc1
  buffer_load_dwordx4 a[4:7], v3, s[12:15], s70 offen offset:1024 sc1
  buffer_load_dwordx4 a[8:11], v3, s[12:15], s70 offen offset:2048 sc1
  buffer_load_dwordx4 a[12:15], v3, s[12:15], s70 offen offset:3072 sc1
  buffer_load_dwordx4 a[16:19], v3, s[12:15], s71 offen offset:0 sc1
  buffer_load_dwordx4 a[20:23], v3, s[12:15], s71 offen offset:1024 sc1
  buffer_load_dwordx4 a[24:27], v3, s[12:15], s71 offen offset:2048 sc1
  buffer_load_dwordx4 a[28:31], v3, s[12:15], s71 offen offset:3072 sc1
  buffer_load_dwordx4 a[32:35], v3, s[12:15], s72 offen offset:0 sc1
  buffer_load_dwordx4 a[36:39], v3, s[12:15], s72 offen offset:1024 sc1
  buffer_load_dwordx4 a[40:43], v3, s[12:15], s72 offen offset:2048 sc1
  buffer_load_dwordx4 a[44:47], v3, s[12:15], s72 offen offset:3072 sc1
  buffer_load_dwordx4 a[48:51], v3, s[12:15], s73 offen offset:0 sc1
  buffer_load_dwordx4 a[52:55], v3, s[12:15], s73 offen offset:1024 sc1
  buffer_load_dwordx4 a[56:59], v3, s[12:15], s73 offen offset:2048 sc1
  buffer_load_dwordx4 a[60:63], v3, s[12:15], s73 offen offset:3072 sc1
  buffer_load_dwordx4 a[64:67], v3, s[12:15], s74 offen offset:0 sc1
  buffer_load_dwordx4 a[68:71], v3, s[12:15], s74 offen offset:1024 sc1
  buffer_load_dwordx4 a[72:75], v3, s[12:15], s74 offen offset:2048 sc1
  buffer_load_dwordx4 a[76:79], v3, s[12:15], s74 offen offset:3072 sc1
  buffer_load_dwordx4 a[80:83], v3, s[12:15], s75 offen offset:0 sc1
  buffer_load_dwordx4 a[84:87], v3, s[12:15], s75 offen offset:1024 sc1
  buffer_load_dwordx4 a[88:91], v3, s[12:15], s75 offen offset:2048 sc1
  buffer_load_dwordx4 a[92:95], v3, s[12:15], s75 offen offset:3072 sc1
  buffer_load_dwordx4 a[96:99], v3, s[12:15], s76 offen offset:0 sc1
  buffer_load_dwordx4 a[100:103], v3, s[12:15], s76 offen offset:1024 sc1
  buffer_load_dwordx4 a[104:107], v3, s[12:15], s76 offen offset:2048 sc1
  buffer_load_dwordx4 a[108:111], v3, s[12:15], s76 offen offset:3072 sc1
  buffer_load_dwordx4 a[112:115], v3, s[12:15], s77 offen offset:0 sc1
  buffer_load_dwordx4 a[116:119], v3, s[12:15], s77 offen offset:1024 sc1
  buffer_load_dwordx4 a[120:123], v3, s[12:15], s77 offen offset:2048 sc1
  buffer_load_dwordx4 a[124:127], v3, s[12:15], s77 offen offset:3072 sc1
  s_waitcnt vmcnt(32)
  s_mov_b32 s27, 0
L_cenp_29:
  v_readfirstlane_b32 s24, v32
  v_readfirstlane_b32 s88, v33
  s_nop 0
  s_and_b32 s25, s24, 63
  s_cmp_eq_u32 s25, 32
  s_cbranch_scc1 L_cenok_30
  s_add_u32 s27, s27, 1
  s_cmp_gt_u32 s27, 400000
  s_cbranch_scc1 L_cenok_30
  s_sleep 4
  global_load_dwordx2 v[32:33], v34, s[48:49] sc1
  s_waitcnt vmcnt(0)
  s_branch L_cenp_29
L_cenok_30:
  s_getreg_b32 s25, hwreg(HW_REG_XCC_ID)
  s_and_b32 s25, s25, 15
  s_mul_i32 s26, s25, s25
  s_lshl_b32 s26, s26, 25
  s_lshl_b32 s25, s25, 13
  s_add_u32 s25, s25, s26
  s_add_u32 s25, s25, 32
  s_cmp_eq_u32 s24, s25
  s_cselect_b32 s89, 1, 0
  s_barrier
  s_cmp_eq_u32 s3, 4
  s_cbranch_scc1 L_ge4_32
  s_barrier
  s_branch L_noge_31
L_ge4_32:
  v_lshrrev_b32 v8, 4, v0
  v_lshlrev_b32 v8, 8, v8
  v_bfe_u32 v9, v0, 2, 2
  v_lshlrev_b32 v9, 5, v9
  v_add_u32 v8, v8, v9
  v_and_b32 v9, 3, v0
  v_lshlrev_b32 v9, 3, v9
  v_add_u32 v8, v8, v9
  v_add_u32 v8, 65536, v8
  v_and_b32 v9, 7, v0
  v_lshlrev_b32 v9, 10, v9
  v_lshrrev_b32 v10, 4, v0
  v_lshlrev_b32 v10, 4, v10
  v_add_u32 v9, v9, v10
  v_add_u32 v9, 81920, v9
  ds_read_b64_tr_b16 v[32:33], v8 offset:0
  ds_read_b64_tr_b16 v[34:35], v8 offset:128
  ds_read_b128 v[36:39], v9 offset:0
  ds_read_b64_tr_b16 v[40:41], v8 offset:1024
  ds_read_b64_tr_b16 v[42:43], v8 offset:1152
  ds_read_b128 v[44:47], v9 offset:64
  ds_read_b64_tr_b16 v[48:49], v8 offset:2048
  ds_read_b64_tr_b16 v[50:51], v8 offset:2176
  ds_read_b128 v[52:55], v9 offset:128
  ds_read_b64_tr_b16 v[56:57], v8 offset:3072
  ds_read_b64_tr_b16 v[58:59], v8 offset:3200
  ds_read_b128 v[60:63], v9 offset:192
  s_waitcnt lgkmcnt(0)
  v_mfma_f32_16x16x32_bf16 v[80:83], v[32:35], v[36:39], 0
  v_mfma_f32_16x16x32_bf16 v[80:83], v[40:43], v[44:47], v[80:83]
  v_mfma_f32_16x16x32_bf16 v[80:83], v[48:51], v[52:55], v[80:83]
  v_mfma_f32_16x16x32_bf16 v[80:83], v[56:59], v[60:63], v[80:83]
  ds_read_b64_tr_b16 v[32:33], v8 offset:4096
  ds_read_b64_tr_b16 v[34:35], v8 offset:4224
  ds_read_b128 v[36:39], v9 offset:256
  ds_read_b64_tr_b16 v[40:41], v8 offset:5120
  ds_read_b64_tr_b16 v[42:43], v8 offset:5248
  ds_read_b128 v[44:47], v9 offset:320
  ds_read_b64_tr_b16 v[48:49], v8 offset:6144
  ds_read_b64_tr_b16 v[50:51], v8 offset:6272
  ds_read_b128 v[52:55], v9 offset:384
  ds_read_b64_tr_b16 v[56:57], v8 offset:7168
  ds_read_b64_tr_b16 v[58:59], v8 offset:7296
  ds_read_b128 v[60:63], v9 offset:448
  s_waitcnt lgkmcnt(0)
  v_mfma_f32_16x16x32_bf16 v[80:83], v[32:35], v[36:39], v[80:83]
  v_mfma_f32_16x16x32_bf16 v[80:83], v[40:43], v[44:47], v[80:83]
  v_mfma_f32_16x16x32_bf16 v[80:83], v[48:51], v[52:55], v[80:83]
  v_mfma_f32_16x16x32_bf16 v[80:83], v[56:59], v[60:63], v[80:83]
  s_barrier
  ds_read_b64_tr_b16 v[32:33], v8 offset:8192
  ds_read_b64_tr_b16 v[34:35], v8 offset:8320
  ds_read_b128 v[36:39], v9 offset:512
  ds_read_b64_tr_b16 v[40:41], v8 offset:9216
  ds_read_b64_tr_b16 v[42:43], v8 offset:9344
  ds_read_b128 v[44:47], v9 offset:576
  ds_read_b64_tr_b16 v[48:49], v8 offset:10240
  ds_read_b64_tr_b16 v[50:51], v8 offset:10368
  ds_read_b128 v[52:55], v9 offset:640
  ds_read_b64_tr_b16 v[56:57], v8 offset:11264
  ds_read_b64_tr_b16 v[58:59], v8 offset:11392
  ds_read_b128 v[60:63], v9 offset:704
  s_waitcnt lgkmcnt(0)
  v_mfma_f32_16x16x32_bf16 v[80:83], v[32:35], v[36:39], v[80:83]
  v_mfma_f32_16x16x32_bf16 v[80:83], v[40:43], v[44:47], v[80:83]
  v_mfma_f32_16x16x32_bf16 v[80:83], v[48:51], v[52:55], v[80:83]
  v_mfma_f32_16x16x32_bf16 v[80:83], v[56:59], v[60:63], v[80:83]
  ds_read_b64_tr_b16 v[32:33], v8 offset:12288
  ds_read_b64_tr_b16 v[34:35], v8 offset:12416
  ds_read_b128 v[36:39], v9 offset:768
  ds_read_b64_tr_b16 v[40:41], v8 offset:13312
  ds_read_b64_tr_b16 v[42:43], v8 offset:13440
  ds_read_b128 v[44:47], v9 offset:832
  ds_read_b64_tr_b16 v[48:49], v8 offset:14336
  ds_read_b64_tr_b16 v[50:51], v8 offset:14464
  ds_read_b128 v[52:55], v9 offset:896
  ds_read_b64_tr_b16 v[56:57], v8 offset:15360
  ds_read_b64_tr_b16 v[58:59], v8 offset:15488
  ds_read_b128 v[60:63], v9 offset:960
  s_waitcnt lgkmcnt(0)
  v_mfma_f32_16x16x32_bf16 v[80:83], v[32:35], v[36:39], v[80:83]
  v_mfma_f32_16x16x32_bf16 v[80:83], v[40:43], v[44:47], v[80:83]
  v_mfma_f32_16x16x32_bf16 v[80:83], v[48:51], v[52:55], v[80:83]
  v_mfma_f32_16x16x32_bf16 v[80:83], v[56:59], v[60:63], v[80:83]
  s_mov_b32 s52, 0x4038aa3b
  v_mov_b32 v20, 0x42a00000
  s_nop 7
  v_mul_f32 v16, s52, v80
  v_mul_f32 v17, s52, v81
  v_mul_f32 v18, s52, v82
  v_mul_f32 v19, s52, v83
  v_med3_f32 v16, v16, v20, -v20
  v_med3_f32 v17, v17, v20, -v20
  v_med3_f32 v18, v18, v20, -v20
  v_med3_f32 v19, v19, v20, -v20
  v_exp_f32 v16, v16
  v_exp_f32 v17, v17
  v_exp_f32 v18, v18
  v_exp_f32 v19, v19
  v_and_b32 v9, 15, v0
  v_cmp_gt_u32 vcc, 8, v9
  v_lshlrev_b32 v9, 11, v9
  v_lshrrev_b32 v10, 4, v0
  v_lshlrev_b32 v10, 4, v10
  v_add_u32 v9, v9, v10
  s_lshl_b32 s26, s5, 6
  v_add_u32 v9, s26, v9
  s_and_saveexec_b64 s[82:83], vcc
  buffer_store_dwordx4 v[16:19], v9, s[92:95], 0 offen
  s_mov_b64 exec, s[82:83]
  s_mov_b32 s24, s5
  s_waitcnt vmcnt(0)
  s_add_u32 s25, s88, 3
  v_mov_b32 v1, s25
  s_lshl_b32 s24, s24, 2
  v_mov_b32 v2, s24
  s_cmp_eq_u32 s89, 0
  s_cbranch_scc1 L_sigs_33
  s_mov_b64 exec, 1
  buffer_store_dword v1, v2, s[84:87], 0 offen offset:1536
  s_mov_b64 exec, -1
  s_branch L_sigd_34
L_sigs_33:
  buffer_wbl2 sc1
  s_waitcnt vmcnt(0)
  s_mov_b64 exec, 1
  buffer_store_dword v1, v2, s[84:87], 0 offen offset:1536 sc1
  s_mov_b64 exec, -1
L_sigd_34:
L_noge_31:
  v_and_b32 v2, 7, v0
  v_lshlrev_b32 v2, 5, v2
  s_lshl_b32 s26, s3, 8
  v_add_u32 v2, s26, v2
  v_bfe_u32 v3, v0, 3, 2
  s_lshl_b32 s26, s90, 4
  v_add_u32 v3, s26, v3
  v_lshlrev_b32 v3, 11, v3
  v_add_u32 v5, v3, v2
  v_lshrrev_b32 v1, 5, v0
  v_lshlrev_b32 v1, 13, v1
  v_add_u32 v2, v1, v2
  v_bfe_u32 v1, v0, 3, 2
  v_lshrrev_b32 v7, 5, v0
  v_lshlrev_b32 v3, 3, v1
  v_lshlrev_b32 v6, 2, v7
  v_add_u32 v3, v3, v6
  v_and_b32 v6, 15, v3
  v_and_b32 v7, 7, v0
  s_and_b32 s26, s3, 1
  s_lshl_b32 s26, s26, 3
  v_add_u32 v7, s26, v7
  v_xor_b32 v7, v7, v6
  v_lshlrev_b32 v7, 4, v7
  v_lshlrev_b32 v3, 10, v3
  v_add_u32 v3, v3, v7
  s_lshr_b32 s26, s3, 1
  s_lshl_b32 s26, s26, 8
  v_add_u32 v4, s26, v3
  v_and_b32 v1, 31, v0
  v_lshrrev_b32 v7, 5, v0
  v_and_b32 v3, 15, v1
  v_xor_b32 v3, v3, v7
  v_lshlrev_b32 v3, 4, v3
  v_lshlrev_b32 v1, 10, v1
  v_add_u32 v3, v3, v1
  v_xor_b32 v120, 0, v3
  v_xor_b32 v121, 32, v3
  v_xor_b32 v122, 64, v3
  v_xor_b32 v123, 96, v3
  v_xor_b32 v124, 128, v3
  v_xor_b32 v125, 160, v3
  v_xor_b32 v126, 192, v3
  v_xor_b32 v127, 224, v3
  v_and_b32 v1, 31, v0
  v_lshlrev_b32 v1, 10, v1
  v_lshrrev_b32 v7, 5, v0
  v_lshlrev_b32 v7, 4, v7
  v_add_u32 v1, v1, v7
  s_lshl_b32 s26, s91, 9
  s_lshl_b32 s27, s3, 6
  s_add_u32 s26, s26, s27
  v_add_u32 v6, s26, v1
  v_lshrrev_b32 v1, 4, v0
  v_lshlrev_b32 v1, 11, v1
  v_and_b32 v3, 15, v0
  v_lshlrev_b32 v3, 4, v3
  v_add_u32 v1, v1, v3
  s_lshl_b32 s26, s3, 8
  v_add_u32 v69, s26, v1
  s_lshl_b32 s27, s90, 15
  v_add_u32 v68, s27, v69
  s_mul_i32 s55, s3, 6144
  s_add_u32 s55, s55, 98304
  v_and_b32 v1, 7, v0
  v_lshlrev_b32 v1, 5, v1
  v_add_u32 v1, s55, v1
  v_lshrrev_b32 v3, 5, v0
  v_lshlrev_b32 v3, 10, v3
  v_add_u32 v2, v1, v3
  v_bfe_u32 v3, v0, 3, 2
  v_lshlrev_b32 v3, 8, v3
  v_add_u32 v5, v1, v3
  s_barrier
L_joint:
  s_mov_b32 m0, s55
  s_mov_b32 s26, 0
  buffer_load_dwordx4 v69, s[20:23], s26 offen lds
  s_add_u32 m0, s55, 1024
  s_mov_b32 s26, 8192
  buffer_load_dwordx4 v69, s[20:23], s26 offen lds
  s_add_u32 m0, s55, 2048
  s_mov_b32 s26, 0
  buffer_load_dwordx4 v68, s[8:11], s26 offen lds
  s_add_u32 m0, s55, 3072
  s_mov_b32 s26, 8192
  buffer_load_dwordx4 v68, s[8:11], s26 offen lds
  s_add_u32 m0, s55, 4096
  s_mov_b32 s26, 16384
  buffer_load_dwordx4 v68, s[8:11], s26 offen lds
  s_add_u32 m0, s55, 5120
  s_mov_b32 s26, 24576
  buffer_load_dwordx4 v68, s[8:11], s26 offen lds
  s_lshl_b32 s70, s91, 3
  s_add_u32 s70, s70, s3
  s_lshl_b32 s70, s70, 15
  s_add_u32 s71, s70, 4096
  s_add_u32 s72, s70, 8192
  s_add_u32 s73, s70, 12288
  s_add_u32 s74, s70, 16384
  s_add_u32 s75, s70, 20480
  s_add_u32 s76, s70, 24576
  s_add_u32 s77, s70, 28672
  v_lshlrev_b32 v3, 4, v0
  s_cmp_ge_u32 s3, 4
  s_cbranch_scc1 L_jearly_35
  s_waitcnt vmcnt(3)
  ds_read_b128 v[8:11], v2 offset:0
  ds_read_b128 v[12:15], v2 offset:16
  ds_read_b128 v[16:19], v2 offset:256
  ds_read_b128 v[20:23], v2 offset:272
  ds_read_b128 v[24:27], v2 offset:512
  ds_read_b128 v[28:31], v2 offset:528
  ds_read_b128 v[32:35], v2 offset:768
  ds_read_b128 v[36:39], v2 offset:784
  ds_read_b128 v[40:43], v5 offset:2048
  ds_read_b128 v[44:47], v5 offset:2064
  buffer_load_dwordx4 a[0:3], v3, s[12:15], s70 offen offset:0 sc1
  buffer_load_dwordx4 a[4:7], v3, s[12:15], s70 offen offset:1024 sc1
  buffer_load_dwordx4 a[8:11], v3, s[12:15], s70 offen offset:2048 sc1
  buffer_load_dwordx4 a[12:15], v3, s[12:15], s70 offen offset:3072 sc1
  buffer_load_dwordx4 a[16:19], v3, s[12:15], s71 offen offset:0 sc1
  buffer_load_dwordx4 a[20:23], v3, s[12:15], s71 offen offset:1024 sc1
  buffer_load_dwordx4 a[24:27], v3, s[12:15], s71 offen offset:2048 sc1
  buffer_load_dwordx4 a[28:31], v3, s[12:15], s71 offen offset:3072 sc1
  s_waitcnt lgkmcnt(0)
  v_pk_fma_f32 v[56:57], v[40:41], v[8:9], 1.0 op_sel_hi:[1,1,0]
  v_pk_fma_f32 v[58:59], v[42:43], v[10:11], 1.0 op_sel_hi:[1,1,0]
  v_pk_fma_f32 v[60:61], v[44:45], v[12:13], 1.0 op_sel_hi:[1,1,0]
  v_pk_fma_f32 v[62:63], v[46:47], v[14:15], 1.0 op_sel_hi:[1,1,0]
  v_rcp_f32 v56, v56
  v_rcp_f32 v57, v57
  v_rcp_f32 v58, v58
  v_rcp_f32 v59, v59
  v_rcp_f32 v60, v60
  v_rcp_f32 v61, v61
  v_rcp_f32 v62, v62
  v_rcp_f32 v63, v63
  v_pk_fma_f32 v[56:57], v[56:57], -2.0, 1.0 op_sel_hi:[1,0,0]
  v_pk_fma_f32 v[58:59], v[58:59], -2.0, 1.0 op_sel_hi:[1,0,0]
  v_pk_fma_f32 v[60:61], v[60:61], -2.0, 1.0 op_sel_hi:[1,0,0]
  v_pk_fma_f32 v[62:63], v[62:63], -2.0, 1.0 op_sel_hi:[1,0,0]
  v_cvt_pk_bf16_f32 v64, v56, v57
  v_cvt_pk_bf16_f32 v65, v58, v59
  v_cvt_pk_bf16_f32 v66, v60, v61
  v_cvt_pk_bf16_f32 v67, v62, v63
  v_xor_b32 v7, 0, v4
  ds_write_b128 v7, v[64:67] offset:0
  v_pk_fma_f32 v[56:57], v[40:41], v[16:17], 1.0 op_sel_hi:[1,1,0]
  v_pk_fma_f32 v[58:59], v[42:43], v[18:19], 1.0 op_sel_hi:[1,1,0]
  v_pk_fma_f32 v[60:61], v[44:45], v[20:21], 1.0 op_sel_hi:[1,1,0]
  v_pk_fma_f32 v[62:63], v[46:47], v[22:23], 1.0 op_sel_hi:[1,1,0]
  v_rcp_f32 v56, v56
  v_rcp_f32 v57, v57
  v_rcp_f32 v58, v58
  v_rcp_f32 v59, v59
  v_rcp_f32 v60, v60
  v_rcp_f32 v61, v61
  v_rcp_f32 v62, v62
  v_rcp_f32 v63, v63
  v_pk_fma_f32 v[56:57], v[56:57], -2.0, 1.0 op_sel_hi:[1,0,0]
  v_pk_fma_f32 v[58:59], v[58:59], -2.0, 1.0 op_sel_hi:[1,0,0]
  v_pk_fma_f32 v[60:61], v[60:61], -2.0, 1.0 op_sel_hi:[1,0,0]
  v_pk_fma_f32 v[62:63], v[62:63], -2.0, 1.0 op_sel_hi:[1,0,0]
  v_cvt_pk_bf16_f32 v64, v56, v57
  v_cvt_pk_bf16_f32 v65, v58, v59
  v_cvt_pk_bf16_f32 v66, v60, v61
  v_cvt_pk_bf16_f32 v67, v62, v63
  v_xor_b32 v7, 16, v4
  ds_write_b128 v7, v[64:67] offset:1024
  v_pk_fma_f32 v[56:57], v[40:41], v[24:25], 1.0 op_sel_hi:[1,1,0]
  v_pk_fma_f32 v[58:59], v[42:43], v[26:27], 1.0 op_sel_hi:[1,1,0]
  v_pk_fma_f32 v[60:61], v[44:45], v[28:29], 1.0 op_sel_hi:[1,1,0]
  v_pk_fma_f32 v[62:63], v[46:47], v[30:31], 1.0 op_sel_hi:[1,1,0]
  v_rcp_f32 v56, v56
  v_rcp_f32 v57, v57
  v_rcp_f32 v58, v58
  v_rcp_f32 v59, v59
  v_rcp_f32 v60, v60
  v_rcp_f32 v61, v61
  v_rcp_f32 v62, v62
  v_rcp_f32 v63, v63
  v_pk_fma_f32 v[56:57], v[56:57], -2.0, 1.0 op_sel_hi:[1,0,0]
  v_pk_fma_f32 v[58:59], v[58:59], -2.0, 1.0 op_sel_hi:[1,0,0]
  v_pk_fma_f32 v[60:61], v[60:61], -2.0, 1.0 op_sel_hi:[1,0,0]
  v_pk_fma_f32 v[62:63], v[62:63], -2.0, 1.0 op_sel_hi:[1,0,0]
  v_cvt_pk_bf16_f32 v64, v56, v57
  v_cvt_pk_bf16_f32 v65, v58, v59
  v_cvt_pk_bf16_f32 v66, v60, v61
  v_cvt_pk_bf16_f32 v67, v62, v63
  v_xor_b32 v7, 32, v4
  ds_write_b128 v7, v[64:67] offset:2048
  v_pk_fma_f32 v[56:57], v[40:41], v[32:33], 1.0 op_sel_hi:[1,1,0]
  v_pk_fma_f32 v[58:59], v[42:43], v[34:35], 1.0 op_sel_hi:[1,1,0]
  v_pk_fma_f32 v[60:61], v[44:45], v[36:37], 1.0 op_sel_hi:[1,1,0]
  v_pk_fma_f32 v[62:63], v[46:47], v[38:39], 1.0 op_sel_hi:[1,1,0]
  v_rcp_f32 v56, v56
  v_rcp_f32 v57, v57
  v_rcp_f32 v58, v58
  v_rcp_f32 v59, v59
  v_rcp_f32 v60, v60
  v_rcp_f32 v61, v61
  v_rcp_f32 v62, v62
  v_rcp_f32 v63, v63
  v_pk_fma_f32 v[56:57], v[56:57], -2.0, 1.0 op_sel_hi:[1,0,0]
  v_pk_fma_f32 v[58:59], v[58:59], -2.0, 1.0 op_sel_hi:[1,0,0]
  v_pk_fma_f32 v[60:61], v[60:61], -2.0, 1.0 op_sel_hi:[1,0,0]
  v_pk_fma_f32 v[62:63], v[62:63], -2.0, 1.0 op_sel_hi:[1,0,0]
  v_cvt_pk_bf16_f32 v64, v56, v57
  v_cvt_pk_bf16_f32 v65, v58, v59
  v_cvt_pk_bf16_f32 v66, v60, v61
  v_cvt_pk_bf16_f32 v67, v62, v63
  v_xor_b32 v7, 48, v4
  ds_write_b128 v7, v[64:67] offset:3072
  s_waitcnt vmcnt(10)
  ds_read_b128 v[48:51], v5 offset:3072
  ds_read_b128 v[52:55], v5 offset:3088
  s_waitcnt lgkmcnt(0)
  s_barrier
  ds_read_b128 v[72:75], v120 offset:0
  ds_read_b128 v[76:79], v121 offset:0
  ds_read_b128 v[80:83], v122 offset:0
  v_add_u32 v4, 0x8000, v4
  s_waitcnt vmcnt(6)
  s_waitcnt lgkmcnt(2)
  v_mfma_f32_32x32x16_bf16 v[88:103], a[0:3], v[72:75], 0
  buffer_load_dwordx4 a[32:35], v3, s[12:15], s72 offen offset:0 sc1
  ds_read_b128 v[84:87], v123 offset:0
  v_fma_f32 v56, v48, v8, 1.0
  v_fma_f32 v57, v49, v9, 1.0
  v_fma_f32 v58, v50, v10, 1.0
  v_fma_f32 v59, v51, v11, 1.0
  s_waitcnt lgkmcnt(2)
  v_mfma_f32_32x32x16_bf16 v[88:103], a[4:7], v[76:79], v[88:103]
  buffer_load_dwordx4 a[36:39], v3, s[12:15], s72 offen offset:1024 sc1
  ds_read_b128 v[72:75], v124 offset:0
  v_fma_f32 v60, v52, v12, 1.0
  v_fma_f32 v61, v53, v13, 1.0
  v_fma_f32 v62, v54, v14, 1.0
  v_fma_f32 v63, v55, v15, 1.0
  v_rcp_f32 v56, v56
  s_waitcnt vmcnt(6)
  s_waitcnt lgkmcnt(2)
  v_mfma_f32_32x32x16_bf16 v[88:103], a[8:11], v[80:83], v[88:103]
  buffer_load_dwordx4 a[40:43], v3, s[12:15], s72 offen offset:2048 sc1
  ds_read_b128 v[76:79], v125 offset:0
  v_rcp_f32 v57, v57
  v_rcp_f32 v58, v58
  v_rcp_f32 v59, v59
  v_rcp_f32 v60, v60
  v_rcp_f32 v61, v61
  s_waitcnt lgkmcnt(2)
  v_mfma_f32_32x32x16_bf16 v[88:103], a[12:15], v[84:87], v[88:103]
  buffer_load_dwordx4 a[44:47], v3, s[12:15], s72 offen offset:3072 sc1
  ds_read_b128 v[80:83], v126 offset:0
  v_rcp_f32 v62, v62
  v_rcp_f32 v63, v63
  v_fma_f32 v56, v56, -2.0, 1.0
  v_fma_f32 v57, v57, -2.0, 1.0
  v_fma_f32 v58, v58, -2.0, 1.0
  s_waitcnt vmcnt(6)
  s_waitcnt lgkmcnt(2)
  v_mfma_f32_32x32x16_bf16 v[88:103], a[16:19], v[72:75], v[88:103]
  buffer_load_dwordx4 a[48:51], v3, s[12:15], s73 offen offset:0 sc1
  ds_read_b128 v[84:87], v127 offset:0
  v_fma_f32 v59, v59, -2.0, 1.0
  v_fma_f32 v60, v60, -2.0, 1.0
  v_fma_f32 v61, v61, -2.0, 1.0
  v_fma_f32 v62, v62, -2.0, 1.0
  v_fma_f32 v63, v63, -2.0, 1.0
  s_waitcnt lgkmcnt(2)
  v_mfma_f32_32x32x16_bf16 v[88:103], a[20:23], v[76:79], v[88:103]
  buffer_load_dwordx4 a[52:55], v3, s[12:15], s73 offen offset:1024 sc1
  ds_read_b128 v[72:75], v120 offset:256
  v_cvt_pk_bf16_f32 v64, v56, v57
  v_cvt_pk_bf16_f32 v65, v58, v59
  v_cvt_pk_bf16_f32 v66, v60, v61
  v_cvt_pk_bf16_f32 v67, v62, v63
  s_waitcnt vmcnt(6)
  s_waitcnt lgkmcnt(2)
  v_mfma_f32_32x32x16_bf16 v[88:103], a[24:27], v[80:83], v[88:103]
  buffer_load_dwordx4 a[56:59], v3, s[12:15], s73 offen offset:2048 sc1
  ds_read_b128 v[76:79], v121 offset:256
  v_xor_b32 v7, 0, v4
  ds_write_b128 v7, v[64:67] offset:0
  v_fma_f32 v56, v48, v16, 1.0
  v_fma_f32 v57, v49, v17, 1.0
  v_fma_f32 v58, v50, v18, 1.0
  s_waitcnt lgkmcnt(3)
  v_mfma_f32_32x32x16_bf16 v[88:103], a[28:31], v[84:87], v[88:103]
  buffer_load_dwordx4 a[60:63], v3, s[12:15], s73 offen offset:3072 sc1
  ds_read_b128 v[80:83], v122 offset:256
  v_fma_f32 v59, v51, v19, 1.0
  v_fma_f32 v60, v52, v20, 1.0
  v_fma_f32 v61, v53, v21, 1.0
  v_fma_f32 v62, v54, v22, 1.0
  v_fma_f32 v63, v55, v23, 1.0
  s_waitcnt vmcnt(6)
  s_waitcnt lgkmcnt(3)
  v_mfma_f32_32x32x16_bf16 v[88:103], a[32:35], v[72:75], v[88:103]
  buffer_load_dwordx4 a[64:67], v3, s[12:15], s74 offen offset:0 sc1
  ds_read_b128 v[84:87], v123 offset:256
  v_rcp_f32 v56, v56
  v_rcp_f32 v57, v57
  v_rcp_f32 v58, v58
  v_rcp_f32 v59, v59
  v_rcp_f32 v60, v60
  s_waitcnt lgkmcnt(3)
  v_mfma_f32_32x32x16_bf16 v[88:103], a[36:39], v[76:79], v[88:103]
  buffer_load_dwordx4 a[68:71], v3, s[12:15], s74 offen offset:1024 sc1
  ds_read_b128 v[72:75], v124 offset:256
  v_rcp_f32 v61, v61
  v_rcp_f32 v62, v62
  v_rcp_f32 v63, v63
  v_fma_f32 v56, v56, -2.0, 1.0
  v_fma_f32 v57, v57, -2.0, 1.0
  s_waitcnt vmcnt(6)
  s_waitcnt lgkmcnt(2)
  v_mfma_f32_32x32x16_bf16 v[88:103], a[40:43], v[80:83], v[88:103]
  buffer_load_dwordx4 a[72:75], v3, s[12:15], s74 offen offset:2048 sc1
  ds_read_b128 v[76:79], v125 offset:256
  v_fma_f32 v58, v58, -2.0, 1.0
  v_fma_f32 v59, v59, -2.0, 1.0
  v_fma_f32 v60, v60, -2.0, 1.0
  v_fma_f32 v61, v61, -2.0, 1.0
  s_waitcnt lgkmcnt(2)
  v_mfma_f32_32x32x16_bf16 v[88:103], a[44:47], v[84:87], v[88:103]
  buffer_load_dwordx4 a[76:79], v3, s[12:15], s74 offen offset:3072 sc1
  ds_read_b128 v[80:83], v126 offset:256
  v_fma_f32 v62, v62, -2.0, 1.0
  v_fma_f32 v63, v63, -2.0, 1.0
  v_cvt_pk_bf16_f32 v64, v56, v57
  v_cvt_pk_bf16_f32 v65, v58, v59
  v_cvt_pk_bf16_f32 v66, v60, v61
  s_waitcnt vmcnt(6)
  s_waitcnt lgkmcnt(2)
  v_mfma_f32_32x32x16_bf16 v[88:103], a[48:51], v[72:75], v[88:103]
  buffer_load_dwordx4 a[80:83], v3, s[12:15], s75 offen offset:0 sc1
  ds_read_b128 v[84:87], v127 offset:256
  v_cvt_pk_bf16_f32 v67, v62, v63
  v_xor_b32 v7, 16, v4
  ds_write_b128 v7, v[64:67] offset:1024
  v_fma_f32 v56, v48, v24, 1.0
  v_fma_f32 v57, v49, v25, 1.0
  s_waitcnt lgkmcnt(3)
  v_mfma_f32_32x32x16_bf16 v[88:103], a[52:55], v[76:79], v[88:103]
  buffer_load_dwordx4 a[84:87], v3, s[12:15], s75 offen offset:1024 sc1
  ds_read_b128 v[72:75], v120 offset:512
  v_fma_f32 v58, v50, v26, 1.0
  v_fma_f32 v59, v51, v27, 1.0
  v_fma_f32 v60, v52, v28, 1.0
  v_fma_f32 v61, v53, v29, 1.0
  v_fma_f32 v62, v54, v30, 1.0
  s_waitcnt vmcnt(6)
  s_waitcnt lgkmcnt(3)
  v_mfma_f32_32x32x16_bf16 v[88:103], a[56:59], v[80:83], v[88:103]
  buffer_load_dwordx4 a[88:91], v3, s[12:15], s75 offen offset:2048 sc1
  ds_read_b128 v[76:79], v121 offset:512
  v_fma_f32 v63, v55, v31, 1.0
  v_rcp_f32 v56, v56
  v_rcp_f32 v57, v57
  v_rcp_f32 v58, v58
  v_rcp_f32 v59, v59
  s_waitcnt lgkmcnt(3)
  v_mfma_f32_32x32x16_bf16 v[88:103], a[60:63], v[84:87], v[88:103]
  buffer_load_dwordx4 a[92:95], v3, s[12:15], s75 offen offset:3072 sc1
  ds_read_b128 v[80:83], v122 offset:512
  v_rcp_f32 v60, v60
  v_rcp_f32 v61, v61
  v_rcp_f32 v62, v62
  v_rcp_f32 v63, v63
  s_waitcnt vmcnt(6)
  s_waitcnt lgkmcnt(2)
  v_mfma_f32_32x32x16_bf16 v[88:103], a[64:67], v[72:75], v[88:103]
  buffer_load_dwordx4 a[96:99], v3, s[12:15], s76 offen offset:0 sc1
  ds_read_b128 v[84:87], v123 offset:512
  v_fma_f32 v56, v56, -2.0, 1.0
  v_fma_f32 v57, v57, -2.0, 1.0
  v_fma_f32 v58, v58, -2.0, 1.0
  v_fma_f32 v59, v59, -2.0, 1.0
  v_fma_f32 v60, v60, -2.0, 1.0
  s_waitcnt lgkmcnt(2)
  v_mfma_f32_32x32x16_bf16 v[88:103], a[68:71], v[76:79], v[88:103]
  buffer_load_dwordx4 a[100:103], v3, s[12:15], s76 offen offset:1024 sc1
  ds_read_b128 v[72:75], v124 offset:512
  v_fma_f32 v61, v61, -2.0, 1.0
  v_fma_f32 v62, v62, -2.0, 1.0
  v_fma_f32 v63, v63, -2.0, 1.0
  v_cvt_pk_bf16_f32 v64, v56, v57
  v_cvt_pk_bf16_f32 v65, v58, v59
  s_waitcnt vmcnt(6)
  s_waitcnt lgkmcnt(2)
  v_mfma_f32_32x32x16_bf16 v[88:103], a[72:75], v[80:83], v[88:103]
  buffer_load_dwordx4 a[104:107], v3, s[12:15], s76 offen offset:2048 sc1
  ds_read_b128 v[76:79], v125 offset:512
  v_cvt_pk_bf16_f32 v66, v60, v61
  v_cvt_pk_bf16_f32 v67, v62, v63
  v_xor_b32 v7, 32, v4
  ds_write_b128 v7, v[64:67] offset:2048
  v_fma_f32 v56, v48, v32, 1.0
  s_waitcnt lgkmcnt(3)
  v_mfma_f32_32x32x16_bf16 v[88:103], a[76:79], v[84:87], v[88:103]
  buffer_load_dwordx4 a[108:111], v3, s[12:15], s76 offen offset:3072 sc1
  ds_read_b128 v[80:83], v126 offset:512
  v_fma_f32 v57, v49, v33, 1.0
  v_fma_f32 v58, v50, v34, 1.0
  v_fma_f32 v59, v51, v35, 1.0
  v_fma_f32 v60, v52, v36, 1.0
  v_fma_f32 v61, v53, v37, 1.0
  s_waitcnt vmcnt(6)
  s_waitcnt lgkmcnt(3)
  v_mfma_f32_32x32x16_bf16 v[88:103], a[80:83], v[72:75], v[88:103]
  buffer_load_dwordx4 a[112:115], v3, s[12:15], s77 offen offset:0 sc1
  ds_read_b128 v[84:87], v127 offset:512
  v_fma_f32 v62, v54, v38, 1.0
  v_fma_f32 v63, v55, v39, 1.0
  v_rcp_f32 v56, v56
  v_rcp_f32 v57, v57
  s_waitcnt lgkmcnt(3)
  v_mfma_f32_32x32x16_bf16 v[88:103], a[84:87], v[76:79], v[88:103]
  buffer_load_dwordx4 a[116:119], v3, s[12:15], s77 offen offset:1024 sc1
  ds_read_b128 v[72:75], v120 offset:768
  v_rcp_f32 v58, v58
  v_rcp_f32 v59, v59
  v_rcp_f32 v60, v60
  v_rcp_f32 v61, v61
  v_rcp_f32 v62, v62
  s_waitcnt vmcnt(6)
  s_waitcnt lgkmcnt(2)
  v_mfma_f32_32x32x16_bf16 v[88:103], a[88:91], v[80:83], v[88:103]
  buffer_load_dwordx4 a[120:123], v3, s[12:15], s77 offen offset:2048 sc1
  ds_read_b128 v[76:79], v121 offset:768
  v_rcp_f32 v63, v63
  v_fma_f32 v56, v56, -2.0, 1.0
  v_fma_f32 v57, v57, -2.0, 1.0
  v_fma_f32 v58, v58, -2.0, 1.0
  v_fma_f32 v59, v59, -2.0, 1.0
  s_waitcnt lgkmcnt(2)
  v_mfma_f32_32x32x16_bf16 v[88:103], a[92:95], v[84:87], v[88:103]
  buffer_load_dwordx4 a[124:127], v3, s[12:15], s77 offen offset:3072 sc1
  ds_read_b128 v[80:83], v122 offset:768
  v_fma_f32 v60, v60, -2.0, 1.0
  v_fma_f32 v61, v61, -2.0, 1.0
  v_fma_f32 v62, v62, -2.0, 1.0
  v_fma_f32 v63, v63, -2.0, 1.0
  v_cvt_pk_bf16_f32 v64, v56, v57
  v_add_u32 v120, 0x8000, v120
  v_add_u32 v121, 0x8000, v121
  v_add_u32 v122, 0x8000, v122
  s_waitcnt vmcnt(6)
  s_waitcnt lgkmcnt(2)
  v_mfma_f32_32x32x16_bf16 v[88:103], a[96:99], v[72:75], v[88:103]
  ds_read_b128 v[84:87], v123 offset:768
  v_cvt_pk_bf16_f32 v65, v58, v59
  v_cvt_pk_bf16_f32 v66, v60, v61
  v_cvt_pk_bf16_f32 v67, v62, v63
  v_xor_b32 v7, 48, v4
  ds_write_b128 v7, v[64:67] offset:3072
  v_add_u32 v123, 0x8000, v123
  s_waitcnt lgkmcnt(3)
  v_mfma_f32_32x32x16_bf16 v[88:103], a[100:103], v[76:79], v[88:103]
  ds_read_b128 v[72:75], v124 offset:768
  v_add_u32 v124, 0x8000, v124
  s_waitcnt vmcnt(4)
  s_waitcnt lgkmcnt(3)
  v_mfma_f32_32x32x16_bf16 v[88:103], a[104:107], v[80:83], v[88:103]
  ds_read_b128 v[76:79], v125 offset:768
  v_add_u32 v125, 0x8000, v125
  s_waitcnt lgkmcnt(3)
  v_mfma_f32_32x32x16_bf16 v[88:103], a[108:111], v[84:87], v[88:103]
  s_waitcnt lgkmcnt(2)
  s_barrier
  ds_read_b128 v[80:83], v126 offset:768
  v_add_u32 v126, 0x8000, v126
  s_waitcnt vmcnt(2)
  s_waitcnt lgkmcnt(2)
  v_mfma_f32_32x32x16_bf16 v[88:103], a[112:115], v[72:75], v[88:103]
  ds_read_b128 v[84:87], v127 offset:768
  ds_read_b128 v[40:43], v5 offset:4096
  ds_read_b128 v[44:47], v5 offset:4112
  v_add_u32 v127, 0x8000, v127
  s_waitcnt lgkmcnt(4)
  v_mfma_f32_32x32x16_bf16 v[88:103], a[116:119], v[76:79], v[88:103]
  ds_read_b128 v[72:75], v120 offset:0
  s_waitcnt vmcnt(0)
  s_waitcnt lgkmcnt(4)
  v_mfma_f32_32x32x16_bf16 v[88:103], a[120:123], v[80:83], v[88:103]
  ds_read_b128 v[76:79], v121 offset:0
  s_waitcnt lgkmcnt(4)
  v_mfma_f32_32x32x16_bf16 v[88:103], a[124:127], v[84:87], v[88:103]
  ds_read_b128 v[80:83], v122 offset:0
  s_branch L_jjoin_36
L_jearly_35:
  s_waitcnt vmcnt(3)
  ds_read_b128 v[8:11], v2 offset:0
  ds_read_b128 v[12:15], v2 offset:16
  ds_read_b128 v[16:19], v2 offset:256
  ds_read_b128 v[20:23], v2 offset:272
  ds_read_b128 v[24:27], v2 offset:512
  ds_read_b128 v[28:31], v2 offset:528
  ds_read_b128 v[32:35], v2 offset:768
  ds_read_b128 v[36:39], v2 offset:784
  ds_read_b128 v[40:43], v5 offset:2048
  ds_read_b128 v[44:47], v5 offset:2064
  s_waitcnt lgkmcnt(0)
  v_pk_fma_f32 v[56:57], v[40:41], v[8:9], 1.0 op_sel_hi:[1,1,0]
  v_pk_fma_f32 v[58:59], v[42:43], v[10:11], 1.0 op_sel_hi:[1,1,0]
  v_pk_fma_f32 v[60:61], v[44:45], v[12:13], 1.0 op_sel_hi:[1,1,0]
  v_pk_fma_f32 v[62:63], v[46:47], v[14:15], 1.0 op_sel_hi:[1,1,0]
  v_rcp_f32 v56, v56
  v_rcp_f32 v57, v57
  v_rcp_f32 v58, v58
  v_rcp_f32 v59, v59
  v_rcp_f32 v60, v60
  v_rcp_f32 v61, v61
  v_rcp_f32 v62, v62
  v_rcp_f32 v63, v63
  v_pk_fma_f32 v[56:57], v[56:57], -2.0, 1.0 op_sel_hi:[1,0,0]
  v_pk_fma_f32 v[58:59], v[58:59], -2.0, 1.0 op_sel_hi:[1,0,0]
  v_pk_fma_f32 v[60:61], v[60:61], -2.0, 1.0 op_sel_hi:[1,0,0]
  v_pk_fma_f32 v[62:63], v[62:63], -2.0, 1.0 op_sel_hi:[1,0,0]
  v_cvt_pk_bf16_f32 v64, v56, v57
  v_cvt_pk_bf16_f32 v65, v58, v59
  v_cvt_pk_bf16_f32 v66, v60, v61
  v_cvt_pk_bf16_f32 v67, v62, v63
  v_xor_b32 v7, 0, v4
  ds_write_b128 v7, v[64:67] offset:0
  v_pk_fma_f32 v[56:57], v[40:41], v[16:17], 1.0 op_sel_hi:[1,1,0]
  v_pk_fma_f32 v[58:59], v[42:43], v[18:19], 1.0 op_sel_hi:[1,1,0]
  v_pk_fma_f32 v[60:61], v[44:45], v[20:21], 1.0 op_sel_hi:[1,1,0]
  v_pk_fma_f32 v[62:63], v[46:47], v[22:23], 1.0 op_sel_hi:[1,1,0]
  v_rcp_f32 v56, v56
  v_rcp_f32 v57, v57
  v_rcp_f32 v58, v58
  v_rcp_f32 v59, v59
  v_rcp_f32 v60, v60
  v_rcp_f32 v61, v61
  v_rcp_f32 v62, v62
  v_rcp_f32 v63, v63
  v_pk_fma_f32 v[56:57], v[56:57], -2.0, 1.0 op_sel_hi:[1,0,0]
  v_pk_fma_f32 v[58:59], v[58:59], -2.0, 1.0 op_sel_hi:[1,0,0]
  v_pk_fma_f32 v[60:61], v[60:61], -2.0, 1.0 op_sel_hi:[1,0,0]
  v_pk_fma_f32 v[62:63], v[62:63], -2.0, 1.0 op_sel_hi:[1,0,0]
  v_cvt_pk_bf16_f32 v64, v56, v57
  v_cvt_pk_bf16_f32 v65, v58, v59
  v_cvt_pk_bf16_f32 v66, v60, v61
  v_cvt_pk_bf16_f32 v67, v62, v63
  v_xor_b32 v7, 16, v4
  ds_write_b128 v7, v[64:67] offset:1024
  v_pk_fma_f32 v[56:57], v[40:41], v[24:25], 1.0 op_sel_hi:[1,1,0]
  v_pk_fma_f32 v[58:59], v[42:43], v[26:27], 1.0 op_sel_hi:[1,1,0]
  v_pk_fma_f32 v[60:61], v[44:45], v[28:29], 1.0 op_sel_hi:[1,1,0]
  v_pk_fma_f32 v[62:63], v[46:47], v[30:31], 1.0 op_sel_hi:[1,1,0]
  v_rcp_f32 v56, v56
  v_rcp_f32 v57, v57
  v_rcp_f32 v58, v58
  v_rcp_f32 v59, v59
  v_rcp_f32 v60, v60
  v_rcp_f32 v61, v61
  v_rcp_f32 v62, v62
  v_rcp_f32 v63, v63
  v_pk_fma_f32 v[56:57], v[56:57], -2.0, 1.0 op_sel_hi:[1,0,0]
  v_pk_fma_f32 v[58:59], v[58:59], -2.0, 1.0 op_sel_hi:[1,0,0]
  v_pk_fma_f32 v[60:61], v[60:61], -2.0, 1.0 op_sel_hi:[1,0,0]
  v_pk_fma_f32 v[62:63], v[62:63], -2.0, 1.0 op_sel_hi:[1,0,0]
  v_cvt_pk_bf16_f32 v64, v56, v57
  v_cvt_pk_bf16_f32 v65, v58, v59
  v_cvt_pk_bf16_f32 v66, v60, v61
  v_cvt_pk_bf16_f32 v67, v62, v63
  v_xor_b32 v7, 32, v4
  ds_write_b128 v7, v[64:67] offset:2048
  v_pk_fma_f32 v[56:57], v[40:41], v[32:33], 1.0 op_sel_hi:[1,1,0]
  v_pk_fma_f32 v[58:59], v[42:43], v[34:35], 1.0 op_sel_hi:[1,1,0]
  v_pk_fma_f32 v[60:61], v[44:45], v[36:37], 1.0 op_sel_hi:[1,1,0]
  v_pk_fma_f32 v[62:63], v[46:47], v[38:39], 1.0 op_sel_hi:[1,1,0]
  v_rcp_f32 v56, v56
  v_rcp_f32 v57, v57
  v_rcp_f32 v58, v58
  v_rcp_f32 v59, v59
  v_rcp_f32 v60, v60
  v_rcp_f32 v61, v61
  v_rcp_f32 v62, v62
  v_rcp_f32 v63, v63
  v_pk_fma_f32 v[56:57], v[56:57], -2.0, 1.0 op_sel_hi:[1,0,0]
  v_pk_fma_f32 v[58:59], v[58:59], -2.0, 1.0 op_sel_hi:[1,0,0]
  v_pk_fma_f32 v[60:61], v[60:61], -2.0, 1.0 op_sel_hi:[1,0,0]
  v_pk_fma_f32 v[62:63], v[62:63], -2.0, 1.0 op_sel_hi:[1,0,0]
  v_cvt_pk_bf16_f32 v64, v56, v57
  v_cvt_pk_bf16_f32 v65, v58, v59
  v_cvt_pk_bf16_f32 v66, v60, v61
  v_cvt_pk_bf16_f32 v67, v62, v63
  v_xor_b32 v7, 48, v4
  ds_write_b128 v7, v[64:67] offset:3072
  s_waitcnt vmcnt(2)
  ds_read_b128 v[48:51], v5 offset:3072
  ds_read_b128 v[52:55], v5 offset:3088
  s_waitcnt lgkmcnt(0)
  s_barrier
  ds_read_b128 v[72:75], v120 offset:0
  ds_read_b128 v[76:79], v121 offset:0
  ds_read_b128 v[80:83], v122 offset:0
  v_add_u32 v4, 0x8000, v4
  s_waitcnt lgkmcnt(2)
  v_mfma_f32_32x32x16_bf16 v[88:103], a[0:3], v[72:75], 0
  ds_read_b128 v[84:87], v123 offset:0
  v_fma_f32 v56, v48, v8, 1.0
  v_fma_f32 v57, v49, v9, 1.0
  v_fma_f32 v58, v50, v10, 1.0
  v_fma_f32 v59, v51, v11, 1.0
  s_waitcnt lgkmcnt(2)
  v_mfma_f32_32x32x16_bf16 v[88:103], a[4:7], v[76:79], v[88:103]
  ds_read_b128 v[72:75], v124 offset:0
  v_fma_f32 v60, v52, v12, 1.0
  v_fma_f32 v61, v53, v13, 1.0
  v_fma_f32 v62, v54, v14, 1.0
  v_fma_f32 v63, v55, v15, 1.0
  v_rcp_f32 v56, v56
  s_waitcnt lgkmcnt(2)
  v_mfma_f32_32x32x16_bf16 v[88:103], a[8:11], v[80:83], v[88:103]
  ds_read_b128 v[76:79], v125 offset:0
  v_rcp_f32 v57, v57
  v_rcp_f32 v58, v58
  v_rcp_f32 v59, v59
  v_rcp_f32 v60, v60
  v_rcp_f32 v61, v61
  s_waitcnt lgkmcnt(2)
  v_mfma_f32_32x32x16_bf16 v[88:103], a[12:15], v[84:87], v[88:103]
  ds_read_b128 v[80:83], v126 offset:0
  v_rcp_f32 v62, v62
  v_rcp_f32 v63, v63
  v_fma_f32 v56, v56, -2.0, 1.0
  v_fma_f32 v57, v57, -2.0, 1.0
  v_fma_f32 v58, v58, -2.0, 1.0
  s_waitcnt lgkmcnt(2)
  v_mfma_f32_32x32x16_bf16 v[88:103], a[16:19], v[72:75], v[88:103]
  ds_read_b128 v[84:87], v127 offset:0
  v_fma_f32 v59, v59, -2.0, 1.0
  v_fma_f32 v60, v60, -2.0, 1.0
  v_fma_f32 v61, v61, -2.0, 1.0
  v_fma_f32 v62, v62, -2.0, 1.0
  v_fma_f32 v63, v63, -2.0, 1.0
  s_waitcnt lgkmcnt(2)
  v_mfma_f32_32x32x16_bf16 v[88:103], a[20:23], v[76:79], v[88:103]
  ds_read_b128 v[72:75], v120 offset:256
  v_cvt_pk_bf16_f32 v64, v56, v57
  v_cvt_pk_bf16_f32 v65, v58, v59
  v_cvt_pk_bf16_f32 v66, v60, v61
  v_cvt_pk_bf16_f32 v67, v62, v63
  s_waitcnt lgkmcnt(2)
  v_mfma_f32_32x32x16_bf16 v[88:103], a[24:27], v[80:83], v[88:103]
  ds_read_b128 v[76:79], v121 offset:256
  v_xor_b32 v7, 0, v4
  ds_write_b128 v7, v[64:67] offset:0
  v_fma_f32 v56, v48, v16, 1.0
  v_fma_f32 v57, v49, v17, 1.0
  v_fma_f32 v58, v50, v18, 1.0
  s_waitcnt lgkmcnt(3)
  v_mfma_f32_32x32x16_bf16 v[88:103], a[28:31], v[84:87], v[88:103]
  ds_read_b128 v[80:83], v122 offset:256
  v_fma_f32 v59, v51, v19, 1.0
  v_fma_f32 v60, v52, v20, 1.0
  v_fma_f32 v61, v53, v21, 1.0
  v_fma_f32 v62, v54, v22, 1.0
  v_fma_f32 v63, v55, v23, 1.0
  s_waitcnt lgkmcnt(3)
  v_mfma_f32_32x32x16_bf16 v[88:103], a[32:35], v[72:75], v[88:103]
  ds_read_b128 v[84:87], v123 offset:256
  v_rcp_f32 v56, v56
  v_rcp_f32 v57, v57
  v_rcp_f32 v58, v58
  v_rcp_f32 v59, v59
  v_rcp_f32 v60, v60
  s_waitcnt lgkmcnt(3)
  v_mfma_f32_32x32x16_bf16 v[88:103], a[36:39], v[76:79], v[88:103]
  ds_read_b128 v[72:75], v124 offset:256
  v_rcp_f32 v61, v61
  v_rcp_f32 v62, v62
  v_rcp_f32 v63, v63
  v_fma_f32 v56, v56, -2.0, 1.0
  v_fma_f32 v57, v57, -2.0, 1.0
  s_waitcnt lgkmcnt(2)
  v_mfma_f32_32x32x16_bf16 v[88:103], a[40:43], v[80:83], v[88:103]
  ds_read_b128 v[76:79], v125 offset:256
  v_fma_f32 v58, v58, -2.0, 1.0
  v_fma_f32 v59, v59, -2.0, 1.0
  v_fma_f32 v60, v60, -2.0, 1.0
  v_fma_f32 v61, v61, -2.0, 1.0
  s_waitcnt lgkmcnt(2)
  v_mfma_f32_32x32x16_bf16 v[88:103], a[44:47], v[84:87], v[88:103]
  ds_read_b128 v[80:83], v126 offset:256
  v_fma_f32 v62, v62, -2.0, 1.0
  v_fma_f32 v63, v63, -2.0, 1.0
  v_cvt_pk_bf16_f32 v64, v56, v57
  v_cvt_pk_bf16_f32 v65, v58, v59
  v_cvt_pk_bf16_f32 v66, v60, v61
  s_waitcnt lgkmcnt(2)
  v_mfma_f32_32x32x16_bf16 v[88:103], a[48:51], v[72:75], v[88:103]
  ds_read_b128 v[84:87], v127 offset:256
  v_cvt_pk_bf16_f32 v67, v62, v63
  v_xor_b32 v7, 16, v4
  ds_write_b128 v7, v[64:67] offset:1024
  v_fma_f32 v56, v48, v24, 1.0
  v_fma_f32 v57, v49, v25, 1.0
  s_waitcnt lgkmcnt(3)
  v_mfma_f32_32x32x16_bf16 v[88:103], a[52:55], v[76:79], v[88:103]
  ds_read_b128 v[72:75], v120 offset:512
  v_fma_f32 v58, v50, v26, 1.0
  v_fma_f32 v59, v51, v27, 1.0
  v_fma_f32 v60, v52, v28, 1.0
  v_fma_f32 v61, v53, v29, 1.0
  v_fma_f32 v62, v54, v30, 1.0
  s_waitcnt lgkmcnt(3)
  v_mfma_f32_32x32x16_bf16 v[88:103], a[56:59], v[80:83], v[88:103]
  ds_read_b128 v[76:79], v121 offset:512
  v_fma_f32 v63, v55, v31, 1.0
  v_rcp_f32 v56, v56
  v_rcp_f32 v57, v57
  v_rcp_f32 v58, v58
  v_rcp_f32 v59, v59
  s_waitcnt lgkmcnt(3)
  v_mfma_f32_32x32x16_bf16 v[88:103], a[60:63], v[84:87], v[88:103]
  ds_read_b128 v[80:83], v122 offset:512
  v_rcp_f32 v60, v60
  v_rcp_f32 v61, v61
  v_rcp_f32 v62, v62
  v_rcp_f32 v63, v63
  s_waitcnt lgkmcnt(2)
  v_mfma_f32_32x32x16_bf16 v[88:103], a[64:67], v[72:75], v[88:103]
  ds_read_b128 v[84:87], v123 offset:512
  v_fma_f32 v56, v56, -2.0, 1.0
  v_fma_f32 v57, v57, -2.0, 1.0
  v_fma_f32 v58, v58, -2.0, 1.0
  v_fma_f32 v59, v59, -2.0, 1.0
  v_fma_f32 v60, v60, -2.0, 1.0
  s_waitcnt lgkmcnt(2)
  v_mfma_f32_32x32x16_bf16 v[88:103], a[68:71], v[76:79], v[88:103]
  ds_read_b128 v[72:75], v124 offset:512
  v_fma_f32 v61, v61, -2.0, 1.0
  v_fma_f32 v62, v62, -2.0, 1.0
  v_fma_f32 v63, v63, -2.0, 1.0
  v_cvt_pk_bf16_f32 v64, v56, v57
  v_cvt_pk_bf16_f32 v65, v58, v59
  s_waitcnt lgkmcnt(2)
  v_mfma_f32_32x32x16_bf16 v[88:103], a[72:75], v[80:83], v[88:103]
  ds_read_b128 v[76:79], v125 offset:512
  v_cvt_pk_bf16_f32 v66, v60, v61
  v_cvt_pk_bf16_f32 v67, v62, v63
  v_xor_b32 v7, 32, v4
  ds_write_b128 v7, v[64:67] offset:2048
  v_fma_f32 v56, v48, v32, 1.0
  s_waitcnt lgkmcnt(3)
  v_mfma_f32_32x32x16_bf16 v[88:103], a[76:79], v[84:87], v[88:103]
  ds_read_b128 v[80:83], v126 offset:512
  v_fma_f32 v57, v49, v33, 1.0
  v_fma_f32 v58, v50, v34, 1.0
  v_fma_f32 v59, v51, v35, 1.0
  v_fma_f32 v60, v52, v36, 1.0
  v_fma_f32 v61, v53, v37, 1.0
  s_waitcnt lgkmcnt(3)
  v_mfma_f32_32x32x16_bf16 v[88:103], a[80:83], v[72:75], v[88:103]
  ds_read_b128 v[84:87], v127 offset:512
  v_fma_f32 v62, v54, v38, 1.0
  v_fma_f32 v63, v55, v39, 1.0
  v_rcp_f32 v56, v56
  v_rcp_f32 v57, v57
  s_waitcnt lgkmcnt(3)
  v_mfma_f32_32x32x16_bf16 v[88:103], a[84:87], v[76:79], v[88:103]
  ds_read_b128 v[72:75], v120 offset:768
  v_rcp_f32 v58, v58
  v_rcp_f32 v59, v59
  v_rcp_f32 v60, v60
  v_rcp_f32 v61, v61
  v_rcp_f32 v62, v62
  s_waitcnt lgkmcnt(2)
  v_mfma_f32_32x32x16_bf16 v[88:103], a[88:91], v[80:83], v[88:103]
  ds_read_b128 v[76:79], v121 offset:768
  v_rcp_f32 v63, v63
  v_fma_f32 v56, v56, -2.0, 1.0
  v_fma_f32 v57, v57, -2.0, 1.0
  v_fma_f32 v58, v58, -2.0, 1.0
  v_fma_f32 v59, v59, -2.0, 1.0
  s_waitcnt lgkmcnt(2)
  v_mfma_f32_32x32x16_bf16 v[88:103], a[92:95], v[84:87], v[88:103]
  ds_read_b128 v[80:83], v122 offset:768
  v_fma_f32 v60, v60, -2.0, 1.0
  v_fma_f32 v61, v61, -2.0, 1.0
  v_fma_f32 v62, v62, -2.0, 1.0
  v_fma_f32 v63, v63, -2.0, 1.0
  v_cvt_pk_bf16_f32 v64, v56, v57
  v_add_u32 v120, 0x8000, v120
  v_add_u32 v121, 0x8000, v121
  v_add_u32 v122, 0x8000, v122
  s_waitcnt lgkmcnt(2)
  v_mfma_f32_32x32x16_bf16 v[88:103], a[96:99], v[72:75], v[88:103]
  ds_read_b128 v[84:87], v123 offset:768
  v_cvt_pk_bf16_f32 v65, v58, v59
  v_cvt_pk_bf16_f32 v66, v60, v61
  v_cvt_pk_bf16_f32 v67, v62, v63
  v_xor_b32 v7, 48, v4
  ds_write_b128 v7, v[64:67] offset:3072
  v_add_u32 v123, 0x8000, v123
  s_waitcnt lgkmcnt(3)
  v_mfma_f32_32x32x16_bf16 v[88:103], a[100:103], v[76:79], v[88:103]
  ds_read_b128 v[72:75], v124 offset:768
  v_add_u32 v124, 0x8000, v124
  s_waitcnt lgkmcnt(3)
  v_mfma_f32_32x32x16_bf16 v[88:103], a[104:107], v[80:83], v[88:103]
  ds_read_b128 v[76:79], v125 offset:768
  v_add_u32 v125, 0x8000, v125
  s_waitcnt lgkmcnt(3)
  v_mfma_f32_32x32x16_bf16 v[88:103], a[108:111], v[84:87], v[88:103]
  s_waitcnt lgkmcnt(2)
  s_barrier
  ds_read_b128 v[80:83], v126 offset:768
  v_add_u32 v126, 0x8000, v126
  s_waitcnt lgkmcnt(2)
  v_mfma_f32_32x32x16_bf16 v[88:103], a[112:115], v[72:75], v[88:103]
  ds_read_b128 v[84:87], v127 offset:768
  s_waitcnt vmcnt(1)
  ds_read_b128 v[40:43], v5 offset:4096
  ds_read_b128 v[44:47], v5 offset:4112
  v_add_u32 v127, 0x8000, v127
  s_waitcnt lgkmcnt(4)
  v_mfma_f32_32x32x16_bf16 v[88:103], a[116:119], v[76:79], v[88:103]
  ds_read_b128 v[72:75], v120 offset:0
  s_waitcnt lgkmcnt(4)
  v_mfma_f32_32x32x16_bf16 v[88:103], a[120:123], v[80:83], v[88:103]
  ds_read_b128 v[76:79], v121 offset:0
  s_waitcnt lgkmcnt(4)
  v_mfma_f32_32x32x16_bf16 v[88:103], a[124:127], v[84:87], v[88:103]
  ds_read_b128 v[80:83], v122 offset:0
L_jjoin_36:
  v_add_u32 v4, 0x8000, v4
  s_waitcnt lgkmcnt(3)
  s_waitcnt lgkmcnt(2)
  v_mfma_f32_32x32x16_bf16 v[104:119], a[0:3], v[72:75], 0
  ds_read_b128 v[84:87], v123 offset:0
  v_fma_f32 v56, v40, v8, 1.0
  v_fma_f32 v57, v41, v9, 1.0
  v_fma_f32 v58, v42, v10, 1.0
  v_fma_f32 v59, v43, v11, 1.0
  s_waitcnt lgkmcnt(2)
  v_mfma_f32_32x32x16_bf16 v[104:119], a[4:7], v[76:79], v[104:119]
  ds_read_b128 v[72:75], v124 offset:0
  v_fma_f32 v60, v44, v12, 1.0
  v_fma_f32 v61, v45, v13, 1.0
  v_fma_f32 v62, v46, v14, 1.0
  v_fma_f32 v63, v47, v15, 1.0
  v_rcp_f32 v56, v56
  s_waitcnt lgkmcnt(2)
  v_mfma_f32_32x32x16_bf16 v[104:119], a[8:11], v[80:83], v[104:119]
  ds_read_b128 v[76:79], v125 offset:0
  v_rcp_f32 v57, v57
  v_rcp_f32 v58, v58
  v_rcp_f32 v59, v59
  v_rcp_f32 v60, v60
  v_rcp_f32 v61, v61
  s_waitcnt lgkmcnt(2)
  v_mfma_f32_32x32x16_bf16 v[104:119], a[12:15], v[84:87], v[104:119]
  ds_read_b128 v[80:83], v126 offset:0
  v_cvt_pk_bf16_f32 v88, v88, v89
  v_cvt_pk_bf16_f32 v89, v90, v91
  v_rcp_f32 v62, v62
  v_rcp_f32 v63, v63
  v_fma_f32 v56, v56, -2.0, 1.0
  v_fma_f32 v57, v57, -2.0, 1.0
  v_fma_f32 v58, v58, -2.0, 1.0
  s_waitcnt lgkmcnt(2)
  v_mfma_f32_32x32x16_bf16 v[104:119], a[16:19], v[72:75], v[104:119]
  ds_read_b128 v[84:87], v127 offset:0
  v_cvt_pk_bf16_f32 v90, v92, v93
  v_cvt_pk_bf16_f32 v91, v94, v95
  v_fma_f32 v59, v59, -2.0, 1.0
  v_fma_f32 v60, v60, -2.0, 1.0
  v_fma_f32 v61, v61, -2.0, 1.0
  v_fma_f32 v62, v62, -2.0, 1.0
  v_fma_f32 v63, v63, -2.0, 1.0
  s_waitcnt lgkmcnt(2)
  v_mfma_f32_32x32x16_bf16 v[104:119], a[20:23], v[76:79], v[104:119]
  ds_read_b128 v[72:75], v120 offset:256
  v_cvt_pk_bf16_f32 v92, v96, v97
  v_cvt_pk_bf16_f32 v93, v98, v99
  v_cvt_pk_bf16_f32 v64, v56, v57
  v_cvt_pk_bf16_f32 v65, v58, v59
  v_cvt_pk_bf16_f32 v66, v60, v61
  v_cvt_pk_bf16_f32 v67, v62, v63
  s_waitcnt lgkmcnt(2)
  v_mfma_f32_32x32x16_bf16 v[104:119], a[24:27], v[80:83], v[104:119]
  ds_read_b128 v[76:79], v121 offset:256
  v_cvt_pk_bf16_f32 v94, v100, v101
  v_cvt_pk_bf16_f32 v95, v102, v103
  v_xor_b32 v7, 0, v4
  ds_write_b128 v7, v[64:67] offset:0
  v_fma_f32 v56, v40, v16, 1.0
  v_fma_f32 v57, v41, v17, 1.0
  v_fma_f32 v58, v42, v18, 1.0
  s_waitcnt lgkmcnt(3)
  v_mfma_f32_32x32x16_bf16 v[104:119], a[28:31], v[84:87], v[104:119]
  ds_read_b128 v[80:83], v122 offset:256
  s_nop 1
  v_permlane32_swap_b32 v88, v90
  v_fma_f32 v59, v43, v19, 1.0
  v_fma_f32 v60, v44, v20, 1.0
  v_fma_f32 v61, v45, v21, 1.0
  v_fma_f32 v62, v46, v22, 1.0
  v_fma_f32 v63, v47, v23, 1.0
  s_waitcnt lgkmcnt(3)
  v_mfma_f32_32x32x16_bf16 v[104:119], a[32:35], v[72:75], v[104:119]
  ds_read_b128 v[84:87], v123 offset:256
  v_permlane32_swap_b32 v89, v91
  v_permlane32_swap_b32 v92, v94
  v_rcp_f32 v56, v56
  v_rcp_f32 v57, v57
  v_rcp_f32 v58, v58
  v_rcp_f32 v59, v59
  v_rcp_f32 v60, v60
  s_waitcnt lgkmcnt(3)
  v_mfma_f32_32x32x16_bf16 v[104:119], a[36:39], v[76:79], v[104:119]
  ds_read_b128 v[72:75], v124 offset:256
  v_permlane32_swap_b32 v93, v95
  buffer_store_dwordx4 v[88:91], v6, s[16:19], 0 offen offset:0
  v_rcp_f32 v61, v61
  v_rcp_f32 v62, v62
  v_rcp_f32 v63, v63
  v_fma_f32 v56, v56, -2.0, 1.0
  v_fma_f32 v57, v57, -2.0, 1.0
  s_waitcnt lgkmcnt(2)
  v_mfma_f32_32x32x16_bf16 v[104:119], a[40:43], v[80:83], v[104:119]
  ds_read_b128 v[76:79], v125 offset:256
  buffer_store_dwordx4 v[92:95], v6, s[16:19], 0 offen offset:32
  v_add_u32 v6, 0x8000, v6
  v_fma_f32 v58, v58, -2.0, 1.0
  v_fma_f32 v59, v59, -2.0, 1.0
  v_fma_f32 v60, v60, -2.0, 1.0
  v_fma_f32 v61, v61, -2.0, 1.0
  s_waitcnt lgkmcnt(2)
  v_mfma_f32_32x32x16_bf16 v[104:119], a[44:47], v[84:87], v[104:119]
  ds_read_b128 v[80:83], v126 offset:256
  v_fma_f32 v62, v62, -2.0, 1.0
  v_fma_f32 v63, v63, -2.0, 1.0
  v_cvt_pk_bf16_f32 v64, v56, v57
  v_cvt_pk_bf16_f32 v65, v58, v59
  v_cvt_pk_bf16_f32 v66, v60, v61
  s_waitcnt lgkmcnt(2)
  v_mfma_f32_32x32x16_bf16 v[104:119], a[48:51], v[72:75], v[104:119]
  ds_read_b128 v[84:87], v127 offset:256
  v_cvt_pk_bf16_f32 v67, v62, v63
  v_xor_b32 v7, 16, v4
  ds_write_b128 v7, v[64:67] offset:1024
  v_fma_f32 v56, v40, v24, 1.0
  v_fma_f32 v57, v41, v25, 1.0
  s_waitcnt lgkmcnt(3)
  v_mfma_f32_32x32x16_bf16 v[104:119], a[52:55], v[76:79], v[104:119]
  ds_read_b128 v[72:75], v120 offset:512
  v_fma_f32 v58, v42, v26, 1.0
  v_fma_f32 v59, v43, v27, 1.0
  v_fma_f32 v60, v44, v28, 1.0
  v_fma_f32 v61, v45, v29, 1.0
  v_fma_f32 v62, v46, v30, 1.0
  s_waitcnt lgkmcnt(3)
  v_mfma_f32_32x32x16_bf16 v[104:119], a[56:59], v[80:83], v[104:119]
  ds_read_b128 v[76:79], v121 offset:512
  v_fma_f32 v63, v47, v31, 1.0
  v_rcp_f32 v56, v56
  v_rcp_f32 v57, v57
  v_rcp_f32 v58, v58
  v_rcp_f32 v59, v59
  s_waitcnt lgkmcnt(3)
  v_mfma_f32_32x32x16_bf16 v[104:119], a[60:63], v[84:87], v[104:119]
  ds_read_b128 v[80:83], v122 offset:512
  v_rcp_f32 v60, v60
  v_rcp_f32 v61, v61
  v_rcp_f32 v62, v62
  v_rcp_f32 v63, v63
  s_waitcnt lgkmcnt(2)
  v_mfma_f32_32x32x16_bf16 v[104:119], a[64:67], v[72:75], v[104:119]
  ds_read_b128 v[84:87], v123 offset:512
  v_fma_f32 v56, v56, -2.0, 1.0
  v_fma_f32 v57, v57, -2.0, 1.0
  v_fma_f32 v58, v58, -2.0, 1.0
  v_fma_f32 v59, v59, -2.0, 1.0
  v_fma_f32 v60, v60, -2.0, 1.0
  s_waitcnt lgkmcnt(2)
  v_mfma_f32_32x32x16_bf16 v[104:119], a[68:71], v[76:79], v[104:119]
  ds_read_b128 v[72:75], v124 offset:512
  v_fma_f32 v61, v61, -2.0, 1.0
  v_fma_f32 v62, v62, -2.0, 1.0
  v_fma_f32 v63, v63, -2.0, 1.0
  v_cvt_pk_bf16_f32 v64, v56, v57
  v_cvt_pk_bf16_f32 v65, v58, v59
  s_waitcnt lgkmcnt(2)
  v_mfma_f32_32x32x16_bf16 v[104:119], a[72:75], v[80:83], v[104:119]
  ds_read_b128 v[76:79], v125 offset:512
  v_cvt_pk_bf16_f32 v66, v60, v61
  v_cvt_pk_bf16_f32 v67, v62, v63
  v_xor_b32 v7, 32, v4
  ds_write_b128 v7, v[64:67] offset:2048
  v_fma_f32 v56, v40, v32, 1.0
  s_waitcnt lgkmcnt(3)
  v_mfma_f32_32x32x16_bf16 v[104:119], a[76:79], v[84:87], v[104:119]
  ds_read_b128 v[80:83], v126 offset:512
  v_fma_f32 v57, v41, v33, 1.0
  v_fma_f32 v58, v42, v34, 1.0
  v_fma_f32 v59, v43, v35, 1.0
  v_fma_f32 v60, v44, v36, 1.0
  v_fma_f32 v61, v45, v37, 1.0
  s_waitcnt lgkmcnt(3)
  v_mfma_f32_32x32x16_bf16 v[104:119], a[80:83], v[72:75], v[104:119]
  ds_read_b128 v[84:87], v127 offset:512
  v_fma_f32 v62, v46, v38, 1.0
  v_fma_f32 v63, v47, v39, 1.0
  v_rcp_f32 v56, v56
  v_rcp_f32 v57, v57
  s_waitcnt lgkmcnt(3)
  v_mfma_f32_32x32x16_bf16 v[104:119], a[84:87], v[76:79], v[104:119]
  ds_read_b128 v[72:75], v120 offset:768
  v_rcp_f32 v58, v58
  v_rcp_f32 v59, v59
  v_rcp_f32 v60, v60
  v_rcp_f32 v61, v61
  v_rcp_f32 v62, v62
  s_waitcnt lgkmcnt(2)
  v_mfma_f32_32x32x16_bf16 v[104:119], a[88:91], v[80:83], v[104:119]
  ds_read_b128 v[76:79], v121 offset:768
  v_rcp_f32 v63, v63
  v_fma_f32 v56, v56, -2.0, 1.0
  v_fma_f32 v57, v57, -2.0, 1.0
  v_fma_f32 v58, v58, -2.0, 1.0
  v_fma_f32 v59, v59, -2.0, 1.0
  s_waitcnt lgkmcnt(2)
  v_mfma_f32_32x32x16_bf16 v[104:119], a[92:95], v[84:87], v[104:119]
  ds_read_b128 v[80:83], v122 offset:768
  v_fma_f32 v60, v60, -2.0, 1.0
  v_fma_f32 v61, v61, -2.0, 1.0
  v_fma_f32 v62, v62, -2.0, 1.0
  v_fma_f32 v63, v63, -2.0, 1.0
  v_cvt_pk_bf16_f32 v64, v56, v57
  v_add_u32 v120, 0x8000, v120
  v_add_u32 v121, 0x8000, v121
  v_add_u32 v122, 0x8000, v122
  s_waitcnt lgkmcnt(2)
  v_mfma_f32_32x32x16_bf16 v[104:119], a[96:99], v[72:75], v[104:119]
  ds_read_b128 v[84:87], v123 offset:768
  v_cvt_pk_bf16_f32 v65, v58, v59
  v_cvt_pk_bf16_f32 v66, v60, v61
  v_cvt_pk_bf16_f32 v67, v62, v63
  v_xor_b32 v7, 48, v4
  ds_write_b128 v7, v[64:67] offset:3072
  v_add_u32 v123, 0x8000, v123
  s_waitcnt lgkmcnt(3)
  v_mfma_f32_32x32x16_bf16 v[104:119], a[100:103], v[76:79], v[104:119]
  ds_read_b128 v[72:75], v124 offset:768
  v_add_u32 v124, 0x8000, v124
  s_waitcnt lgkmcnt(3)
  v_mfma_f32_32x32x16_bf16 v[104:119], a[104:107], v[80:83], v[104:119]
  ds_read_b128 v[76:79], v125 offset:768
  v_add_u32 v125, 0x8000, v125
  s_waitcnt lgkmcnt(3)
  v_mfma_f32_32x32x16_bf16 v[104:119], a[108:111], v[84:87], v[104:119]
  s_waitcnt lgkmcnt(2)
  s_barrier
  ds_read_b128 v[80:83], v126 offset:768
  v_add_u32 v126, 0x8000, v126
  s_waitcnt lgkmcnt(2)
  v_mfma_f32_32x32x16_bf16 v[104:119], a[112:115], v[72:75], v[104:119]
  ds_read_b128 v[84:87], v127 offset:768
  s_waitcnt vmcnt(0)
  ds_read_b128 v[48:51], v5 offset:5120
  ds_read_b128 v[52:55], v5 offset:5136
  v_add_u32 v127, 0x8000, v127
  s_waitcnt lgkmcnt(4)
  v_mfma_f32_32x32x16_bf16 v[104:119], a[116:119], v[76:79], v[104:119]
  ds_read_b128 v[72:75], v120 offset:0
  s_waitcnt lgkmcnt(4)
  v_mfma_f32_32x32x16_bf16 v[104:119], a[120:123], v[80:83], v[104:119]
  ds_read_b128 v[76:79], v121 offset:0
  s_waitcnt lgkmcnt(4)
  v_mfma_f32_32x32x16_bf16 v[104:119], a[124:127], v[84:87], v[104:119]
  ds_read_b128 v[80:83], v122 offset:0
  v_add_u32 v4, 0xffff0000, v4
  s_waitcnt lgkmcnt(3)
  s_waitcnt lgkmcnt(2)
  v_mfma_f32_32x32x16_bf16 v[88:103], a[0:3], v[72:75], 0
  ds_read_b128 v[84:87], v123 offset:0
  v_fma_f32 v56, v48, v8, 1.0
  v_fma_f32 v57, v49, v9, 1.0
  v_fma_f32 v58, v50, v10, 1.0
  v_fma_f32 v59, v51, v11, 1.0
  s_waitcnt lgkmcnt(2)
  v_mfma_f32_32x32x16_bf16 v[88:103], a[4:7], v[76:79], v[88:103]
  ds_read_b128 v[72:75], v124 offset:0
  v_fma_f32 v60, v52, v12, 1.0
  v_fma_f32 v61, v53, v13, 1.0
  v_fma_f32 v62, v54, v14, 1.0
  v_fma_f32 v63, v55, v15, 1.0
  v_rcp_f32 v56, v56
  s_waitcnt lgkmcnt(2)
  v_mfma_f32_32x32x16_bf16 v[88:103], a[8:11], v[80:83], v[88:103]
  ds_read_b128 v[76:79], v125 offset:0
  v_rcp_f32 v57, v57
  v_rcp_f32 v58, v58
  v_rcp_f32 v59, v59
  v_rcp_f32 v60, v60
  v_rcp_f32 v61, v61
  s_waitcnt lgkmcnt(2)
  v_mfma_f32_32x32x16_bf16 v[88:103], a[12:15], v[84:87], v[88:103]
  ds_read_b128 v[80:83], v126 offset:0
  v_cvt_pk_bf16_f32 v104, v104, v105
  v_cvt_pk_bf16_f32 v105, v106, v107
  v_rcp_f32 v62, v62
  v_rcp_f32 v63, v63
  v_fma_f32 v56, v56, -2.0, 1.0
  v_fma_f32 v57, v57, -2.0, 1.0
  v_fma_f32 v58, v58, -2.0, 1.0
  s_waitcnt lgkmcnt(2)
  v_mfma_f32_32x32x16_bf16 v[88:103], a[16:19], v[72:75], v[88:103]
  ds_read_b128 v[84:87], v127 offset:0
  v_cvt_pk_bf16_f32 v106, v108, v109
  v_cvt_pk_bf16_f32 v107, v110, v111
  v_fma_f32 v59, v59, -2.0, 1.0
  v_fma_f32 v60, v60, -2.0, 1.0
  v_fma_f32 v61, v61, -2.0, 1.0
  v_fma_f32 v62, v62, -2.0, 1.0
  v_fma_f32 v63, v63, -2.0, 1.0
  s_waitcnt lgkmcnt(2)
  v_mfma_f32_32x32x16_bf16 v[88:103], a[20:23], v[76:79], v[88:103]
  ds_read_b128 v[72:75], v120 offset:256
  v_cvt_pk_bf16_f32 v108, v112, v113
  v_cvt_pk_bf16_f32 v109, v114, v115
  v_cvt_pk_bf16_f32 v64, v56, v57
  v_cvt_pk_bf16_f32 v65, v58, v59
  v_cvt_pk_bf16_f32 v66, v60, v61
  v_cvt_pk_bf16_f32 v67, v62, v63
  s_waitcnt lgkmcnt(2)
  v_mfma_f32_32x32x16_bf16 v[88:103], a[24:27], v[80:83], v[88:103]
  ds_read_b128 v[76:79], v121 offset:256
  v_cvt_pk_bf16_f32 v110, v116, v117
  v_cvt_pk_bf16_f32 v111, v118, v119
  v_xor_b32 v7, 0, v4
  ds_write_b128 v7, v[64:67] offset:0
  v_fma_f32 v56, v48, v16, 1.0
  v_fma_f32 v57, v49, v17, 1.0
  v_fma_f32 v58, v50, v18, 1.0
  s_waitcnt lgkmcnt(3)
  v_mfma_f32_32x32x16_bf16 v[88:103], a[28:31], v[84:87], v[88:103]
  ds_read_b128 v[80:83], v122 offset:256
  s_nop 1
  v_permlane32_swap_b32 v104, v106
  v_fma_f32 v59, v51, v19, 1.0
  v_fma_f32 v60, v52, v20, 1.0
  v_fma_f32 v61, v53, v21, 1.0
  v_fma_f32 v62, v54, v22, 1.0
  v_fma_f32 v63, v55, v23, 1.0
  s_waitcnt lgkmcnt(3)
  v_mfma_f32_32x32x16_bf16 v[88:103], a[32:35], v[72:75], v[88:103]
  ds_read_b128 v[84:87], v123 offset:256
  v_permlane32_swap_b32 v105, v107
  v_permlane32_swap_b32 v108, v110
  v_rcp_f32 v56, v56
  v_rcp_f32 v57, v57
  v_rcp_f32 v58, v58
  v_rcp_f32 v59, v59
  v_rcp_f32 v60, v60
  s_waitcnt lgkmcnt(3)
  v_mfma_f32_32x32x16_bf16 v[88:103], a[36:39], v[76:79], v[88:103]
  ds_read_b128 v[72:75], v124 offset:256
  v_permlane32_swap_b32 v109, v111
  buffer_store_dwordx4 v[104:107], v6, s[16:19], 0 offen offset:0
  v_rcp_f32 v61, v61
  v_rcp_f32 v62, v62
  v_rcp_f32 v63, v63
  v_fma_f32 v56, v56, -2.0, 1.0
  v_fma_f32 v57, v57, -2.0, 1.0
  s_waitcnt lgkmcnt(2)
  v_mfma_f32_32x32x16_bf16 v[88:103], a[40:43], v[80:83], v[88:103]
  ds_read_b128 v[76:79], v125 offset:256
  buffer_store_dwordx4 v[108:111], v6, s[16:19], 0 offen offset:32
  v_add_u32 v6, 0x8000, v6
  v_fma_f32 v58, v58, -2.0, 1.0
  v_fma_f32 v59, v59, -2.0, 1.0
  v_fma_f32 v60, v60, -2.0, 1.0
  v_fma_f32 v61, v61, -2.0, 1.0
  s_waitcnt lgkmcnt(2)
  v_mfma_f32_32x32x16_bf16 v[88:103], a[44:47], v[84:87], v[88:103]
  ds_read_b128 v[80:83], v126 offset:256
  v_fma_f32 v62, v62, -2.0, 1.0
  v_fma_f32 v63, v63, -2.0, 1.0
  v_cvt_pk_bf16_f32 v64, v56, v57
  v_cvt_pk_bf16_f32 v65, v58, v59
  v_cvt_pk_bf16_f32 v66, v60, v61
  s_waitcnt lgkmcnt(2)
  v_mfma_f32_32x32x16_bf16 v[88:103], a[48:51], v[72:75], v[88:103]
  ds_read_b128 v[84:87], v127 offset:256
  v_cvt_pk_bf16_f32 v67, v62, v63
  v_xor_b32 v7, 16, v4
  ds_write_b128 v7, v[64:67] offset:1024
  v_fma_f32 v56, v48, v24, 1.0
  v_fma_f32 v57, v49, v25, 1.0
  s_waitcnt lgkmcnt(3)
  v_mfma_f32_32x32x16_bf16 v[88:103], a[52:55], v[76:79], v[88:103]
  ds_read_b128 v[72:75], v120 offset:512
  v_fma_f32 v58, v50, v26, 1.0
  v_fma_f32 v59, v51, v27, 1.0
  v_fma_f32 v60, v52, v28, 1.0
  v_fma_f32 v61, v53, v29, 1.0
  v_fma_f32 v62, v54, v30, 1.0
  s_waitcnt lgkmcnt(3)
  v_mfma_f32_32x32x16_bf16 v[88:103], a[56:59], v[80:83], v[88:103]
  ds_read_b128 v[76:79], v121 offset:512
  v_fma_f32 v63, v55, v31, 1.0
  v_rcp_f32 v56, v56
  v_rcp_f32 v57, v57
  v_rcp_f32 v58, v58
  v_rcp_f32 v59, v59
  s_waitcnt lgkmcnt(3)
  v_mfma_f32_32x32x16_bf16 v[88:103], a[60:63], v[84:87], v[88:103]
  ds_read_b128 v[80:83], v122 offset:512
  v_rcp_f32 v60, v60
  v_rcp_f32 v61, v61
  v_rcp_f32 v62, v62
  v_rcp_f32 v63, v63
  s_waitcnt lgkmcnt(2)
  v_mfma_f32_32x32x16_bf16 v[88:103], a[64:67], v[72:75], v[88:103]
  ds_read_b128 v[84:87], v123 offset:512
  v_fma_f32 v56, v56, -2.0, 1.0
  v_fma_f32 v57, v57, -2.0, 1.0
  v_fma_f32 v58, v58, -2.0, 1.0
  v_fma_f32 v59, v59, -2.0, 1.0
  v_fma_f32 v60, v60, -2.0, 1.0
  s_waitcnt lgkmcnt(2)
  v_mfma_f32_32x32x16_bf16 v[88:103], a[68:71], v[76:79], v[88:103]
  ds_read_b128 v[72:75], v124 offset:512
  v_fma_f32 v61, v61, -2.0, 1.0
  v_fma_f32 v62, v62, -2.0, 1.0
  v_fma_f32 v63, v63, -2.0, 1.0
  v_cvt_pk_bf16_f32 v64, v56, v57
  v_cvt_pk_bf16_f32 v65, v58, v59
  s_waitcnt lgkmcnt(2)
  v_mfma_f32_32x32x16_bf16 v[88:103], a[72:75], v[80:83], v[88:103]
  ds_read_b128 v[76:79], v125 offset:512
  v_cvt_pk_bf16_f32 v66, v60, v61
  v_cvt_pk_bf16_f32 v67, v62, v63
  v_xor_b32 v7, 32, v4
  ds_write_b128 v7, v[64:67] offset:2048
  v_fma_f32 v56, v48, v32, 1.0
  s_waitcnt lgkmcnt(3)
  v_mfma_f32_32x32x16_bf16 v[88:103], a[76:79], v[84:87], v[88:103]
  ds_read_b128 v[80:83], v126 offset:512
  v_fma_f32 v57, v49, v33, 1.0
  v_fma_f32 v58, v50, v34, 1.0
  v_fma_f32 v59, v51, v35, 1.0
  v_fma_f32 v60, v52, v36, 1.0
  v_fma_f32 v61, v53, v37, 1.0
  s_waitcnt lgkmcnt(3)
  v_mfma_f32_32x32x16_bf16 v[88:103], a[80:83], v[72:75], v[88:103]
  ds_read_b128 v[84:87], v127 offset:512
  v_fma_f32 v62, v54, v38, 1.0
  v_fma_f32 v63, v55, v39, 1.0
  v_rcp_f32 v56, v56
  v_rcp_f32 v57, v57
  s_waitcnt lgkmcnt(3)
  v_mfma_f32_32x32x16_bf16 v[88:103], a[84:87], v[76:79], v[88:103]
  ds_read_b128 v[72:75], v120 offset:768
  v_rcp_f32 v58, v58
  v_rcp_f32 v59, v59
  v_rcp_f32 v60, v60
  v_rcp_f32 v61, v61
  v_rcp_f32 v62, v62
  s_waitcnt lgkmcnt(2)
  v_mfma_f32_32x32x16_bf16 v[88:103], a[88:91], v[80:83], v[88:103]
  ds_read_b128 v[76:79], v121 offset:768
  v_rcp_f32 v63, v63
  v_fma_f32 v56, v56, -2.0, 1.0
  v_fma_f32 v57, v57, -2.0, 1.0
  v_fma_f32 v58, v58, -2.0, 1.0
  v_fma_f32 v59, v59, -2.0, 1.0
  s_waitcnt lgkmcnt(2)
  v_mfma_f32_32x32x16_bf16 v[88:103], a[92:95], v[84:87], v[88:103]
  ds_read_b128 v[80:83], v122 offset:768
  v_fma_f32 v60, v60, -2.0, 1.0
  v_fma_f32 v61, v61, -2.0, 1.0
  v_fma_f32 v62, v62, -2.0, 1.0
  v_fma_f32 v63, v63, -2.0, 1.0
  v_cvt_pk_bf16_f32 v64, v56, v57
  v_add_u32 v120, 0xffff0000, v120
  v_add_u32 v121, 0xffff0000, v121
  v_add_u32 v122, 0xffff0000, v122
  s_waitcnt lgkmcnt(2)
  v_mfma_f32_32x32x16_bf16 v[88:103], a[96:99], v[72:75], v[88:103]
  ds_read_b128 v[84:87], v123 offset:768
  v_cvt_pk_bf16_f32 v65, v58, v59
  v_cvt_pk_bf16_f32 v66, v60, v61
  v_cvt_pk_bf16_f32 v67, v62, v63
  v_xor_b32 v7, 48, v4
  ds_write_b128 v7, v[64:67] offset:3072
  v_add_u32 v123, 0xffff0000, v123
  s_waitcnt lgkmcnt(3)
  v_mfma_f32_32x32x16_bf16 v[88:103], a[100:103], v[76:79], v[88:103]
  ds_read_b128 v[72:75], v124 offset:768
  v_add_u32 v124, 0xffff0000, v124
  s_waitcnt lgkmcnt(3)
  v_mfma_f32_32x32x16_bf16 v[88:103], a[104:107], v[80:83], v[88:103]
  ds_read_b128 v[76:79], v125 offset:768
  v_add_u32 v125, 0xffff0000, v125
  s_waitcnt lgkmcnt(3)
  v_mfma_f32_32x32x16_bf16 v[88:103], a[108:111], v[84:87], v[88:103]
  s_waitcnt lgkmcnt(2)
  s_barrier
  ds_read_b128 v[80:83], v126 offset:768
  v_add_u32 v126, 0xffff0000, v126
  s_waitcnt lgkmcnt(2)
  v_mfma_f32_32x32x16_bf16 v[88:103], a[112:115], v[72:75], v[88:103]
  ds_read_b128 v[84:87], v127 offset:768
  v_add_u32 v127, 0xffff0000, v127
  s_waitcnt lgkmcnt(2)
  v_mfma_f32_32x32x16_bf16 v[88:103], a[116:119], v[76:79], v[88:103]
  ds_read_b128 v[72:75], v120 offset:0
  s_waitcnt lgkmcnt(2)
  v_mfma_f32_32x32x16_bf16 v[88:103], a[120:123], v[80:83], v[88:103]
  ds_read_b128 v[76:79], v121 offset:0
  s_waitcnt lgkmcnt(2)
  v_mfma_f32_32x32x16_bf16 v[88:103], a[124:127], v[84:87], v[88:103]
  ds_read_b128 v[80:83], v122 offset:0
  s_waitcnt lgkmcnt(2)
  v_mfma_f32_32x32x16_bf16 v[104:119], a[0:3], v[72:75], 0
  ds_read_b128 v[84:87], v123 offset:0
  s_waitcnt lgkmcnt(2)
  v_mfma_f32_32x32x16_bf16 v[104:119], a[4:7], v[76:79], v[104:119]
  ds_read_b128 v[72:75], v124 offset:0
  s_waitcnt lgkmcnt(2)
  v_mfma_f32_32x32x16_bf16 v[104:119], a[8:11], v[80:83], v[104:119]
  ds_read_b128 v[76:79], v125 offset:0
  s_waitcnt lgkmcnt(2)
  v_mfma_f32_32x32x16_bf16 v[104:119], a[12:15], v[84:87], v[104:119]
  ds_read_b128 v[80:83], v126 offset:0
  v_cvt_pk_bf16_f32 v88, v88, v89
  v_cvt_pk_bf16_f32 v89, v90, v91
  s_waitcnt lgkmcnt(2)
  v_mfma_f32_32x32x16_bf16 v[104:119], a[16:19], v[72:75], v[104:119]
  ds_read_b128 v[84:87], v127 offset:0
  v_cvt_pk_bf16_f32 v90, v92, v93
  v_cvt_pk_bf16_f32 v91, v94, v95
  s_waitcnt lgkmcnt(2)
  v_mfma_f32_32x32x16_bf16 v[104:119], a[20:23], v[76:79], v[104:119]
  ds_read_b128 v[72:75], v120 offset:256
  v_cvt_pk_bf16_f32 v92, v96, v97
  v_cvt_pk_bf16_f32 v93, v98, v99
  s_waitcnt lgkmcnt(2)
  v_mfma_f32_32x32x16_bf16 v[104:119], a[24:27], v[80:83], v[104:119]
  ds_read_b128 v[76:79], v121 offset:256
  v_cvt_pk_bf16_f32 v94, v100, v101
  v_cvt_pk_bf16_f32 v95, v102, v103
  s_waitcnt lgkmcnt(2)
  v_mfma_f32_32x32x16_bf16 v[104:119], a[28:31], v[84:87], v[104:119]
  ds_read_b128 v[80:83], v122 offset:256
  s_nop 1
  v_permlane32_swap_b32 v88, v90
  s_waitcnt lgkmcnt(2)
  v_mfma_f32_32x32x16_bf16 v[104:119], a[32:35], v[72:75], v[104:119]
  ds_read_b128 v[84:87], v123 offset:256
  v_permlane32_swap_b32 v89, v91
  v_permlane32_swap_b32 v92, v94
  s_waitcnt lgkmcnt(2)
  v_mfma_f32_32x32x16_bf16 v[104:119], a[36:39], v[76:79], v[104:119]
  ds_read_b128 v[72:75], v124 offset:256
  v_permlane32_swap_b32 v93, v95
  buffer_store_dwordx4 v[88:91], v6, s[16:19], 0 offen offset:0
  s_waitcnt lgkmcnt(2)
  v_mfma_f32_32x32x16_bf16 v[104:119], a[40:43], v[80:83], v[104:119]
  ds_read_b128 v[76:79], v125 offset:256
  buffer_store_dwordx4 v[92:95], v6, s[16:19], 0 offen offset:32
  v_add_u32 v6, 0x8000, v6
  s_waitcnt lgkmcnt(2)
  v_mfma_f32_32x32x16_bf16 v[104:119], a[44:47], v[84:87], v[104:119]
  ds_read_b128 v[80:83], v126 offset:256
  s_waitcnt lgkmcnt(2)
  v_mfma_f32_32x32x16_bf16 v[104:119], a[48:51], v[72:75], v[104:119]
  ds_read_b128 v[84:87], v127 offset:256
  s_waitcnt lgkmcnt(2)
  v_mfma_f32_32x32x16_bf16 v[104:119], a[52:55], v[76:79], v[104:119]
  ds_read_b128 v[72:75], v120 offset:512
  s_waitcnt lgkmcnt(2)
  v_mfma_f32_32x32x16_bf16 v[104:119], a[56:59], v[80:83], v[104:119]
  ds_read_b128 v[76:79], v121 offset:512
  s_waitcnt lgkmcnt(2)
  v_mfma_f32_32x32x16_bf16 v[104:119], a[60:63], v[84:87], v[104:119]
  ds_read_b128 v[80:83], v122 offset:512
  s_waitcnt lgkmcnt(2)
  v_mfma_f32_32x32x16_bf16 v[104:119], a[64:67], v[72:75], v[104:119]
  ds_read_b128 v[84:87], v123 offset:512
  s_waitcnt lgkmcnt(2)
  v_mfma_f32_32x32x16_bf16 v[104:119], a[68:71], v[76:79], v[104:119]
  ds_read_b128 v[72:75], v124 offset:512
  s_waitcnt lgkmcnt(2)
  v_mfma_f32_32x32x16_bf16 v[104:119], a[72:75], v[80:83], v[104:119]
  ds_read_b128 v[76:79], v125 offset:512
  s_waitcnt lgkmcnt(2)
  v_mfma_f32_32x32x16_bf16 v[104:119], a[76:79], v[84:87], v[104:119]
  ds_read_b128 v[80:83], v126 offset:512
  s_waitcnt lgkmcnt(2)
  v_mfma_f32_32x32x16_bf16 v[104:119], a[80:83], v[72:75], v[104:119]
  ds_read_b128 v[84:87], v127 offset:512
  s_waitcnt lgkmcnt(2)
  v_mfma_f32_32x32x16_bf16 v[104:119], a[84:87], v[76:79], v[104:119]
  ds_read_b128 v[72:75], v120 offset:768
  s_waitcnt lgkmcnt(2)
  v_mfma_f32_32x32x16_bf16 v[104:119], a[88:91], v[80:83], v[104:119]
  ds_read_b128 v[76:79], v121 offset:768
  s_waitcnt lgkmcnt(2)
  v_mfma_f32_32x32x16_bf16 v[104:119], a[92:95], v[84:87], v[104:119]
  ds_read_b128 v[80:83], v122 offset:768
  s_waitcnt lgkmcnt(2)
  v_mfma_f32_32x32x16_bf16 v[104:119], a[96:99], v[72:75], v[104:119]
  ds_read_b128 v[84:87], v123 offset:768
  s_waitcnt lgkmcnt(2)
  v_mfma_f32_32x32x16_bf16 v[104:119], a[100:103], v[76:79], v[104:119]
  ds_read_b128 v[72:75], v124 offset:768
  s_waitcnt lgkmcnt(2)
  v_mfma_f32_32x32x16_bf16 v[104:119], a[104:107], v[80:83], v[104:119]
  ds_read_b128 v[76:79], v125 offset:768
  s_waitcnt lgkmcnt(2)
  v_mfma_f32_32x32x16_bf16 v[104:119], a[108:111], v[84:87], v[104:119]
  ds_read_b128 v[80:83], v126 offset:768
  s_waitcnt lgkmcnt(2)
  v_mfma_f32_32x32x16_bf16 v[104:119], a[112:115], v[72:75], v[104:119]
  ds_read_b128 v[84:87], v127 offset:768
  s_waitcnt lgkmcnt(2)
  v_mfma_f32_32x32x16_bf16 v[104:119], a[116:119], v[76:79], v[104:119]
  s_waitcnt lgkmcnt(1)
  v_mfma_f32_32x32x16_bf16 v[104:119], a[120:123], v[80:83], v[104:119]
  s_waitcnt lgkmcnt(0)
  v_mfma_f32_32x32x16_bf16 v[104:119], a[124:127], v[84:87], v[104:119]
  s_nop 7
  s_nop 3
  v_cvt_pk_bf16_f32 v104, v104, v105
  v_cvt_pk_bf16_f32 v105, v106, v107
  v_cvt_pk_bf16_f32 v106, v108, v109
  v_cvt_pk_bf16_f32 v107, v110, v111
  v_cvt_pk_bf16_f32 v108, v112, v113
  v_cvt_pk_bf16_f32 v109, v114, v115
  v_cvt_pk_bf16_f32 v110, v116, v117
  v_cvt_pk_bf16_f32 v111, v118, v119
  s_nop 1
  v_permlane32_swap_b32 v104, v106
  v_permlane32_swap_b32 v105, v107
  v_permlane32_swap_b32 v108, v110
  v_permlane32_swap_b32 v109, v111
  buffer_store_dwordx4 v[104:107], v6, s[16:19], 0 offen offset:0
  buffer_store_dwordx4 v[108:111], v6, s[16:19], 0 offen offset:32
  v_add_u32 v6, 0x8000, v6
L_done:
  s_endpgm
  s_endpgm
L_code_end:
.section .rodata,"a"
.p2align 6
.amdhsa_kernel standalone__seq2seq_rnn_t_joint__speech_kernel
  .amdhsa_next_free_vgpr 256
  .amdhsa_next_free_sgpr 96
  .amdhsa_accum_offset 128
  .amdhsa_group_segment_fixed_size 0
  .amdhsa_kernarg_size 80
  .amdhsa_user_sgpr_count 2
  .amdhsa_user_sgpr_kernarg_segment_ptr 1
  .amdhsa_system_sgpr_workgroup_id_x 1
.end_amdhsa_kernel
```
